```python
import torch

def _softmax(x, axis=-1):
    return torch.softmax(x, dim=axis)
def _gelu(x):
    return torch.nn.functional.gelu(x, approximate="tanh")
def _silu(x):
    return torch.nn.functional.silu(x)
def _sigmoid(x):
    return torch.sigmoid(x)
def _layernorm(x, axis=-1, eps=1e-5):
    m = x.mean(dim=axis, keepdim=True)
    v = x.var(dim=axis, keepdim=True, unbiased=False)
    return (x - m) / torch.sqrt(v + eps)
def _scatter_add(tgt, idx, src, axis=0):
    return tgt.clone().index_add_(axis, idx, src)
def _segment_sum(src, seg, n):
    out = torch.zeros((n,) + src.shape[1:], dtype=src.dtype)
    return out.index_add_(0, seg, src)
def _pad(x, pw):
    flat = tuple(v for pair in reversed(pw) for v in pair)
    return torch.nn.functional.pad(x, flat)

kernel_name = 'sequential_preLN__sliding_local_dilated__swiglu_ffn__prompt'

def setup_inputs():

    _w = (lambda a: (lambda t: t.to(torch.bfloat16) if t.is_floating_point() else t)(torch.as_tensor(a)))
    def _A_setup():
        B, S, D = 1, 2048, 640
        return {
            "x": _w((lambda *s: torch.randn(*s, dtype=torch.bfloat16) * 0.05)(B, S, D)),
            "wqkv": _w((lambda *s: torch.randn(*s, dtype=torch.bfloat16) * 0.05)(D, 3 * D)),
            "wo": _w((lambda *s: torch.randn(*s, dtype=torch.bfloat16) * 0.05)(D, D)),
        }
    _A_in = _A_setup()

    def _B_setup():
        B, S, D, F = 1, 2048, 640, 1728
        return {
            "x": _w((lambda *s: torch.randn(*s, dtype=torch.bfloat16) * 0.05)(B, S, D)),
            "w_gate": _w((lambda *s: torch.randn(*s, dtype=torch.bfloat16) * 0.05)(D, F)),
            "w_up": _w((lambda *s: torch.randn(*s, dtype=torch.bfloat16) * 0.05)(D, F)),
            "w_down": _w((lambda *s: torch.randn(*s, dtype=torch.bfloat16) * 0.05)(F, D)),
        }
    _B_in = _B_setup()

    return {
        "A_x": _A_in["x"],
        "A_wqkv": _A_in["wqkv"],
        "A_wo": _A_in["wo"],
        "B_x": _B_in["x"],
        "B_w_gate": _B_in["w_gate"],
        "B_w_up": _B_in["w_up"],
        "B_w_down": _B_in["w_down"],
    }

def reference(A_x, A_wqkv, A_wo, B_x, B_w_gate, B_w_up, B_w_down):
    def _A_ref(x, wqkv, wo):
        B, S, D = x.shape
        H = 32; Dh = D // H
        W, dil = 8, 2
        qkv = (lambda x, *d: x.permute(*d))((x @ wqkv).reshape(B, S, 3, H, Dh), 2, 0, 3, 1, 4)
        q, k, v = qkv[0], qkv[1], qkv[2]
        scale = Dh ** -0.5
        pos = torch.arange(S)
        off = torch.arange(W) * dil
        idx = pos[:, None] - off[None, :]
        mask = idx >= 0
        idx_c = torch.where(mask, idx, 0).reshape(-1)
        kg = k[:, :, idx_c, :].reshape(B, H, S, W, Dh)
        vg = v[:, :, idx_c, :].reshape(B, H, S, W, Dh)
        logits = torch.einsum("bhsd,bhswd->bhsw", q, kg) * scale
        logits = torch.where(mask[None, None, :, :], logits, -1e9)
        attn = _softmax(logits, axis=-1)
        o = torch.einsum("bhsw,bhswd->bhsd", attn, vg)
        return (lambda x, *d: x.permute(*d))(o, 0, 2, 1, 3).reshape(B, S, D) @ wo

    def _B_ref(x, w_gate, w_up, w_down):
        g = _silu(x @ w_gate)
        u = x @ w_up
        return (g * u) @ w_down

    x = A_x
    h = x + _A_ref(_layernorm(x, axis=-1), A_wqkv, A_wo)
    h2 = h + _B_ref(_layernorm(h, axis=-1), B_w_gate, B_w_up, B_w_down)
    return h2
```

```asm
; @launch grid=(256,1,1) block=(512,1,1) lds=163840
.amdgcn_target "amdgcn-amd-amdhsa--gfx950"
.text
.globl sequential_preLN__sliding_local_dilated__swiglu_ffn__prompt_kernel
.p2align 8
.type sequential_preLN__sliding_local_dilated__swiglu_ffn__prompt_kernel,@function
sequential_preLN__sliding_local_dilated__swiglu_ffn__prompt_kernel:
    s_cmp_ge_u32 s2, 256
    s_cbranch_scc1 L_end
    s_load_dwordx4 s[4:7], s[0:1], 0
    s_load_dwordx2 s[56:57], s[0:1], 16
    s_load_dwordx4 s[60:63], s[0:1], 32
    s_load_dwordx2 s[58:59], s[0:1], 48
    s_load_dwordx4 s[88:91], s[0:1], 56
    s_load_dwordx2 s[64:65], s[0:1], 72
    v_lshrrev_b32 v1, 6, v0
    v_and_b32 v0, 63, v0
    v_readfirstlane_b32 s3, v1
    v_lshlrev_b32 v2, 4, v0
    s_and_b32 s28, s3, 3
    s_and_b32 s29, s2, 7
    s_lshr_b32 s30, s2, 3
    s_lshl_b32 s29, s29, 2
    s_lshr_b32 s31, s30, 3
    s_add_u32 s29, s29, s31
    s_and_b32 s94, s30, 15
    s_and_b32 s30, s30, 7
    s_cmp_lt_u32 s3, 4
    s_cbranch_scc1 L_cons
    s_lshr_b32 s31, s28, 1
    s_lshl_b32 s31, s31, 5
    s_and_b32 s33, s28, 1
    s_lshl_b32 s33, s33, 2
    s_add_u32 s31, s31, s33
    s_mul_i32 s31, s31, 3840
    s_mul_i32 s33, s30, 160
    s_add_u32 s31, s31, s33
    s_mov_b32 s33, 2185
    s_mov_b32 s40, 3840
    v_mov_b32 v84, 3072
    v_mov_b32 v85, 2048
    v_mov_b32 v86, 1024
    v_mov_b32 v87, 0
    s_mul_i32 s41, s28, 20
    s_lshl_b32 s32, s29, 6
    s_sub_u32 s32, s32, 16
    v_lshrrev_b32 v80, 3, v0
    v_add_u32 v80, s41, v80
    v_and_b32 v81, 7, v0
    v_add_u32 v82, 0, v80
    v_bfe_u32 v83, v82, 1, 3
    v_xor_b32 v83, v83, v81
    v_add_u32 v82, s32, v82
    v_max_i32 v82, 0, v82
    v_mul_u32_u24 v82, 1280, v82
    v_lshl_add_u32 v82, v83, 4, v82
    v_add_u32 v3, 2048, v82
    v_add_u32 v82, 8, v80
    v_bfe_u32 v83, v82, 1, 3
    v_xor_b32 v83, v83, v81
    v_add_u32 v82, s32, v82
    v_max_i32 v82, 0, v82
    v_mul_u32_u24 v82, 1280, v82
    v_lshl_add_u32 v82, v83, 4, v82
    v_add_u32 v4, 1024, v82
    v_add_u32 v82, 16, v80
    v_bfe_u32 v83, v82, 1, 3
    v_xor_b32 v83, v83, v81
    v_add_u32 v82, s32, v82
    v_max_i32 v82, 0, v82
    v_mul_u32_u24 v82, 1280, v82
    v_lshl_add_u32 v82, v83, 4, v82
    v_add_u32 v5, 0, v82
    s_mul_i32 s34, s28, 7680
    s_mul_i32 s35, s28, 2560
    s_add_u32 s35, s35, 30720
    s_mov_b64 s[36:37], -1
    s_cmp_eq_u32 s28, 0
    s_cselect_b32 s36, 0xffffff00, s36
    s_and_b32 s38, s29, 3
    s_mul_i32 s38, s38, 3
    s_mul_i32 s39, s30, 1
    s_add_u32 s38, s38, s39
    s_lshr_b32 s39, s29, 2
    s_mul_i32 s39, s39, 1
    s_add_u32 s38, s38, s39
    s_mul_i32 s39, s38, 6554
    s_lshr_b32 s39, s39, 16
    s_mul_i32 s39, s39, 10
    s_sub_u32 s38, s38, s39
    s_mul_i32 s39, s38, 245760
    s_lshl_b32 s38, s38, 7
    s_waitcnt lgkmcnt(0)
    s_sub_u32 s8, s4, 2048
    s_subb_u32 s9, s5, 0
    s_mov_b32 s10, 2623488
    s_mov_b32 s11, 0x20000
    s_sub_u32 s12, s6, 3072
    s_subb_u32 s13, s7, 0
    s_mov_b32 s14, 2460672
    s_mov_b32 s15, 0x20000
    s_add_u32 m0, s35, 0
    s_mov_b64 exec, s[36:37]
    buffer_load_dwordx4 v3, s[8:11], s38 offen lds
    s_mov_b64 exec, -1
    buffer_load_dwordx4 v4, s[8:11], s38 offen offset:1024 lds
    s_mov_b32 exec_hi, 0
    buffer_load_dwordx4 v5, s[8:11], s38 offen offset:2048 lds
    s_mov_b64 exec, -1
    s_add_u32 m0, s34, 0
    s_add_u32 s38, s38, 128
    s_sub_u32 s97, s38, 1280
    s_cmp_ge_u32 s38, 1280
    s_cselect_b32 s38, s97, s38
    v_add_u32 v80, 0, v0
    v_mul_u32_u24 v81, s33, v80
    v_lshrrev_b32 v81, 16, v81
    v_mul_u32_u24 v82, 30, v81
    v_sub_u32 v80, v80, v82
    v_lshrrev_b32 v82, 2, v81
    v_and_b32 v81, 3, v81
    v_lshl_add_u32 v81, v82, 3, v81
    v_mul_u32_u24 v82, 26, v80
    v_lshrrev_b32 v82, 8, v82
    v_mul_u32_u24 v82, 1120, v82
    v_lshl_add_u32 v80, v80, 4, v82
    v_mad_u32_u24 v80, v81, s40, v80
    v_add3_u32 v6, v80, s31, v84
    buffer_load_dwordx4 v6, s[12:15], s39 offen offset:0 lds
    v_add_u32 v80, 64, v0
    v_mul_u32_u24 v81, s33, v80
    v_lshrrev_b32 v81, 16, v81
    v_mul_u32_u24 v82, 30, v81
    v_sub_u32 v80, v80, v82
    v_lshrrev_b32 v82, 2, v81
    v_and_b32 v81, 3, v81
    v_lshl_add_u32 v81, v82, 3, v81
    v_mul_u32_u24 v82, 26, v80
    v_lshrrev_b32 v82, 8, v82
    v_mul_u32_u24 v82, 1120, v82
    v_lshl_add_u32 v80, v80, 4, v82
    v_mad_u32_u24 v80, v81, s40, v80
    v_add3_u32 v7, v80, s31, v85
    buffer_load_dwordx4 v7, s[12:15], s39 offen offset:1024 lds
    v_add_u32 v80, 128, v0
    v_mul_u32_u24 v81, s33, v80
    v_lshrrev_b32 v81, 16, v81
    v_mul_u32_u24 v82, 30, v81
    v_sub_u32 v80, v80, v82
    v_lshrrev_b32 v82, 2, v81
    v_and_b32 v81, 3, v81
    v_lshl_add_u32 v81, v82, 3, v81
    v_mul_u32_u24 v82, 26, v80
    v_lshrrev_b32 v82, 8, v82
    v_mul_u32_u24 v82, 1120, v82
    v_lshl_add_u32 v80, v80, 4, v82
    v_mad_u32_u24 v80, v81, s40, v80
    v_add3_u32 v8, v80, s31, v86
    buffer_load_dwordx4 v8, s[12:15], s39 offen offset:2048 lds
    v_add_u32 v80, 192, v0
    v_mul_u32_u24 v81, s33, v80
    v_lshrrev_b32 v81, 16, v81
    v_mul_u32_u24 v82, 30, v81
    v_sub_u32 v80, v80, v82
    v_lshrrev_b32 v82, 2, v81
    v_and_b32 v81, 3, v81
    v_lshl_add_u32 v81, v82, 3, v81
    v_mul_u32_u24 v82, 26, v80
    v_lshrrev_b32 v82, 8, v82
    v_mul_u32_u24 v82, 1120, v82
    v_lshl_add_u32 v80, v80, 4, v82
    v_mad_u32_u24 v80, v81, s40, v80
    v_add3_u32 v9, v80, s31, v87
    buffer_load_dwordx4 v9, s[12:15], s39 offen offset:3072 lds
    v_add_u32 v80, 256, v0
    v_mul_u32_u24 v81, s33, v80
    v_lshrrev_b32 v81, 16, v81
    v_mul_u32_u24 v82, 30, v81
    v_sub_u32 v80, v80, v82
    v_lshrrev_b32 v82, 2, v81
    v_and_b32 v81, 3, v81
    v_lshl_add_u32 v81, v82, 3, v81
    v_mul_u32_u24 v82, 26, v80
    v_lshrrev_b32 v82, 8, v82
    v_mul_u32_u24 v82, 1120, v82
    v_lshl_add_u32 v80, v80, 4, v82
    v_mad_u32_u24 v80, v81, s40, v80
    v_add3_u32 v10, v80, s31, v84
    s_add_u32 m0, s34, 4096
    s_nop 0
    buffer_load_dwordx4 v10, s[12:15], s39 offen offset:0 lds
    v_add_u32 v80, 320, v0
    v_mul_u32_u24 v81, s33, v80
    v_lshrrev_b32 v81, 16, v81
    v_mul_u32_u24 v82, 30, v81
    v_sub_u32 v80, v80, v82
    v_lshrrev_b32 v82, 2, v81
    v_and_b32 v81, 3, v81
    v_lshl_add_u32 v81, v82, 3, v81
    v_mul_u32_u24 v82, 26, v80
    v_lshrrev_b32 v82, 8, v82
    v_mul_u32_u24 v82, 1120, v82
    v_lshl_add_u32 v80, v80, 4, v82
    v_mad_u32_u24 v80, v81, s40, v80
    v_add3_u32 v11, v80, s31, v85
    buffer_load_dwordx4 v11, s[12:15], s39 offen offset:1024 lds
    v_add_u32 v80, 384, v0
    v_mul_u32_u24 v81, s33, v80
    v_lshrrev_b32 v81, 16, v81
    v_mul_u32_u24 v82, 30, v81
    v_sub_u32 v80, v80, v82
    v_lshrrev_b32 v82, 2, v81
    v_and_b32 v81, 3, v81
    v_lshl_add_u32 v81, v82, 3, v81
    v_mul_u32_u24 v82, 26, v80
    v_lshrrev_b32 v82, 8, v82
    v_mul_u32_u24 v82, 1120, v82
    v_lshl_add_u32 v80, v80, 4, v82
    v_mad_u32_u24 v80, v81, s40, v80
    v_add3_u32 v12, v80, s31, v86
    buffer_load_dwordx4 v12, s[12:15], s39 offen offset:2048 lds
    v_add_u32 v80, 448, v0
    v_mul_u32_u24 v81, s33, v80
    v_lshrrev_b32 v81, 16, v81
    v_mul_u32_u24 v82, 30, v81
    v_sub_u32 v80, v80, v82
    v_lshrrev_b32 v82, 2, v81
    v_and_b32 v81, 3, v81
    v_lshl_add_u32 v81, v82, 3, v81
    v_mul_u32_u24 v82, 26, v80
    v_lshrrev_b32 v82, 8, v82
    v_mul_u32_u24 v82, 1120, v82
    v_lshl_add_u32 v80, v80, 4, v82
    v_mad_u32_u24 v80, v81, s40, v80
    v_add3_u32 v13, v80, s31, v87
    s_mov_b32 exec_hi, 0
    buffer_load_dwordx4 v13, s[12:15], s39 offen offset:3072 lds
    s_mov_b64 exec, -1
    s_add_u32 s39, s39, 245760
    s_sub_u32 s97, s39, 2457600
    s_cmp_ge_u32 s39, 2457600
    s_cselect_b32 s39, s97, s39
    s_add_u32 m0, s35, 40960
    s_mov_b64 exec, s[36:37]
    buffer_load_dwordx4 v3, s[8:11], s38 offen lds
    s_mov_b64 exec, -1
    buffer_load_dwordx4 v4, s[8:11], s38 offen offset:1024 lds
    s_mov_b32 exec_hi, 0
    buffer_load_dwordx4 v5, s[8:11], s38 offen offset:2048 lds
    s_mov_b64 exec, -1
    s_add_u32 m0, s34, 40960
    s_add_u32 s38, s38, 128
    s_sub_u32 s97, s38, 1280
    s_cmp_ge_u32 s38, 1280
    s_cselect_b32 s38, s97, s38
    buffer_load_dwordx4 v6, s[12:15], s39 offen offset:0 lds
    buffer_load_dwordx4 v7, s[12:15], s39 offen offset:1024 lds
    buffer_load_dwordx4 v8, s[12:15], s39 offen offset:2048 lds
    buffer_load_dwordx4 v9, s[12:15], s39 offen offset:3072 lds
    s_add_u32 m0, s34, 45056
    s_nop 0
    buffer_load_dwordx4 v10, s[12:15], s39 offen offset:0 lds
    buffer_load_dwordx4 v11, s[12:15], s39 offen offset:1024 lds
    buffer_load_dwordx4 v12, s[12:15], s39 offen offset:2048 lds
    s_mov_b32 exec_hi, 0
    buffer_load_dwordx4 v13, s[12:15], s39 offen offset:3072 lds
    s_mov_b64 exec, -1
    s_add_u32 s39, s39, 245760
    s_sub_u32 s97, s39, 2457600
    s_cmp_ge_u32 s39, 2457600
    s_cselect_b32 s39, s97, s39
    s_mul_i32 s66, s2, 6554
    s_lshr_b32 s66, s66, 16
    s_mul_i32 s67, s66, 10
    s_sub_u32 s67, s2, s67
    s_mul_i32 s68, s66, 40
    s_mul_i32 s69, s66, 160
    s_sub_u32 s69, s69, 2544
    s_cmp_lt_u32 s66, 16
    s_cselect_b32 s68, s68, s69
    s_cselect_b32 s41, 4, 80
    s_cselect_b32 s42, 8, 20
    s_cselect_b32 s43, 20, 40
    s_lshr_b32 s69, s28, 1
    s_mul_i32 s69, s69, s41
    s_add_u32 s68, s68, s69
    s_and_b32 s69, s28, 1
    s_mul_i32 s69, s69, s43
    s_add_u32 s68, s68, s69
    s_mul_i32 s68, s68, 1280
    s_lshl_b32 s69, s67, 7
    s_add_u32 s68, s68, s69
    s_cmp_lt_u32 s2, 200
    s_cselect_b32 s45, s68, 0x80000000
    v_lshrrev_b32 v80, 5, v0
    v_mul_u32_u24 v80, s42, v80
    v_bfe_u32 v81, v0, 3, 2
    v_add_u32 v80, v80, v81
    v_mul_u32_u24 v80, 1280, v80
    v_and_b32 v82, 7, v0
    v_lshl_add_u32 v15, v82, 4, v80
    s_lshl_b32 s75, s28, 10
    s_add_u32 m0, s75, 122880
    s_mov_b32 s16, s56
    s_mov_b32 s17, s57
    s_mov_b32 s18, 819200
    s_mov_b32 s19, 0x20000
    buffer_load_dwordx4 v15, s[16:19], s45 offen nt lds
    s_lshl_b32 s67, s67, 2
    s_add_u32 s67, s67, s28
    s_mul_i32 s70, s67, 205
    s_lshr_b32 s70, s70, 10
    s_mul_i32 s71, s70, 5
    s_sub_u32 s71, s67, s71
    s_and_b32 s46, s70, 1
    s_sub_u32 s71, s71, s46
    s_cselect_b32 s71, 4, s71
    s_mul_i32 s70, s70, 102400
    s_lshl_b32 s71, s71, 10
    s_add_u32 s46, s70, s71
    s_mul_i32 s66, s66, 5120
    s_add_u32 s46, s46, s66
    s_add_u32 s46, s46, 0
    s_cmp_lt_u32 s2, 200
    s_cselect_b32 s46, s46, 0x80000000
    s_lshr_b32 s66, s28, 1
    s_lshl_b32 s66, s66, 6
    s_and_b32 s67, s28, 1
    s_lshl_b32 s67, s67, 3
    s_add_u32 s47, s66, s67
    v_and_b32 v80, 3, v0
    v_lshrrev_b32 v81, 2, v0
    v_lshlrev_b32 v81, 7, v81
    v_lshl_add_u32 v82, v80, 4, v81
    v_add_u32 v82, s47, v82
    v_add_u32 v16, 122880, v82
    s_mov_b32 s20, s64
    s_mov_b32 s21, s65
    s_mov_b32 s22, 7667712
    s_mov_b32 s23, 0x20000
    s_cmp_ge_u32 s2, 162
    s_cbranch_scc1 L_pk_wd
    s_cmp_ge_u32 s2, 81
    s_cselect_b32 s66, 1, 0
    s_cselect_b32 s24, s62, s60
    s_cselect_b32 s25, s63, s61
    s_mov_b32 s26, 2211840
    s_mul_i32 s67, s66, 81
    s_sub_u32 s67, s2, s67
    s_mul_i32 s68, s67, 21846
    s_lshr_b32 s68, s68, 16
    s_mul_i32 s69, s68, 3
    s_sub_u32 s67, s67, s69
    s_lshr_b32 s72, s28, 1
    s_lshl_b32 s72, s72, 2
    s_and_b32 s73, s28, 1
    s_lshl_b32 s73, s73, 4
    s_add_u32 s72, s72, s73
    s_mul_i32 s73, s67, 224
    s_add_u32 s72, s72, s73
    s_mul_i32 s72, s72, 3456
    s_lshl_b32 s73, s68, 7
    s_add_u32 s76, s72, s73
    s_lshl_b32 s69, s68, 2
    s_add_u32 s69, s69, s28
    s_mul_i32 s70, s69, 9363
    s_lshr_b32 s70, s70, 16
    s_mul_i32 s71, s70, 7
    s_sub_u32 s71, s69, s71
    s_cmp_eq_u32 s69, 107
    s_cselect_b32 s71, 6, s71
    s_mul_i32 s72, s66, 7
    s_add_u32 s71, s71, s72
    s_mul_i32 s72, s70, 20
    s_mul_i32 s73, s67, 7
    s_add_u32 s72, s72, s73
    s_mul_i32 s72, s72, 14
    s_add_u32 s72, s72, s71
    s_lshl_b32 s48, s72, 10
    s_add_u32 s48, s48, 3031040
    s_mul_i32 s72, s70, 14
    s_add_u32 s72, s72, s71
    s_lshl_b32 s72, s72, 6
    s_mul_i32 s73, s67, 14336
    s_add_u32 s55, s72, s73
    s_add_u32 s55, s55, 7618560
    s_add_u32 s77, s76, 110592
    s_add_u32 s49, s48, 14336
    s_add_u32 s78, s77, 110592
    s_add_u32 s50, s49, 14336
    s_add_u32 s79, s78, 110592
    s_add_u32 s51, s50, 14336
    s_add_u32 s80, s79, 110592
    s_add_u32 s52, s51, 14336
    s_add_u32 s81, s80, 110592
    s_add_u32 s53, s52, 14336
    s_add_u32 s82, s81, 110592
    s_add_u32 s54, s53, 14336
    s_cmp_eq_u32 s67, 2
    s_cselect_b32 s82, 0x80000000, s82
    s_cselect_b32 s54, 0x80000000, s54
    v_lshrrev_b32 v80, 5, v0
    v_lshlrev_b32 v80, 3, v80
    v_bfe_u32 v83, v0, 3, 2
    v_add_u32 v80, v80, v83
    v_mul_u32_u24 v80, 3456, v80
    v_and_b32 v83, 7, v0
    v_lshl_add_u32 v17, v83, 4, v80
    v_and_b32 v80, 3, v0
    v_lshl_add_u32 v82, v80, 3, v81
    s_lshl_b32 s47, s28, 5
    v_add_u32 v82, s47, v82
    s_branch L_pk_done
L_pk_wd:
    s_mov_b32 s24, s58
    s_mov_b32 s25, s59
    s_mov_b32 s26, 2211840
    s_sub_u32 s66, s2, 162
    s_mul_i32 s67, s66, 7282
    s_lshr_b32 s67, s67, 16
    s_mul_i32 s68, s67, 9
    s_sub_u32 s66, s66, s68
    s_mul_i32 s66, s66, 6
    s_lshl_b32 s68, s67, 2
    s_add_u32 s68, s68, s28
    s_lshl_b32 s67, s67, 7
    s_and_b32 s69, s28, 1
    s_mul_i32 s69, s69, 10240
    s_add_u32 s67, s67, s69
    s_lshr_b32 s83, s28, 1
    s_mul_i32 s70, s68, 205
    s_lshr_b32 s70, s70, 10
    s_mul_i32 s71, s70, 5
    s_sub_u32 s71, s68, s71
    s_and_b32 s48, s70, 1
    s_sub_u32 s71, s71, s48
    s_cselect_b32 s71, 4, s71
    s_mul_i32 s70, s70, 276480
    s_lshl_b32 s71, s71, 10
    s_add_u32 s48, s70, s71
    s_mul_i32 s69, s66, 5120
    s_add_u32 s48, s48, s69
    s_add_u32 s48, s48, 819200
    s_mov_b32 s55, 0x80000000
    s_mov_b32 s82, 0x80000000
    s_mov_b32 s54, 0x80000000
    s_mul_i32 s69, s66, 9363
    s_lshr_b32 s69, s69, 16
    s_mul_i32 s70, s69, 7
    s_sub_u32 s70, s66, s70
    s_lshl_b32 s72, s66, 1
    s_cmp_gt_u32 s70, 3
    s_cselect_b32 s71, 1, 0
    s_sub_u32 s72, s72, s71
    s_cmp_eq_u32 s69, 7
    s_cselect_b32 s71, 3, 7
    s_cmp_eq_u32 s70, 3
    s_cselect_b32 s71, s71, 1
    s_mul_i32 s71, s71, s83
    s_add_u32 s72, s72, s71
    s_mul_i32 s72, s72, 20480
    s_add_u32 s72, s72, s67
    s_cmp_lt_u32 s2, 252
    s_cselect_b32 s76, s72, 0x80000000
    s_add_u32 s66, s66, 1
    s_mul_i32 s69, s66, 9363
    s_lshr_b32 s69, s69, 16
    s_mul_i32 s70, s69, 7
    s_sub_u32 s70, s66, s70
    s_lshl_b32 s72, s66, 1
    s_cmp_gt_u32 s70, 3
    s_cselect_b32 s71, 1, 0
    s_sub_u32 s72, s72, s71
    s_cmp_eq_u32 s69, 7
    s_cselect_b32 s71, 3, 7
    s_cmp_eq_u32 s70, 3
    s_cselect_b32 s71, s71, 1
    s_mul_i32 s71, s71, s83
    s_add_u32 s72, s72, s71
    s_mul_i32 s72, s72, 20480
    s_add_u32 s72, s72, s67
    s_cmp_lt_u32 s2, 252
    s_cselect_b32 s77, s72, 0x80000000
    s_add_u32 s66, s66, 1
    s_add_u32 s49, s48, 5120
    s_mul_i32 s69, s66, 9363
    s_lshr_b32 s69, s69, 16
    s_mul_i32 s70, s69, 7
    s_sub_u32 s70, s66, s70
    s_lshl_b32 s72, s66, 1
    s_cmp_gt_u32 s70, 3
    s_cselect_b32 s71, 1, 0
    s_sub_u32 s72, s72, s71
    s_cmp_eq_u32 s69, 7
    s_cselect_b32 s71, 3, 7
    s_cmp_eq_u32 s70, 3
    s_cselect_b32 s71, s71, 1
    s_mul_i32 s71, s71, s83
    s_add_u32 s72, s72, s71
    s_mul_i32 s72, s72, 20480
    s_add_u32 s72, s72, s67
    s_cmp_lt_u32 s2, 252
    s_cselect_b32 s78, s72, 0x80000000
    s_add_u32 s66, s66, 1
    s_add_u32 s50, s49, 5120
    s_mul_i32 s69, s66, 9363
    s_lshr_b32 s69, s69, 16
    s_mul_i32 s70, s69, 7
    s_sub_u32 s70, s66, s70
    s_lshl_b32 s72, s66, 1
    s_cmp_gt_u32 s70, 3
    s_cselect_b32 s71, 1, 0
    s_sub_u32 s72, s72, s71
    s_cmp_eq_u32 s69, 7
    s_cselect_b32 s71, 3, 7
    s_cmp_eq_u32 s70, 3
    s_cselect_b32 s71, s71, 1
    s_mul_i32 s71, s71, s83
    s_add_u32 s72, s72, s71
    s_mul_i32 s72, s72, 20480
    s_add_u32 s72, s72, s67
    s_cmp_lt_u32 s2, 252
    s_cselect_b32 s79, s72, 0x80000000
    s_add_u32 s66, s66, 1
    s_add_u32 s51, s50, 5120
    s_mul_i32 s69, s66, 9363
    s_lshr_b32 s69, s69, 16
    s_mul_i32 s70, s69, 7
    s_sub_u32 s70, s66, s70
    s_lshl_b32 s72, s66, 1
    s_cmp_gt_u32 s70, 3
    s_cselect_b32 s71, 1, 0
    s_sub_u32 s72, s72, s71
    s_cmp_eq_u32 s69, 7
    s_cselect_b32 s71, 3, 7
    s_cmp_eq_u32 s70, 3
    s_cselect_b32 s71, s71, 1
    s_mul_i32 s71, s71, s83
    s_add_u32 s72, s72, s71
    s_mul_i32 s72, s72, 20480
    s_add_u32 s72, s72, s67
    s_cmp_lt_u32 s2, 252
    s_cselect_b32 s80, s72, 0x80000000
    s_add_u32 s66, s66, 1
    s_add_u32 s52, s51, 5120
    s_mul_i32 s69, s66, 9363
    s_lshr_b32 s69, s69, 16
    s_mul_i32 s70, s69, 7
    s_sub_u32 s70, s66, s70
    s_lshl_b32 s72, s66, 1
    s_cmp_gt_u32 s70, 3
    s_cselect_b32 s71, 1, 0
    s_sub_u32 s72, s72, s71
    s_cmp_eq_u32 s69, 7
    s_cselect_b32 s71, 3, 7
    s_cmp_eq_u32 s70, 3
    s_cselect_b32 s71, s71, 1
    s_mul_i32 s71, s71, s83
    s_add_u32 s72, s72, s71
    s_mul_i32 s72, s72, 20480
    s_add_u32 s72, s72, s67
    s_cmp_lt_u32 s2, 252
    s_cselect_b32 s81, s72, 0x80000000
    s_add_u32 s66, s66, 1
    s_add_u32 s53, s52, 5120
    s_cmp_lt_u32 s2, 252
    s_cselect_b32 s48, s48, 0x80000000
    s_cmp_lt_u32 s2, 252
    s_cselect_b32 s49, s49, 0x80000000
    s_cmp_lt_u32 s2, 252
    s_cselect_b32 s50, s50, 0x80000000
    s_cmp_lt_u32 s2, 252
    s_cselect_b32 s51, s51, 0x80000000
    s_cmp_lt_u32 s2, 252
    s_cselect_b32 s52, s52, 0x80000000
    s_cmp_lt_u32 s2, 252
    s_cselect_b32 s53, s53, 0x80000000
    v_lshrrev_b32 v80, 5, v0
    v_lshlrev_b32 v80, 2, v80
    v_bfe_u32 v83, v0, 3, 2
    v_add_u32 v80, v80, v83
    v_mul_u32_u24 v80, 1280, v80
    v_and_b32 v83, 7, v0
    v_lshl_add_u32 v17, v83, 4, v80
L_pk_done:
    s_mov_b32 s27, 0x20000
    v_add_u32 v18, 81920, v82
    v_mov_b32 v20, 0x3f803f80
    v_mov_b32 v21, 0x3f803f80
    v_mov_b32 v22, 0x3f803f80
    v_mov_b32 v23, 0x3f803f80
    v_and_b32 v80, 7, v0
    v_lshlrev_b32 v80, 4, v80
    v_add_u32 v84, 122880, v80
    v_lshrrev_b32 v85, 4, v0
    v_lshlrev_b32 v85, 4, v85
    v_mov_b32 v86, 122848
    s_waitcnt vmcnt(12)
    s_barrier
    s_add_u32 m0, s35, 81920
    s_mov_b64 exec, s[36:37]
    buffer_load_dwordx4 v3, s[8:11], s38 offen lds
    s_mov_b64 exec, -1
    buffer_load_dwordx4 v4, s[8:11], s38 offen offset:1024 lds
    s_mov_b32 exec_hi, 0
    buffer_load_dwordx4 v5, s[8:11], s38 offen offset:2048 lds
    s_mov_b64 exec, -1
    s_add_u32 m0, s34, 81920
    s_add_u32 s38, s38, 128
    s_sub_u32 s97, s38, 1280
    s_cmp_ge_u32 s38, 1280
    s_cselect_b32 s38, s97, s38
    buffer_load_dwordx4 v6, s[12:15], s39 offen offset:0 lds
    buffer_load_dwordx4 v7, s[12:15], s39 offen offset:1024 lds
    buffer_load_dwordx4 v8, s[12:15], s39 offen offset:2048 lds
    buffer_load_dwordx4 v9, s[12:15], s39 offen offset:3072 lds
    s_add_u32 m0, s34, 86016
    s_nop 0
    buffer_load_dwordx4 v10, s[12:15], s39 offen offset:0 lds
    buffer_load_dwordx4 v11, s[12:15], s39 offen offset:1024 lds
    buffer_load_dwordx4 v12, s[12:15], s39 offen offset:2048 lds
    s_mov_b32 exec_hi, 0
    buffer_load_dwordx4 v13, s[12:15], s39 offen offset:3072 lds
    s_mov_b64 exec, -1
    s_add_u32 s39, s39, 245760
    s_sub_u32 s97, s39, 2457600
    s_cmp_ge_u32 s39, 2457600
    s_cselect_b32 s39, s97, s39
    s_waitcnt vmcnt(11)
    s_barrier
    ds_read_b64_tr_b16 v[36:37], v16
    ds_read_b64_tr_b16 v[38:39], v16 offset:2048
    s_waitcnt lgkmcnt(0)
    buffer_store_dwordx4 v[36:39], v2, s[20:23], s46 offen sc1
    s_add_u32 m0, s35, 0
    s_mov_b64 exec, s[36:37]
    buffer_load_dwordx4 v3, s[8:11], s38 offen lds
    s_mov_b64 exec, -1
    buffer_load_dwordx4 v4, s[8:11], s38 offen offset:1024 lds
    s_mov_b32 exec_hi, 0
    buffer_load_dwordx4 v5, s[8:11], s38 offen offset:2048 lds
    s_mov_b64 exec, -1
    s_add_u32 m0, s34, 0
    s_add_u32 s38, s38, 128
    s_sub_u32 s97, s38, 1280
    s_cmp_ge_u32 s38, 1280
    s_cselect_b32 s38, s97, s38
    buffer_load_dwordx4 v6, s[12:15], s39 offen offset:0 lds
    buffer_load_dwordx4 v7, s[12:15], s39 offen offset:1024 lds
    buffer_load_dwordx4 v8, s[12:15], s39 offen offset:2048 lds
    buffer_load_dwordx4 v9, s[12:15], s39 offen offset:3072 lds
    s_add_u32 m0, s34, 4096
    s_nop 0
    buffer_load_dwordx4 v10, s[12:15], s39 offen offset:0 lds
    buffer_load_dwordx4 v11, s[12:15], s39 offen offset:1024 lds
    buffer_load_dwordx4 v12, s[12:15], s39 offen offset:2048 lds
    s_mov_b32 exec_hi, 0
    buffer_load_dwordx4 v13, s[12:15], s39 offen offset:3072 lds
    s_mov_b64 exec, -1
    s_add_u32 s39, s39, 245760
    s_sub_u32 s97, s39, 2457600
    s_cmp_ge_u32 s39, 2457600
    s_cselect_b32 s39, s97, s39
    s_waitcnt vmcnt(12)
    s_barrier
    ds_write_b128 v84, v[20:23] offset:30720
    s_add_u32 m0, s35, 40960
    s_mov_b64 exec, s[36:37]
    buffer_load_dwordx4 v3, s[8:11], s38 offen lds
    s_mov_b64 exec, -1
    buffer_load_dwordx4 v4, s[8:11], s38 offen offset:1024 lds
    s_mov_b32 exec_hi, 0
    buffer_load_dwordx4 v5, s[8:11], s38 offen offset:2048 lds
    s_mov_b64 exec, -1
    s_add_u32 m0, s34, 40960
    s_add_u32 s38, s38, 128
    s_sub_u32 s97, s38, 1280
    s_cmp_ge_u32 s38, 1280
    s_cselect_b32 s38, s97, s38
    buffer_load_dwordx4 v6, s[12:15], s39 offen offset:0 lds
    buffer_load_dwordx4 v7, s[12:15], s39 offen offset:1024 lds
    buffer_load_dwordx4 v8, s[12:15], s39 offen offset:2048 lds
    buffer_load_dwordx4 v9, s[12:15], s39 offen offset:3072 lds
    s_add_u32 m0, s34, 45056
    s_nop 0
    buffer_load_dwordx4 v10, s[12:15], s39 offen offset:0 lds
    buffer_load_dwordx4 v11, s[12:15], s39 offen offset:1024 lds
    buffer_load_dwordx4 v12, s[12:15], s39 offen offset:2048 lds
    s_mov_b32 exec_hi, 0
    buffer_load_dwordx4 v13, s[12:15], s39 offen offset:3072 lds
    s_mov_b64 exec, -1
    s_add_u32 s39, s39, 245760
    s_sub_u32 s97, s39, 2457600
    s_cmp_ge_u32 s39, 2457600
    s_cselect_b32 s39, s97, s39
    s_add_u32 m0, s35, 122880
    s_mov_b64 exec, s[36:37]
    buffer_load_dwordx4 v3, s[8:11], s38 offen lds
    s_mov_b64 exec, -1
    buffer_load_dwordx4 v4, s[8:11], s38 offen offset:1024 lds
    s_mov_b32 exec_hi, 0
    buffer_load_dwordx4 v5, s[8:11], s38 offen offset:2048 lds
    s_mov_b64 exec, -1
    s_add_u32 m0, s34, 122880
    s_add_u32 s38, s38, 128
    s_sub_u32 s97, s38, 1280
    s_cmp_ge_u32 s38, 1280
    s_cselect_b32 s38, s97, s38
    buffer_load_dwordx4 v6, s[12:15], s39 offen offset:0 lds
    buffer_load_dwordx4 v7, s[12:15], s39 offen offset:1024 lds
    buffer_load_dwordx4 v8, s[12:15], s39 offen offset:2048 lds
    buffer_load_dwordx4 v9, s[12:15], s39 offen offset:3072 lds
    s_add_u32 m0, s34, 126976
    s_nop 0
    buffer_load_dwordx4 v10, s[12:15], s39 offen offset:0 lds
    buffer_load_dwordx4 v11, s[12:15], s39 offen offset:1024 lds
    buffer_load_dwordx4 v12, s[12:15], s39 offen offset:2048 lds
    s_mov_b32 exec_hi, 0
    buffer_load_dwordx4 v13, s[12:15], s39 offen offset:3072 lds
    s_mov_b64 exec, -1
    s_add_u32 s39, s39, 245760
    s_sub_u32 s97, s39, 2457600
    s_cmp_ge_u32 s39, 2457600
    s_cselect_b32 s39, s97, s39
    s_waitcnt vmcnt(22) lgkmcnt(0)
    s_barrier
    s_add_u32 m0, s35, 81920
    s_mov_b64 exec, s[36:37]
    buffer_load_dwordx4 v3, s[8:11], s38 offen lds
    s_mov_b64 exec, -1
    buffer_load_dwordx4 v4, s[8:11], s38 offen offset:1024 lds
    s_mov_b32 exec_hi, 0
    buffer_load_dwordx4 v5, s[8:11], s38 offen offset:2048 lds
    s_mov_b64 exec, -1
    s_add_u32 m0, s34, 81920
    s_add_u32 s38, s38, 128
    s_sub_u32 s97, s38, 1280
    s_cmp_ge_u32 s38, 1280
    s_cselect_b32 s38, s97, s38
    buffer_load_dwordx4 v6, s[12:15], s39 offen offset:0 lds
    buffer_load_dwordx4 v7, s[12:15], s39 offen offset:1024 lds
    buffer_load_dwordx4 v8, s[12:15], s39 offen offset:2048 lds
    buffer_load_dwordx4 v9, s[12:15], s39 offen offset:3072 lds
    s_add_u32 m0, s34, 86016
    s_nop 0
    buffer_load_dwordx4 v10, s[12:15], s39 offen offset:0 lds
    buffer_load_dwordx4 v11, s[12:15], s39 offen offset:1024 lds
    buffer_load_dwordx4 v12, s[12:15], s39 offen offset:2048 lds
    s_mov_b32 exec_hi, 0
    buffer_load_dwordx4 v13, s[12:15], s39 offen offset:3072 lds
    s_mov_b64 exec, -1
    s_add_u32 s39, s39, 245760
    s_sub_u32 s97, s39, 2457600
    s_cmp_ge_u32 s39, 2457600
    s_cselect_b32 s39, s97, s39
    s_waitcnt vmcnt(22)
    s_barrier
    s_add_u32 m0, s35, 0
    s_mov_b64 exec, s[36:37]
    buffer_load_dwordx4 v3, s[8:11], s38 offen lds
    s_mov_b64 exec, -1
    buffer_load_dwordx4 v4, s[8:11], s38 offen offset:1024 lds
    s_mov_b32 exec_hi, 0
    buffer_load_dwordx4 v5, s[8:11], s38 offen offset:2048 lds
    s_mov_b64 exec, -1
    s_add_u32 m0, s34, 0
    s_add_u32 s38, s38, 128
    s_sub_u32 s97, s38, 1280
    s_cmp_ge_u32 s38, 1280
    s_cselect_b32 s38, s97, s38
    buffer_load_dwordx4 v6, s[12:15], s39 offen offset:0 lds
    buffer_load_dwordx4 v7, s[12:15], s39 offen offset:1024 lds
    buffer_load_dwordx4 v8, s[12:15], s39 offen offset:2048 lds
    buffer_load_dwordx4 v9, s[12:15], s39 offen offset:3072 lds
    s_add_u32 m0, s34, 4096
    s_nop 0
    buffer_load_dwordx4 v10, s[12:15], s39 offen offset:0 lds
    buffer_load_dwordx4 v11, s[12:15], s39 offen offset:1024 lds
    buffer_load_dwordx4 v12, s[12:15], s39 offen offset:2048 lds
    s_mov_b32 exec_hi, 0
    buffer_load_dwordx4 v13, s[12:15], s39 offen offset:3072 lds
    s_mov_b64 exec, -1
    s_add_u32 s39, s39, 245760
    s_sub_u32 s97, s39, 2457600
    s_cmp_ge_u32 s39, 2457600
    s_cselect_b32 s39, s97, s39
    s_waitcnt vmcnt(22)
    s_barrier
    s_add_u32 m0, s35, 40960
    s_mov_b64 exec, s[36:37]
    buffer_load_dwordx4 v3, s[8:11], s38 offen lds
    s_mov_b64 exec, -1
    buffer_load_dwordx4 v4, s[8:11], s38 offen offset:1024 lds
    s_mov_b32 exec_hi, 0
    buffer_load_dwordx4 v5, s[8:11], s38 offen offset:2048 lds
    s_mov_b64 exec, -1
    s_add_u32 m0, s34, 40960
    s_add_u32 s38, s38, 128
    s_sub_u32 s97, s38, 1280
    s_cmp_ge_u32 s38, 1280
    s_cselect_b32 s38, s97, s38
    buffer_load_dwordx4 v6, s[12:15], s39 offen offset:0 lds
    buffer_load_dwordx4 v7, s[12:15], s39 offen offset:1024 lds
    buffer_load_dwordx4 v8, s[12:15], s39 offen offset:2048 lds
    buffer_load_dwordx4 v9, s[12:15], s39 offen offset:3072 lds
    s_add_u32 m0, s34, 45056
    s_nop 0
    buffer_load_dwordx4 v10, s[12:15], s39 offen offset:0 lds
    buffer_load_dwordx4 v11, s[12:15], s39 offen offset:1024 lds
    buffer_load_dwordx4 v12, s[12:15], s39 offen offset:2048 lds
    s_mov_b32 exec_hi, 0
    buffer_load_dwordx4 v13, s[12:15], s39 offen offset:3072 lds
    s_mov_b64 exec, -1
    s_add_u32 s39, s39, 245760
    s_sub_u32 s97, s39, 2457600
    s_cmp_ge_u32 s39, 2457600
    s_cselect_b32 s39, s97, s39
    s_waitcnt vmcnt(22)
    s_barrier
    s_add_u32 m0, s35, 122880
    s_mov_b64 exec, s[36:37]
    buffer_load_dwordx4 v3, s[8:11], s38 offen lds
    s_mov_b64 exec, -1
    buffer_load_dwordx4 v4, s[8:11], s38 offen offset:1024 lds
    s_mov_b32 exec_hi, 0
    buffer_load_dwordx4 v5, s[8:11], s38 offen offset:2048 lds
    s_mov_b64 exec, -1
    s_add_u32 m0, s34, 122880
    s_add_u32 s38, s38, 128
    s_sub_u32 s97, s38, 1280
    s_cmp_ge_u32 s38, 1280
    s_cselect_b32 s38, s97, s38
    buffer_load_dwordx4 v6, s[12:15], s39 offen offset:0 lds
    buffer_load_dwordx4 v7, s[12:15], s39 offen offset:1024 lds
    buffer_load_dwordx4 v8, s[12:15], s39 offen offset:2048 lds
    buffer_load_dwordx4 v9, s[12:15], s39 offen offset:3072 lds
    s_add_u32 m0, s34, 126976
    s_nop 0
    buffer_load_dwordx4 v10, s[12:15], s39 offen offset:0 lds
    buffer_load_dwordx4 v11, s[12:15], s39 offen offset:1024 lds
    buffer_load_dwordx4 v12, s[12:15], s39 offen offset:2048 lds
    s_mov_b32 exec_hi, 0
    buffer_load_dwordx4 v13, s[12:15], s39 offen offset:3072 lds
    s_mov_b64 exec, -1
    s_add_u32 s39, s39, 245760
    s_sub_u32 s97, s39, 2457600
    s_cmp_ge_u32 s39, 2457600
    s_cselect_b32 s39, s97, s39
    s_mul_i32 s34, s28, 5120
    v_add_u32 v5, s34, v2
    v_add_u32 v6, 4096, v5
    s_mul_i32 s36, s30, 102400
    s_add_u32 s36, s36, 0
    s_add_u32 s12, s64, s36
    s_addc_u32 s13, s65, 0
    s_mov_b32 s14, 102400
    s_mov_b32 s15, 0x20000
    s_waitcnt vmcnt(22)
    s_barrier
    s_add_u32 m0, s75, 81920
    s_nop 0
    buffer_load_dwordx4 v17, s[24:27], s76 offen nt lds
    s_add_u32 m0, s75, 86016
    s_nop 0
    buffer_load_dwordx4 v17, s[24:27], s77 offen nt lds
    s_add_u32 m0, s75, 90112
    s_nop 0
    buffer_load_dwordx4 v17, s[24:27], s78 offen nt lds
    s_add_u32 m0, s75, 94208
    s_nop 0
    buffer_load_dwordx4 v17, s[24:27], s79 offen nt lds
    s_add_u32 m0, s75, 98304
    s_nop 0
    buffer_load_dwordx4 v17, s[24:27], s80 offen nt lds
    s_add_u32 m0, s75, 102400
    s_nop 0
    buffer_load_dwordx4 v17, s[24:27], s81 offen nt lds
    s_add_u32 m0, s75, 106496
    s_nop 0
    buffer_load_dwordx4 v17, s[24:27], s82 offen nt lds
    s_lshl_b32 s66, s29, 2
    s_add_u32 s66, s66, s28
    s_mul_i32 s67, s66, 20480
    s_mul_i32 s68, s30, 2560
    s_add_u32 s67, s67, s68
    s_add_u32 s67, s67, 7667712
    v_lshlrev_b32 v80, 7, v0
    v_add_u32 v81, s67, v80
    v_add_u32 v82, 2618880, v81
    v_cmp_gt_u32 vcc, 20, v0
    s_lshl_b32 s67, s66, 10
    s_lshl_b32 s68, s30, 7
    s_add_u32 s67, s67, s68
    s_add_u32 s67, s67, 12910592
    v_cndmask_b32 v81, v82, v81, vcc
    v_writelane_b32 v81, s67, 40
    s_lshl_b32 s67, s29, 7
    s_add_u32 s67, s67, 20381696
    v_writelane_b32 v81, s67, 41
    s_add_u32 s67, s67, 4096
    v_writelane_b32 v81, s67, 42
    s_add_u32 s67, s67, 4096
    v_writelane_b32 v81, s67, 43
    s_mov_b32 s69, s67
    s_mul_i32 s67, s66, 57344
    s_mul_i32 s68, s30, 4352
    s_add_u32 s67, s67, s68
    s_add_u32 s67, s67, 13062144
    v_add_u32 v19, s67, v80
    v_writelane_b32 v19, s69, 34
    v_mov_b32 v91, s69
    s_mov_b32 s84, s64
    s_mov_b32 s85, s65
    s_mov_b32 s86, 20447232
    s_mov_b32 s87, 0x20000
    v_mov_b32 v90, v81
    s_waitcnt vmcnt(18)
    s_barrier
    s_mov_b32 s33, 0
    s_add_u32 m0, s34, 0
    s_nop 0
    buffer_load_dwordx4 v5, s[12:15], s33 offen offset:0 sc1 lds
    buffer_load_dwordx4 v5, s[12:15], s33 offen offset:1024 sc1 lds
    buffer_load_dwordx4 v5, s[12:15], s33 offen offset:2048 sc1 lds
    buffer_load_dwordx4 v5, s[12:15], s33 offen offset:3072 sc1 lds
    s_add_u32 m0, s34, 4096
    s_nop 0
    buffer_load_dwordx4 v6, s[12:15], s33 offen sc1 lds
    s_mov_b32 s33, 20480
    s_add_u32 m0, s34, 20480
    s_nop 0
    buffer_load_dwordx4 v5, s[12:15], s33 offen offset:0 sc1 lds
    buffer_load_dwordx4 v5, s[12:15], s33 offen offset:1024 sc1 lds
    buffer_load_dwordx4 v5, s[12:15], s33 offen offset:2048 sc1 lds
    buffer_load_dwordx4 v5, s[12:15], s33 offen offset:3072 sc1 lds
    s_add_u32 m0, s34, 24576
    s_nop 0
    buffer_load_dwordx4 v6, s[12:15], s33 offen sc1 lds
    ds_read_b32 v83, v86
    s_waitcnt lgkmcnt(0)
    v_readfirstlane_b32 s92, v83
    s_nop 0
    s_cmp_eq_u32 s92, 1
    s_cselect_b32 s83, 0, 0x80000000
    s_mov_b32 exec_hi, 0xfff
    buffer_load_dword v88, v90, s[84:87], s83 offen
    s_mov_b64 exec, -1
    s_waitcnt vmcnt(11)
    s_barrier
    ds_read_b64_tr_b16 v[100:101], v18 offset:0
    ds_read_b64_tr_b16 v[102:103], v18 offset:2048
    ds_read_b64_tr_b16 v[104:105], v18 offset:4096
    ds_read_b64_tr_b16 v[106:107], v18 offset:6144
    ds_read_b64_tr_b16 v[108:109], v18 offset:8192
    ds_read_b64_tr_b16 v[110:111], v18 offset:10240
    ds_read_b64_tr_b16 v[112:113], v18 offset:12288
    ds_read_b64_tr_b16 v[114:115], v18 offset:14336
    ds_read_b64_tr_b16 v[116:117], v18 offset:16384
    ds_read_b64_tr_b16 v[118:119], v18 offset:18432
    ds_read_b64_tr_b16 v[120:121], v18 offset:20480
    ds_read_b64_tr_b16 v[122:123], v18 offset:22528
    ds_read_b64_tr_b16 v[124:125], v18 offset:24576
    ds_read_b64_tr_b16 v[126:127], v18 offset:26624
    ds_read_b32 v87, v86 offset:4
    s_waitcnt lgkmcnt(13)
    buffer_store_dwordx4 v[100:103], v2, s[20:23], s48 offen sc1
    v_mfma_f32_16x16x32_bf16 v[24:27], v[100:103], v[20:23], 0
    s_waitcnt lgkmcnt(11)
    buffer_store_dwordx4 v[104:107], v2, s[20:23], s49 offen sc1
    v_mfma_f32_16x16x32_bf16 v[24:27], v[104:107], v[20:23], v[24:27]
    s_waitcnt lgkmcnt(9)
    buffer_store_dwordx4 v[108:111], v2, s[20:23], s50 offen sc1
    v_mfma_f32_16x16x32_bf16 v[24:27], v[108:111], v[20:23], v[24:27]
    s_waitcnt lgkmcnt(7)
    buffer_store_dwordx4 v[112:115], v2, s[20:23], s51 offen sc1
    v_mfma_f32_16x16x32_bf16 v[24:27], v[112:115], v[20:23], v[24:27]
    s_waitcnt lgkmcnt(5)
    buffer_store_dwordx4 v[116:119], v2, s[20:23], s52 offen sc1
    v_mfma_f32_16x16x32_bf16 v[24:27], v[116:119], v[20:23], v[24:27]
    s_waitcnt lgkmcnt(3)
    buffer_store_dwordx4 v[120:123], v2, s[20:23], s53 offen sc1
    v_mfma_f32_16x16x32_bf16 v[24:27], v[120:123], v[20:23], v[24:27]
    s_waitcnt lgkmcnt(1)
    buffer_store_dwordx4 v[124:127], v2, s[20:23], s54 offen sc1
    v_mfma_f32_16x16x32_bf16 v[24:27], v[124:127], v[20:23], v[24:27]
    s_mov_b32 exec_lo, 0x00010001
    s_mov_b32 exec_hi, 0x00010001
    s_nop 5
    buffer_store_dwordx4 v[24:27], v85, s[20:23], s55 offen sc1
    s_mov_b64 exec, -1
    s_waitcnt lgkmcnt(0)
    v_readfirstlane_b32 s93, v87
    s_mul_i32 s35, s28, 7168
    s_lshl_b32 s37, s28, 12
    v_add_u32 v3, 18432, v2
    v_add_u32 v7, s35, v2
    v_add_u32 v8, 4096, v7
    s_lshr_b32 s31, s29, 1
    s_lshl_b32 s31, s31, 2
    s_add_u32 s31, s31, s28
    s_lshl_b32 s31, s31, 1
    s_mul_i32 s40, s31, 20480
    s_add_u32 s40, s40, 10289152
    s_mul_i32 s41, s94, 286720
    s_add_u32 s41, s41, 3031040
    s_mov_b32 s38, 0
    s_mov_b32 s39, 0
    s_add_u32 s16, s64, s41
    s_addc_u32 s17, s65, 0
    s_mov_b32 s18, 286720
    s_mov_b32 s19, 0x20000
    s_add_u32 s8, s64, s40
    s_addc_u32 s9, s65, 0
    s_mov_b32 s10, 40960
    s_mov_b32 s11, 0x20000
    s_cmp_eq_u32 s94, 15
    s_cselect_b32 s95, 0x80000000, 0
    s_mov_b32 s33, 40960
    s_add_u32 m0, s34, 40960
    s_nop 0
    buffer_load_dwordx4 v5, s[12:15], s33 offen offset:0 sc1 lds
    buffer_load_dwordx4 v5, s[12:15], s33 offen offset:1024 sc1 lds
    buffer_load_dwordx4 v5, s[12:15], s33 offen offset:2048 sc1 lds
    buffer_load_dwordx4 v5, s[12:15], s33 offen offset:3072 sc1 lds
    s_add_u32 m0, s34, 45056
    s_nop 0
    buffer_load_dwordx4 v6, s[12:15], s33 offen sc1 lds
    s_mov_b32 s33, 61440
    s_add_u32 m0, s34, 61440
    s_nop 0
    buffer_load_dwordx4 v5, s[12:15], s33 offen offset:0 sc1 lds
    buffer_load_dwordx4 v5, s[12:15], s33 offen offset:1024 sc1 lds
    buffer_load_dwordx4 v5, s[12:15], s33 offen offset:2048 sc1 lds
    buffer_load_dwordx4 v5, s[12:15], s33 offen offset:3072 sc1 lds
    s_add_u32 m0, s34, 65536
    s_nop 0
    buffer_load_dwordx4 v6, s[12:15], s33 offen sc1 lds
    s_mov_b32 s96, 0
L_bal:
    ds_read_b32 v83, v86 offset:16
    s_add_u32 s96, s96, 1
    s_waitcnt lgkmcnt(0)
    v_readfirstlane_b32 s97, v83
    s_cmp_ge_u32 s96, 1600000
    s_cbranch_scc1 L_end
    s_cmp_lt_u32 s97, 4
    s_cbranch_scc1 L_bal
    s_mov_b32 s33, 81920
    s_add_u32 m0, s34, 122880
    s_nop 0
    buffer_load_dwordx4 v5, s[12:15], s33 offen offset:0 sc1 lds
    buffer_load_dwordx4 v5, s[12:15], s33 offen offset:1024 sc1 lds
    buffer_load_dwordx4 v5, s[12:15], s33 offen offset:2048 sc1 lds
    buffer_load_dwordx4 v5, s[12:15], s33 offen offset:3072 sc1 lds
    s_add_u32 m0, s34, 126976
    s_nop 0
    buffer_load_dwordx4 v6, s[12:15], s33 offen sc1 lds
    s_add_u32 s24, s64, 20381696
    s_addc_u32 s25, s65, 0
    s_mov_b32 s26, 65536
    s_mov_b32 s27, 0x20000
    s_lshl_b32 s42, s2, 7
    s_add_u32 s42, s42, 16384
    v_mov_b32 v80, s93
    v_mov_b32 v81, 0
    v_mov_b32 v82, 1
    s_mov_b32 s46, 16384
    s_waitcnt vmcnt(0)
    s_mov_b64 exec, 1
    ds_add_rtn_u32 v83, v86, v82 offset:8
    s_waitcnt lgkmcnt(0)
    v_readfirstlane_b32 s43, v83
    s_mov_b32 s49, s42
    s_cmp_eq_u32 s43, 3
    s_cselect_b32 s42, s42, 0x80000000
    buffer_store_dword v80, v81, s[24:27], s42 offen sc1
    s_mov_b64 exec, -1
    s_mul_i32 s66, s94, 7
    s_add_u32 s67, s66, 6
    s_lshr_b32 s66, s66, 2
    s_lshr_b32 s67, s67, 2
    s_min_u32 s67, s67, 26
    s_sub_u32 s67, s67, s66
    s_mul_i32 s67, s67, 3
    s_add_u32 s67, s67, 3
    s_mul_i32 s66, s66, 3
    s_lshl_b32 s72, 1, s67
    s_sub_u32 s72, s72, 1
    s_mul_i32 s72, s72, 0x10001
    s_mov_b32 s73, 0
    v_lshrrev_b32 v83, 4, v0
    v_mul_u32_u24 v83, 65, v83
    v_add3_u32 v83, v83, v0, s66
    v_lshlrev_b32 v52, 7, v83
    s_mul_i32 s66, s30, 5
    s_lshr_b32 s66, s66, 2
    s_mul_i32 s66, s66, 9
    s_add_u32 s66, s66, 162
    v_add_u32 v83, s66, v0
    v_lshlrev_b32 v53, 7, v83
    s_lshl_b32 s42, s31, 10
    s_add_u32 s42, s42, 12910592
    s_mul_i32 s43, s94, 896
    s_add_u32 s43, s43, 7618560
    s_lshl_b32 s45, s28, 11
    s_add_u32 s45, s45, 145408
    s_mov_b32 s47, 14336
    s_mov_b32 s48, 28672
    s_add_u32 s20, s64, s42
    s_addc_u32 s21, s65, 0
    s_mov_b32 s22, 2048
    s_mov_b32 s23, 0x20000
    s_barrier
    s_cmp_lg_u32 s28, 0
    s_cbranch_scc1 L_pfw
    s_mov_b64 exec, s[72:73]
    s_mov_b32 s96, 0
L_spb:
    buffer_load_dword v36, v52, s[24:27], s46 offen sc1
    s_waitcnt vmcnt(0)
    v_cmp_ne_u32 vcc, s93, v36
    s_add_u32 s96, s96, 1
    s_cmp_eq_u64 vcc, 0
    s_cbranch_scc1 L_spokb
    s_cmp_lt_u32 s96, 200000
    s_sleep 8
    s_cbranch_scc1 L_spb
    s_endpgm
L_spokb:
    s_mov_b64 exec, -1
    ds_write_b32 v86, v82 offset:12
    s_branch L_pfgo
L_pfw:
    s_mov_b32 s96, 0
L_pfw2:
    s_sleep 2
    ds_read_b32 v83, v86 offset:12
    s_add_u32 s96, s96, 1
    s_waitcnt lgkmcnt(0)
    v_readfirstlane_b32 s97, v83
    s_cmp_ge_u32 s96, 1600000
    s_cbranch_scc1 L_end
    s_cmp_eq_u32 s97, 0
    s_cbranch_scc1 L_pfw2
L_pfgo:
    s_add_u32 m0, s35, 81920
    s_or_b32 s74, s39, s95
    buffer_load_dwordx4 v7, s[16:19], s39 offen offset:0 sc1 lds
    buffer_load_dwordx4 v7, s[16:19], s39 offen offset:1024 sc1 lds
    buffer_load_dwordx4 v7, s[16:19], s74 offen offset:2048 sc1 lds
    buffer_load_dwordx4 v7, s[16:19], s74 offen offset:3072 sc1 lds
    s_add_u32 m0, s35, 86016
    s_nop 0
    buffer_load_dwordx4 v8, s[16:19], s74 offen offset:0 sc1 lds
    buffer_load_dwordx4 v8, s[16:19], s74 offen offset:1024 sc1 lds
    buffer_load_dwordx4 v8, s[16:19], s39 offen offset:2048 sc1 lds
    s_add_u32 s39, s39, 28672
    s_add_u32 s68, s64, s43
    s_addc_u32 s69, s65, 0
    s_mov_b32 s70, 29568
    s_mov_b32 s71, 0x20000
    s_barrier
    s_add_u32 s38, s38, 2048
    s_add_u32 s38, s38, 2048
    s_add_u32 m0, s35, 0
    s_or_b32 s74, s39, s95
    buffer_load_dwordx4 v7, s[16:19], s39 offen offset:0 sc1 lds
    buffer_load_dwordx4 v7, s[16:19], s39 offen offset:1024 sc1 lds
    buffer_load_dwordx4 v7, s[16:19], s74 offen offset:2048 sc1 lds
    buffer_load_dwordx4 v7, s[16:19], s74 offen offset:3072 sc1 lds
    s_add_u32 m0, s35, 4096
    s_nop 0
    buffer_load_dwordx4 v8, s[16:19], s74 offen offset:0 sc1 lds
    buffer_load_dwordx4 v8, s[16:19], s74 offen offset:1024 sc1 lds
    buffer_load_dwordx4 v8, s[16:19], s39 offen offset:2048 sc1 lds
    s_add_u32 s39, s39, 28672
    s_waitcnt vmcnt(7)
    s_barrier
    s_add_u32 m0, s37, 126976
    s_nop 0
    buffer_load_dwordx4 v2, s[8:11], s38 offen offset:0 sc1 lds
    buffer_load_dwordx4 v2, s[8:11], s38 offen offset:1024 sc1 lds
    buffer_load_dwordx4 v3, s[8:11], s38 offen offset:2048 sc1 lds
    buffer_load_dwordx4 v3, s[8:11], s38 offen offset:3072 sc1 lds
    s_add_u32 s38, s38, 2048
    s_add_u32 m0, s35, 28672
    s_or_b32 s74, s39, s95
    buffer_load_dwordx4 v7, s[16:19], s39 offen offset:0 sc1 lds
    buffer_load_dwordx4 v7, s[16:19], s39 offen offset:1024 sc1 lds
    buffer_load_dwordx4 v7, s[16:19], s74 offen offset:2048 sc1 lds
    buffer_load_dwordx4 v7, s[16:19], s74 offen offset:3072 sc1 lds
    s_add_u32 m0, s35, 32768
    s_nop 0
    buffer_load_dwordx4 v8, s[16:19], s74 offen offset:0 sc1 lds
    buffer_load_dwordx4 v8, s[16:19], s74 offen offset:1024 sc1 lds
    buffer_load_dwordx4 v8, s[16:19], s39 offen offset:2048 sc1 lds
    s_add_u32 s39, s39, 28672
    buffer_load_dwordx4 v[36:39], v2, s[68:71], 0 offen sc1
    buffer_load_dwordx4 v[40:43], v2, s[68:71], s47 offen sc1
    buffer_load_dwordx4 v[44:47], v2, s[68:71], s48 offen sc1
    s_mov_b32 m0, s45
    s_nop 0
    buffer_load_dwordx4 v2, s[20:23], 0 offen sc1 lds
    buffer_load_dwordx4 v2, s[20:23], 0 offen offset:1024 sc1 lds
    s_mul_i32 s36, s30, 276480
    s_add_u32 s36, s36, 819200
    s_lshl_b32 s40, s29, 2
    s_add_u32 s40, s40, s28
    s_mul_i32 s41, s40, 57344
    s_add_u32 s41, s41, 13041664
    s_mul_i32 s40, s40, 20480
    s_add_u32 s40, s40, 7667712
    s_cmp_eq_u32 s92, 1
    s_cselect_b32 s40, s40, s41
    s_and_b32 s32, s29, 3
    s_mul_i32 s32, s32, 3
    s_add_u32 s32, s32, s30
    s_sub_u32 s33, s32, 13
    s_cmp_ge_u32 s32, 13
    s_cselect_b32 s32, s33, s32
    s_mul_i32 s33, s32, 20480
    s_lshl_b32 s32, s32, 12
    s_add_u32 s12, s64, s36
    s_addc_u32 s13, s65, 0
    s_mov_b32 s14, 276480
    s_mov_b32 s15, 0x20000
    s_waitcnt vmcnt(16)
    s_barrier
    s_add_u32 m0, s37, 57344
    s_nop 0
    buffer_load_dwordx4 v2, s[8:11], s38 offen offset:0 sc1 lds
    buffer_load_dwordx4 v2, s[8:11], s38 offen offset:1024 sc1 lds
    buffer_load_dwordx4 v3, s[8:11], s38 offen offset:2048 sc1 lds
    buffer_load_dwordx4 v3, s[8:11], s38 offen offset:3072 sc1 lds
    s_add_u32 s38, s38, 2048
    s_add_u32 m0, s35, 81920
    s_or_b32 s74, s39, s95
    buffer_load_dwordx4 v7, s[16:19], s39 offen offset:0 sc1 lds
    buffer_load_dwordx4 v7, s[16:19], s39 offen offset:1024 sc1 lds
    buffer_load_dwordx4 v7, s[16:19], s74 offen offset:2048 sc1 lds
    buffer_load_dwordx4 v7, s[16:19], s74 offen offset:3072 sc1 lds
    s_add_u32 m0, s35, 86016
    s_nop 0
    buffer_load_dwordx4 v8, s[16:19], s74 offen offset:0 sc1 lds
    buffer_load_dwordx4 v8, s[16:19], s74 offen offset:1024 sc1 lds
    buffer_load_dwordx4 v8, s[16:19], s39 offen offset:2048 sc1 lds
    s_add_u32 s39, s39, 28672
    s_waitcnt vmcnt(16)
    s_barrier
    s_add_u32 m0, s37, 110592
    s_nop 0
    buffer_load_dwordx4 v2, s[8:11], s38 offen offset:0 sc1 lds
    buffer_load_dwordx4 v2, s[8:11], s38 offen offset:1024 sc1 lds
    buffer_load_dwordx4 v3, s[8:11], s38 offen offset:2048 sc1 lds
    buffer_load_dwordx4 v3, s[8:11], s38 offen offset:3072 sc1 lds
    s_add_u32 s38, s38, 2048
    s_add_u32 m0, s35, 0
    s_or_b32 s74, s39, s95
    buffer_load_dwordx4 v7, s[16:19], s39 offen offset:0 sc1 lds
    buffer_load_dwordx4 v7, s[16:19], s39 offen offset:1024 sc1 lds
    buffer_load_dwordx4 v7, s[16:19], s74 offen offset:2048 sc1 lds
    buffer_load_dwordx4 v7, s[16:19], s74 offen offset:3072 sc1 lds
    s_add_u32 m0, s35, 4096
    s_nop 0
    buffer_load_dwordx4 v8, s[16:19], s74 offen offset:0 sc1 lds
    buffer_load_dwordx4 v8, s[16:19], s74 offen offset:1024 sc1 lds
    buffer_load_dwordx4 v8, s[16:19], s39 offen offset:2048 sc1 lds
    s_add_u32 s39, s39, 28672
    s_waitcnt vmcnt(25)
    v_pk_add_f32 v[36:37], v[36:37], v[40:41]
    s_waitcnt vmcnt(24)
    v_pk_add_f32 v[36:37], v[36:37], v[44:45]
    v_pk_add_f32 v[38:39], v[38:39], v[42:43]
    v_pk_add_f32 v[38:39], v[38:39], v[46:47]
    v_add_u32 v80, 143360, v2
    ds_write_b128 v80, v[36:39]
    s_waitcnt vmcnt(11) lgkmcnt(0)
    s_barrier
    s_add_u32 m0, s37, 126976
    s_nop 0
    buffer_load_dwordx4 v2, s[8:11], s38 offen offset:0 sc1 lds
    buffer_load_dwordx4 v2, s[8:11], s38 offen offset:1024 sc1 lds
    buffer_load_dwordx4 v3, s[8:11], s38 offen offset:2048 sc1 lds
    buffer_load_dwordx4 v3, s[8:11], s38 offen offset:3072 sc1 lds
    s_add_u32 s38, s38, 2048
    s_add_u32 m0, s35, 28672
    s_or_b32 s74, s39, s95
    buffer_load_dwordx4 v7, s[16:19], s39 offen offset:0 sc1 lds
    buffer_load_dwordx4 v7, s[16:19], s39 offen offset:1024 sc1 lds
    buffer_load_dwordx4 v7, s[16:19], s74 offen offset:2048 sc1 lds
    buffer_load_dwordx4 v7, s[16:19], s74 offen offset:3072 sc1 lds
    s_add_u32 m0, s35, 32768
    s_nop 0
    buffer_load_dwordx4 v8, s[16:19], s74 offen offset:0 sc1 lds
    buffer_load_dwordx4 v8, s[16:19], s74 offen offset:1024 sc1 lds
    buffer_load_dwordx4 v8, s[16:19], s39 offen offset:2048 sc1 lds
    s_add_u32 s39, s39, 28672
    s_waitcnt vmcnt(11)
    s_barrier
    s_add_u32 m0, s37, 57344
    s_nop 0
    buffer_load_dwordx4 v2, s[8:11], s38 offen offset:0 sc1 lds
    buffer_load_dwordx4 v2, s[8:11], s38 offen offset:1024 sc1 lds
    buffer_load_dwordx4 v3, s[8:11], s38 offen offset:2048 sc1 lds
    buffer_load_dwordx4 v3, s[8:11], s38 offen offset:3072 sc1 lds
    s_add_u32 s38, s38, 2048
    s_add_u32 m0, s35, 81920
    s_or_b32 s74, s39, s95
    buffer_load_dwordx4 v7, s[16:19], s39 offen offset:0 sc1 lds
    buffer_load_dwordx4 v7, s[16:19], s39 offen offset:1024 sc1 lds
    buffer_load_dwordx4 v7, s[16:19], s74 offen offset:2048 sc1 lds
    buffer_load_dwordx4 v7, s[16:19], s74 offen offset:3072 sc1 lds
    s_add_u32 m0, s35, 86016
    s_nop 0
    buffer_load_dwordx4 v8, s[16:19], s74 offen offset:0 sc1 lds
    buffer_load_dwordx4 v8, s[16:19], s74 offen offset:1024 sc1 lds
    buffer_load_dwordx4 v8, s[16:19], s39 offen offset:2048 sc1 lds
    s_add_u32 s39, s39, 28672
    s_mov_b64 exec, 0x3ffff
    buffer_load_dword v60, v53, s[24:27], s46 offen sc1
    s_mov_b64 exec, -1
    s_waitcnt vmcnt(12)
    s_barrier
    s_add_u32 m0, s37, 110592
    s_nop 0
    buffer_load_dwordx4 v2, s[8:11], s38 offen offset:0 sc1 lds
    buffer_load_dwordx4 v2, s[8:11], s38 offen offset:1024 sc1 lds
    buffer_load_dwordx4 v3, s[8:11], s38 offen offset:2048 sc1 lds
    buffer_load_dwordx4 v3, s[8:11], s38 offen offset:3072 sc1 lds
    s_add_u32 s38, s38, 2048
    s_add_u32 m0, s35, 0
    s_or_b32 s74, s39, s95
    buffer_load_dwordx4 v7, s[16:19], s39 offen offset:0 sc1 lds
    buffer_load_dwordx4 v7, s[16:19], s39 offen offset:1024 sc1 lds
    buffer_load_dwordx4 v7, s[16:19], s74 offen offset:2048 sc1 lds
    buffer_load_dwordx4 v7, s[16:19], s74 offen offset:3072 sc1 lds
    s_add_u32 m0, s35, 4096
    s_nop 0
    buffer_load_dwordx4 v8, s[16:19], s74 offen offset:0 sc1 lds
    buffer_load_dwordx4 v8, s[16:19], s74 offen offset:1024 sc1 lds
    buffer_load_dwordx4 v8, s[16:19], s39 offen offset:2048 sc1 lds
    s_add_u32 s39, s39, 28672
    s_waitcnt vmcnt(12)
    s_barrier
    s_add_u32 m0, s37, 126976
    s_nop 0
    buffer_load_dwordx4 v2, s[8:11], s38 offen offset:0 sc1 lds
    buffer_load_dwordx4 v2, s[8:11], s38 offen offset:1024 sc1 lds
    buffer_load_dwordx4 v3, s[8:11], s38 offen offset:2048 sc1 lds
    buffer_load_dwordx4 v3, s[8:11], s38 offen offset:3072 sc1 lds
    s_add_u32 s38, s38, 2048
    s_add_u32 m0, s35, 28672
    s_or_b32 s74, s39, s95
    buffer_load_dwordx4 v7, s[16:19], s39 offen offset:0 sc1 lds
    buffer_load_dwordx4 v7, s[16:19], s39 offen offset:1024 sc1 lds
    buffer_load_dwordx4 v7, s[16:19], s74 offen offset:2048 sc1 lds
    buffer_load_dwordx4 v7, s[16:19], s74 offen offset:3072 sc1 lds
    s_add_u32 m0, s35, 32768
    s_nop 0
    buffer_load_dwordx4 v8, s[16:19], s74 offen offset:0 sc1 lds
    buffer_load_dwordx4 v8, s[16:19], s74 offen offset:1024 sc1 lds
    buffer_load_dwordx4 v8, s[16:19], s39 offen offset:2048 sc1 lds
    s_add_u32 s39, s39, 28672
    s_mov_b64 exec, 0x3ffff
    s_waitcnt vmcnt(22)
    v_cmp_ne_u32 vcc, s93, v60
    s_mov_b64 exec, -1
    s_cmp_eq_u64 vcc, 0
    s_cbranch_scc1 L_spokc
    s_mov_b64 exec, 0x3ffff
    s_mov_b32 s96, 0
L_spc:
    buffer_load_dword v60, v53, s[24:27], s46 offen sc1
    s_waitcnt vmcnt(0)
    v_cmp_ne_u32 vcc, s93, v60
    s_add_u32 s96, s96, 1
    s_cmp_eq_u64 vcc, 0
    s_cbranch_scc1 L_spokc
    s_cmp_lt_u32 s96, 200000
    s_sleep 8
    s_cbranch_scc1 L_spc
    s_endpgm
L_spokc:
    s_mov_b64 exec, -1
    s_waitcnt vmcnt(11)
    s_barrier
    s_add_u32 m0, s37, 57344
    s_nop 0
    buffer_load_dwordx4 v2, s[8:11], s38 offen offset:0 sc1 lds
    buffer_load_dwordx4 v2, s[8:11], s38 offen offset:1024 sc1 lds
    buffer_load_dwordx4 v3, s[8:11], s38 offen offset:2048 sc1 lds
    buffer_load_dwordx4 v3, s[8:11], s38 offen offset:3072 sc1 lds
    s_add_u32 s38, s38, 2048
    s_add_u32 m0, s35, 81920
    s_or_b32 s74, s39, s95
    buffer_load_dwordx4 v7, s[16:19], s39 offen offset:0 sc1 lds
    buffer_load_dwordx4 v7, s[16:19], s39 offen offset:1024 sc1 lds
    buffer_load_dwordx4 v7, s[16:19], s74 offen offset:2048 sc1 lds
    buffer_load_dwordx4 v7, s[16:19], s74 offen offset:3072 sc1 lds
    s_add_u32 m0, s35, 86016
    s_nop 0
    buffer_load_dwordx4 v8, s[16:19], s74 offen offset:0 sc1 lds
    buffer_load_dwordx4 v8, s[16:19], s74 offen offset:1024 sc1 lds
    buffer_load_dwordx4 v8, s[16:19], s39 offen offset:2048 sc1 lds
    s_add_u32 s39, s39, 28672
    s_mov_b64 exec, 0xfffff
    buffer_load_dword v88, v90, s[84:87], s83 offen
    s_mov_b32 exec_lo, -1
    s_mov_b32 exec_hi, 7
    buffer_load_dword v88, v19, s[84:87], s83 offen
    s_mov_b64 exec, -1
    s_waitcnt vmcnt(13)
    s_barrier
    s_add_u32 m0, s34, 0
    s_nop 0
    buffer_load_dwordx4 v5, s[12:15], s33 offen offset:0 sc1 lds
    buffer_load_dwordx4 v5, s[12:15], s33 offen offset:1024 sc1 lds
    buffer_load_dwordx4 v5, s[12:15], s33 offen offset:2048 sc1 lds
    buffer_load_dwordx4 v5, s[12:15], s33 offen offset:3072 sc1 lds
    s_add_u32 m0, s34, 4096
    s_nop 0
    buffer_load_dwordx4 v6, s[12:15], s33 offen sc1 lds
    s_add_u32 s33, s33, 20480
    s_sub_u32 s97, s33, 266240
    s_cmp_ge_u32 s33, 266240
    s_cselect_b32 s33, s97, s33
    s_waitcnt vmcnt(7)
    s_barrier
    s_add_u32 m0, s34, 20480
    s_nop 0
    buffer_load_dwordx4 v5, s[12:15], s33 offen offset:0 sc1 lds
    buffer_load_dwordx4 v5, s[12:15], s33 offen offset:1024 sc1 lds
    buffer_load_dwordx4 v5, s[12:15], s33 offen offset:2048 sc1 lds
    buffer_load_dwordx4 v5, s[12:15], s33 offen offset:3072 sc1 lds
    s_add_u32 m0, s34, 24576
    s_nop 0
    buffer_load_dwordx4 v6, s[12:15], s33 offen sc1 lds
    s_add_u32 s33, s33, 20480
    s_sub_u32 s97, s33, 266240
    s_cmp_ge_u32 s33, 266240
    s_cselect_b32 s33, s97, s33
    s_add_u32 m0, s34, 110592
    s_nop 0
    buffer_load_dwordx4 v5, s[12:15], s33 offen offset:0 sc1 lds
    buffer_load_dwordx4 v5, s[12:15], s33 offen offset:1024 sc1 lds
    buffer_load_dwordx4 v5, s[12:15], s33 offen offset:2048 sc1 lds
    buffer_load_dwordx4 v5, s[12:15], s33 offen offset:3072 sc1 lds
    s_add_u32 m0, s34, 114688
    s_nop 0
    buffer_load_dwordx4 v6, s[12:15], s33 offen sc1 lds
    s_add_u32 s33, s33, 20480
    s_sub_u32 s97, s33, 266240
    s_cmp_ge_u32 s33, 266240
    s_cselect_b32 s33, s97, s33
    s_mov_b32 s8, s64
    s_mov_b32 s9, s65
    s_mov_b32 s10, 20381696
    s_mov_b32 s11, 0x20000
    s_barrier
    s_add_u32 s32, s32, 4096
    s_sub_u32 s97, s32, 53248
    s_cmp_ge_u32 s32, 53248
    s_cselect_b32 s32, s97, s32
    s_add_u32 s32, s32, 4096
    s_sub_u32 s97, s32, 53248
    s_cmp_ge_u32 s32, 53248
    s_cselect_b32 s32, s97, s32
    s_waitcnt vmcnt(10)
    s_barrier
    s_add_u32 m0, s37, 147456
    s_cmp_lt_u32 s32, 20480
    s_cselect_b32 s74, s40, s41
    s_add_u32 s74, s74, s32
    buffer_load_dwordx4 v2, s[8:11], s74 offen offset:0 sc1 lds
    buffer_load_dwordx4 v2, s[8:11], s74 offen offset:1024 sc1 lds
    buffer_load_dwordx4 v2, s[8:11], s74 offen offset:2048 sc1 lds
    buffer_load_dwordx4 v2, s[8:11], s74 offen offset:3072 sc1 lds
    s_add_u32 s32, s32, 4096
    s_sub_u32 s97, s32, 53248
    s_cmp_ge_u32 s32, 53248
    s_cselect_b32 s32, s97, s32
    s_add_u32 m0, s34, 40960
    s_nop 0
    buffer_load_dwordx4 v5, s[12:15], s33 offen offset:0 sc1 lds
    buffer_load_dwordx4 v5, s[12:15], s33 offen offset:1024 sc1 lds
    buffer_load_dwordx4 v5, s[12:15], s33 offen offset:2048 sc1 lds
    buffer_load_dwordx4 v5, s[12:15], s33 offen offset:3072 sc1 lds
    s_add_u32 m0, s34, 45056
    s_nop 0
    buffer_load_dwordx4 v6, s[12:15], s33 offen sc1 lds
    s_add_u32 s33, s33, 20480
    s_sub_u32 s97, s33, 266240
    s_cmp_ge_u32 s33, 266240
    s_cselect_b32 s33, s97, s33
    s_add_u32 m0, s34, 61440
    s_nop 0
    buffer_load_dwordx4 v5, s[12:15], s33 offen offset:0 sc1 lds
    buffer_load_dwordx4 v5, s[12:15], s33 offen offset:1024 sc1 lds
    buffer_load_dwordx4 v5, s[12:15], s33 offen offset:2048 sc1 lds
    buffer_load_dwordx4 v5, s[12:15], s33 offen offset:3072 sc1 lds
    s_add_u32 m0, s34, 65536
    s_nop 0
    buffer_load_dwordx4 v6, s[12:15], s33 offen sc1 lds
    s_add_u32 s33, s33, 20480
    s_sub_u32 s97, s33, 266240
    s_cmp_ge_u32 s33, 266240
    s_cselect_b32 s33, s97, s33
    s_waitcnt vmcnt(19)
    s_barrier
    s_add_u32 m0, s37, 81920
    s_cmp_lt_u32 s32, 20480
    s_cselect_b32 s74, s40, s41
    s_add_u32 s74, s74, s32
    buffer_load_dwordx4 v2, s[8:11], s74 offen offset:0 sc1 lds
    buffer_load_dwordx4 v2, s[8:11], s74 offen offset:1024 sc1 lds
    buffer_load_dwordx4 v2, s[8:11], s74 offen offset:2048 sc1 lds
    buffer_load_dwordx4 v2, s[8:11], s74 offen offset:3072 sc1 lds
    s_add_u32 s32, s32, 4096
    s_sub_u32 s97, s32, 53248
    s_cmp_ge_u32 s32, 53248
    s_cselect_b32 s32, s97, s32
    s_add_u32 m0, s34, 0
    s_nop 0
    buffer_load_dwordx4 v5, s[12:15], s33 offen offset:0 sc1 lds
    buffer_load_dwordx4 v5, s[12:15], s33 offen offset:1024 sc1 lds
    buffer_load_dwordx4 v5, s[12:15], s33 offen offset:2048 sc1 lds
    buffer_load_dwordx4 v5, s[12:15], s33 offen offset:3072 sc1 lds
    s_add_u32 m0, s34, 4096
    s_nop 0
    buffer_load_dwordx4 v6, s[12:15], s33 offen sc1 lds
    s_add_u32 s33, s33, 20480
    s_sub_u32 s97, s33, 266240
    s_cmp_ge_u32 s33, 266240
    s_cselect_b32 s33, s97, s33
    s_waitcnt vmcnt(19)
    s_barrier
    s_add_u32 m0, s37, 131072
    s_cmp_lt_u32 s32, 20480
    s_cselect_b32 s74, s40, s41
    s_add_u32 s74, s74, s32
    buffer_load_dwordx4 v2, s[8:11], s74 offen offset:0 sc1 lds
    buffer_load_dwordx4 v2, s[8:11], s74 offen offset:1024 sc1 lds
    buffer_load_dwordx4 v2, s[8:11], s74 offen offset:2048 sc1 lds
    buffer_load_dwordx4 v2, s[8:11], s74 offen offset:3072 sc1 lds
    s_add_u32 s32, s32, 4096
    s_sub_u32 s97, s32, 53248
    s_cmp_ge_u32 s32, 53248
    s_cselect_b32 s32, s97, s32
    s_add_u32 m0, s34, 20480
    s_nop 0
    buffer_load_dwordx4 v5, s[12:15], s33 offen offset:0 sc1 lds
    buffer_load_dwordx4 v5, s[12:15], s33 offen offset:1024 sc1 lds
    buffer_load_dwordx4 v5, s[12:15], s33 offen offset:2048 sc1 lds
    buffer_load_dwordx4 v5, s[12:15], s33 offen offset:3072 sc1 lds
    s_add_u32 m0, s34, 24576
    s_nop 0
    buffer_load_dwordx4 v6, s[12:15], s33 offen sc1 lds
    s_add_u32 s33, s33, 20480
    s_sub_u32 s97, s33, 266240
    s_cmp_ge_u32 s33, 266240
    s_cselect_b32 s33, s97, s33
    s_waitcnt vmcnt(14)
    s_barrier
    s_add_u32 m0, s37, 147456
    s_cmp_lt_u32 s32, 20480
    s_cselect_b32 s74, s40, s41
    s_add_u32 s74, s74, s32
    buffer_load_dwordx4 v2, s[8:11], s74 offen offset:0 sc1 lds
    buffer_load_dwordx4 v2, s[8:11], s74 offen offset:1024 sc1 lds
    buffer_load_dwordx4 v2, s[8:11], s74 offen offset:2048 sc1 lds
    buffer_load_dwordx4 v2, s[8:11], s74 offen offset:3072 sc1 lds
    s_add_u32 s32, s32, 4096
    s_sub_u32 s97, s32, 53248
    s_cmp_ge_u32 s32, 53248
    s_cselect_b32 s32, s97, s32
    s_add_u32 m0, s34, 110592
    s_nop 0
    buffer_load_dwordx4 v5, s[12:15], s33 offen offset:0 sc1 lds
    buffer_load_dwordx4 v5, s[12:15], s33 offen offset:1024 sc1 lds
    buffer_load_dwordx4 v5, s[12:15], s33 offen offset:2048 sc1 lds
    buffer_load_dwordx4 v5, s[12:15], s33 offen offset:3072 sc1 lds
    s_add_u32 m0, s34, 114688
    s_nop 0
    buffer_load_dwordx4 v6, s[12:15], s33 offen sc1 lds
    s_add_u32 s33, s33, 20480
    s_sub_u32 s97, s33, 266240
    s_cmp_ge_u32 s33, 266240
    s_cselect_b32 s33, s97, s33
    s_waitcnt vmcnt(14)
    s_barrier
    s_add_u32 m0, s37, 81920
    s_cmp_lt_u32 s32, 20480
    s_cselect_b32 s74, s40, s41
    s_add_u32 s74, s74, s32
    buffer_load_dwordx4 v2, s[8:11], s74 offen offset:0 sc1 lds
    buffer_load_dwordx4 v2, s[8:11], s74 offen offset:1024 sc1 lds
    buffer_load_dwordx4 v2, s[8:11], s74 offen offset:2048 sc1 lds
    buffer_load_dwordx4 v2, s[8:11], s74 offen offset:3072 sc1 lds
    s_add_u32 s32, s32, 4096
    s_sub_u32 s97, s32, 53248
    s_cmp_ge_u32 s32, 53248
    s_cselect_b32 s32, s97, s32
    s_add_u32 m0, s34, 40960
    s_nop 0
    buffer_load_dwordx4 v5, s[12:15], s33 offen offset:0 sc1 lds
    buffer_load_dwordx4 v5, s[12:15], s33 offen offset:1024 sc1 lds
    buffer_load_dwordx4 v5, s[12:15], s33 offen offset:2048 sc1 lds
    buffer_load_dwordx4 v5, s[12:15], s33 offen offset:3072 sc1 lds
    s_add_u32 m0, s34, 45056
    s_nop 0
    buffer_load_dwordx4 v6, s[12:15], s33 offen sc1 lds
    s_add_u32 s33, s33, 20480
    s_sub_u32 s97, s33, 266240
    s_cmp_ge_u32 s33, 266240
    s_cselect_b32 s33, s97, s33
    s_waitcnt vmcnt(14)
    s_barrier
    s_add_u32 m0, s37, 131072
    s_cmp_lt_u32 s32, 20480
    s_cselect_b32 s74, s40, s41
    s_add_u32 s74, s74, s32
    buffer_load_dwordx4 v2, s[8:11], s74 offen offset:0 sc1 lds
    buffer_load_dwordx4 v2, s[8:11], s74 offen offset:1024 sc1 lds
    buffer_load_dwordx4 v2, s[8:11], s74 offen offset:2048 sc1 lds
    buffer_load_dwordx4 v2, s[8:11], s74 offen offset:3072 sc1 lds
    s_add_u32 s32, s32, 4096
    s_sub_u32 s97, s32, 53248
    s_cmp_ge_u32 s32, 53248
    s_cselect_b32 s32, s97, s32
    s_add_u32 m0, s34, 61440
    s_nop 0
    buffer_load_dwordx4 v5, s[12:15], s33 offen offset:0 sc1 lds
    buffer_load_dwordx4 v5, s[12:15], s33 offen offset:1024 sc1 lds
    buffer_load_dwordx4 v5, s[12:15], s33 offen offset:2048 sc1 lds
    buffer_load_dwordx4 v5, s[12:15], s33 offen offset:3072 sc1 lds
    s_add_u32 m0, s34, 65536
    s_nop 0
    buffer_load_dwordx4 v6, s[12:15], s33 offen sc1 lds
    s_add_u32 s33, s33, 20480
    s_sub_u32 s97, s33, 266240
    s_cmp_ge_u32 s33, 266240
    s_cselect_b32 s33, s97, s33
    s_waitcnt vmcnt(14)
    s_barrier
    s_add_u32 m0, s37, 147456
    s_cmp_lt_u32 s32, 20480
    s_cselect_b32 s74, s40, s41
    s_add_u32 s74, s74, s32
    buffer_load_dwordx4 v2, s[8:11], s74 offen offset:0 sc1 lds
    buffer_load_dwordx4 v2, s[8:11], s74 offen offset:1024 sc1 lds
    buffer_load_dwordx4 v2, s[8:11], s74 offen offset:2048 sc1 lds
    buffer_load_dwordx4 v2, s[8:11], s74 offen offset:3072 sc1 lds
    s_add_u32 s32, s32, 4096
    s_sub_u32 s97, s32, 53248
    s_cmp_ge_u32 s32, 53248
    s_cselect_b32 s32, s97, s32
    s_add_u32 m0, s34, 0
    s_nop 0
    buffer_load_dwordx4 v5, s[12:15], s33 offen offset:0 sc1 lds
    buffer_load_dwordx4 v5, s[12:15], s33 offen offset:1024 sc1 lds
    buffer_load_dwordx4 v5, s[12:15], s33 offen offset:2048 sc1 lds
    buffer_load_dwordx4 v5, s[12:15], s33 offen offset:3072 sc1 lds
    s_add_u32 m0, s34, 4096
    s_nop 0
    buffer_load_dwordx4 v6, s[12:15], s33 offen sc1 lds
    s_add_u32 s33, s33, 20480
    s_sub_u32 s97, s33, 266240
    s_cmp_ge_u32 s33, 266240
    s_cselect_b32 s33, s97, s33
    s_waitcnt vmcnt(14)
    s_barrier
    s_add_u32 m0, s37, 81920
    s_cmp_lt_u32 s32, 20480
    s_cselect_b32 s74, s40, s41
    s_add_u32 s74, s74, s32
    buffer_load_dwordx4 v2, s[8:11], s74 offen offset:0 sc1 lds
    buffer_load_dwordx4 v2, s[8:11], s74 offen offset:1024 sc1 lds
    buffer_load_dwordx4 v2, s[8:11], s74 offen offset:2048 sc1 lds
    buffer_load_dwordx4 v2, s[8:11], s74 offen offset:3072 sc1 lds
    s_add_u32 s32, s32, 4096
    s_sub_u32 s97, s32, 53248
    s_cmp_ge_u32 s32, 53248
    s_cselect_b32 s32, s97, s32
    s_add_u32 m0, s34, 20480
    s_nop 0
    buffer_load_dwordx4 v5, s[12:15], s33 offen offset:0 sc1 lds
    buffer_load_dwordx4 v5, s[12:15], s33 offen offset:1024 sc1 lds
    buffer_load_dwordx4 v5, s[12:15], s33 offen offset:2048 sc1 lds
    buffer_load_dwordx4 v5, s[12:15], s33 offen offset:3072 sc1 lds
    s_add_u32 m0, s34, 24576
    s_nop 0
    buffer_load_dwordx4 v6, s[12:15], s33 offen sc1 lds
    s_add_u32 s33, s33, 20480
    s_sub_u32 s97, s33, 266240
    s_cmp_ge_u32 s33, 266240
    s_cselect_b32 s33, s97, s33
    s_waitcnt vmcnt(14)
    s_barrier
    s_add_u32 m0, s37, 131072
    s_cmp_lt_u32 s32, 20480
    s_cselect_b32 s74, s40, s41
    s_add_u32 s74, s74, s32
    buffer_load_dwordx4 v2, s[8:11], s74 offen offset:0 sc1 lds
    buffer_load_dwordx4 v2, s[8:11], s74 offen offset:1024 sc1 lds
    buffer_load_dwordx4 v2, s[8:11], s74 offen offset:2048 sc1 lds
    buffer_load_dwordx4 v2, s[8:11], s74 offen offset:3072 sc1 lds
    s_add_u32 s32, s32, 4096
    s_sub_u32 s97, s32, 53248
    s_cmp_ge_u32 s32, 53248
    s_cselect_b32 s32, s97, s32
    s_add_u32 m0, s34, 110592
    s_nop 0
    buffer_load_dwordx4 v5, s[12:15], s33 offen offset:0 sc1 lds
    buffer_load_dwordx4 v5, s[12:15], s33 offen offset:1024 sc1 lds
    buffer_load_dwordx4 v5, s[12:15], s33 offen offset:2048 sc1 lds
    buffer_load_dwordx4 v5, s[12:15], s33 offen offset:3072 sc1 lds
    s_add_u32 m0, s34, 114688
    s_nop 0
    buffer_load_dwordx4 v6, s[12:15], s33 offen sc1 lds
    s_add_u32 s33, s33, 20480
    s_sub_u32 s97, s33, 266240
    s_cmp_ge_u32 s33, 266240
    s_cselect_b32 s33, s97, s33
    s_waitcnt vmcnt(14)
    s_barrier
    s_add_u32 m0, s37, 147456
    s_cmp_lt_u32 s32, 20480
    s_cselect_b32 s74, s40, s41
    s_add_u32 s74, s74, s32
    buffer_load_dwordx4 v2, s[8:11], s74 offen offset:0 sc1 lds
    buffer_load_dwordx4 v2, s[8:11], s74 offen offset:1024 sc1 lds
    buffer_load_dwordx4 v2, s[8:11], s74 offen offset:2048 sc1 lds
    buffer_load_dwordx4 v2, s[8:11], s74 offen offset:3072 sc1 lds
    s_add_u32 s32, s32, 4096
    s_sub_u32 s97, s32, 53248
    s_cmp_ge_u32 s32, 53248
    s_cselect_b32 s32, s97, s32
    s_mov_b32 s33, 266240
    s_add_u32 m0, s34, 40960
    s_nop 0
    buffer_load_dwordx4 v5, s[12:15], s33 offen offset:0 sc1 lds
    buffer_load_dwordx4 v5, s[12:15], s33 offen offset:1024 sc1 lds
    buffer_load_dwordx4 v5, s[12:15], s33 offen offset:2048 sc1 lds
    buffer_load_dwordx4 v5, s[12:15], s33 offen offset:3072 sc1 lds
    s_add_u32 m0, s34, 45056
    s_nop 0
    buffer_load_dwordx4 v6, s[12:15], s33 offen sc1 lds
    s_add_u32 s33, s33, 20480
    s_sub_u32 s97, s33, 266240
    s_cmp_ge_u32 s33, 266240
    s_cselect_b32 s33, s97, s33
    s_waitcnt vmcnt(14)
    s_barrier
    s_add_u32 m0, s37, 81920
    s_cmp_lt_u32 s32, 20480
    s_cselect_b32 s74, s40, s41
    s_add_u32 s74, s74, s32
    buffer_load_dwordx4 v2, s[8:11], s74 offen offset:0 sc1 lds
    buffer_load_dwordx4 v2, s[8:11], s74 offen offset:1024 sc1 lds
    buffer_load_dwordx4 v2, s[8:11], s74 offen offset:2048 sc1 lds
    buffer_load_dwordx4 v2, s[8:11], s74 offen offset:3072 sc1 lds
    s_add_u32 s32, s32, 4096
    s_sub_u32 s97, s32, 53248
    s_cmp_ge_u32 s32, 53248
    s_cselect_b32 s32, s97, s32
    s_waitcnt vmcnt(9)
    s_barrier
    s_mov_b32 s32, 53248
    s_add_u32 m0, s37, 131072
    s_cmp_lt_u32 s32, 20480
    s_cselect_b32 s74, s40, s41
    s_add_u32 s74, s74, s32
    buffer_load_dwordx4 v2, s[8:11], s74 offen offset:0 sc1 lds
    buffer_load_dwordx4 v2, s[8:11], s74 offen offset:1024 sc1 lds
    s_add_u32 s32, s32, 4096
    s_sub_u32 s97, s32, 53248
    s_cmp_ge_u32 s32, 53248
    s_cselect_b32 s32, s97, s32
    s_waitcnt vmcnt(2)
    s_barrier
    s_waitcnt vmcnt(0)
    s_barrier
    s_endpgm
L_cons:
    s_nop 7
    s_getpc_b64 s[12:13]
L_pc:
    s_sub_u32 s12, s12, L_pc-sequential_preLN__sliding_local_dilated__swiglu_ffn__prompt_kernel
    s_subb_u32 s13, s13, 0
    s_mov_b32 s14, L_end-sequential_preLN__sliding_local_dilated__swiglu_ffn__prompt_kernel
    s_mov_b32 s15, 0x20000
    s_lshr_b32 s66, s2, 3
    s_mul_i32 s67, s66, 10923
    s_lshr_b32 s67, s67, 16
    s_mul_i32 s67, s67, 6
    s_sub_u32 s66, s66, s67
    s_lshl_b32 s66, s66, 13
    s_cmp_eq_u32 s28, 0
    s_cselect_b32 s66, s66, 0x80000000
    v_lshlrev_b32 v14, 7, v0
    buffer_load_dword v249, v14, s[12:15], s66 offen
    s_lshl_b32 s84, s29, 3
    s_add_u32 s84, s84, s30
    s_lshl_b32 s84, s84, 2
    s_add_u32 s84, s84, s28
    s_lshl_b32 s84, s84, 2
    s_lshl_b32 s31, s29, 2
    s_add_u32 s31, s31, s28
    s_lshl_b32 s85, s31, 3
    s_add_u32 s85, s85, s30
    s_lshl_b32 s85, s85, 2
    s_add_u32 s85, s85, 4096
    s_lshr_b32 s86, s29, 1
    s_lshl_b32 s86, s86, 2
    s_add_u32 s86, s86, s28
    s_lshl_b32 s87, s86, 1
    s_lshl_b32 s86, s86, 4
    s_add_u32 s86, s86, s94
    s_lshl_b32 s86, s86, 2
    s_add_u32 s86, s86, 8192
    v_mov_b32 v15, 0
    s_waitcnt lgkmcnt(0)
    s_add_u32 s24, s64, 20381696
    s_addc_u32 s25, s65, 0
    s_mov_b32 s26, 32768
    s_mov_b32 s27, 0x20000
    s_mov_b32 s12, s90
    s_mov_b32 s13, s91
    s_mov_b32 s14, 256
    s_mov_b32 s15, 0x20000
    s_getreg_b32 s95, hwreg(HW_REG_XCC_ID, 0, 4)
    s_or_b32 s66, s2, s28
    s_cmp_lg_u32 s66, 0
    s_cbranch_scc1 L_nononce
    s_memrealtime s[66:67]
    s_waitcnt lgkmcnt(0)
    s_lshl_b32 s66, s66, 4
    s_or_b32 s66, s66, 0x80000000
    v_mov_b32 v14, s66
    s_mov_b64 exec, 1
    buffer_store_dword v14, v15, s[12:15], 0 offen sc1
    s_mov_b64 exec, -1
L_nononce:
    s_and_b32 s78, s2, 7
    s_lshl_b32 s78, s78, 5
    s_lshr_b32 s79, s2, 3
    s_add_u32 s78, s78, s79
    s_lshl_b32 s78, s78, 2
    s_add_u32 s78, s78, 12288
    s_cmp_eq_u32 s28, 0
    s_cselect_b32 s78, s78, 0x80000000
    s_and_b32 s80, s2, 7
    s_lshl_b32 s80, s80, 3
    s_lshr_b32 s79, s79, 4
    s_lshl_b32 s79, s79, 2
    s_add_u32 s80, s80, s79
    s_lshl_b64 s[80:81], 15, s80
    s_mov_b32 s79, 12288
    v_mov_b32 v228, 0x3f803f80
    v_mov_b32 v229, 0x3f803f80
    v_mov_b32 v230, 0x3f803f80
    v_mov_b32 v231, 0x3f803f80
    v_and_b32 v220, 7, v0
    v_lshlrev_b32 v220, 4, v220
    s_min_u32 s66, s28, 2
    s_mul_i32 s66, s66, 40960
    v_add_u32 v220, s66, v220
    ds_write_b128 v220, v[228:231] offset:30720
    v_and_b32 v220, 15, v0
    v_lshrrev_b32 v221, 4, v0
    v_lshrrev_b32 v222, 1, v220
    v_xor_b32 v222, v222, v221
    v_lshlrev_b32 v222, 4, v222
    v_lshl_add_u32 v222, v220, 7, v222
    v_add_u32 v3, 30720, v222
    v_xor_b32 v4, 64, v3
    s_lshl_b32 s66, s28, 11
    s_add_u32 s66, s66, 2048
    v_add_u32 v5, s66, v3
    v_add_u32 v6, s66, v4
    v_lshlrev_b32 v255, 2, v220
    v_add_u32 v252, 113088, v255
    v_lshlrev_b32 v253, 4, v221
    v_add_u32 v253, 113088, v253
    v_lshlrev_b32 v254, 3, v0
    v_add_u32 v254, 113088, v254
    v_lshrrev_b32 v220, 2, v0
    v_mul_u32_u24 v220, 480, v220
    v_and_b32 v221, 3, v0
    s_mul_i32 s66, s28, 40
    v_lshl_add_u32 v222, v221, 3, v220
    v_add_u32 v7, s66, v222
    v_mul_u32_u24 v221, 40, v221
    v_add3_u32 v8, v220, v221, 32
    s_mov_b32 s68, 0xf149f2ca
    v_and_b32 v220, 15, v0
    v_lshrrev_b32 v221, 4, v0
    v_lshlrev_b32 v221, 2, v221
    v_sub_u32 v220, v221, v220
    v_mov_b32 v223, s68
    s_cmp_eq_u32 s29, 0
    s_cselect_b64 s[72:73], -1, 0
    v_add_u32 v221, 0, v220
    v_and_b32 v222, 0x80000001, v221
    v_cmp_eq_u32 vcc, 0, v222
    v_cmp_ne_u32 s[76:77], 0, v221
    s_nop 0
    s_and_b64 s[76:77], s[76:77], vcc
    v_cndmask_b32 v20, v223, 0, s[76:77]
    v_and_b32 v222, 1, v221
    v_cmp_eq_u32 vcc, 0, v222
    s_nop 0
    s_andn2_b64 s[76:77], vcc, s[76:77]
    v_cndmask_b32 v16, v223, 0, s[76:77]
    v_cndmask_b32 v24, v20, v223, s[72:73]
    v_add_u32 v221, 1, v220
    v_and_b32 v222, 0x80000001, v221
    v_cmp_eq_u32 vcc, 0, v222
    v_cmp_ne_u32 s[76:77], 0, v221
    s_nop 0
    s_and_b64 s[76:77], s[76:77], vcc
    v_cndmask_b32 v21, v223, 0, s[76:77]
    v_and_b32 v222, 1, v221
    v_cmp_eq_u32 vcc, 0, v222
    s_nop 0
    s_andn2_b64 s[76:77], vcc, s[76:77]
    v_cndmask_b32 v17, v223, 0, s[76:77]
    v_cndmask_b32 v25, v21, v223, s[72:73]
    v_add_u32 v221, 2, v220
    v_and_b32 v222, 0x80000001, v221
    v_cmp_eq_u32 vcc, 0, v222
    v_cmp_ne_u32 s[76:77], 0, v221
    s_nop 0
    s_and_b64 s[76:77], s[76:77], vcc
    v_cndmask_b32 v22, v223, 0, s[76:77]
    v_and_b32 v222, 1, v221
    v_cmp_eq_u32 vcc, 0, v222
    s_nop 0
    s_andn2_b64 s[76:77], vcc, s[76:77]
    v_cndmask_b32 v18, v223, 0, s[76:77]
    v_cndmask_b32 v26, v22, v223, s[72:73]
    v_add_u32 v221, 3, v220
    v_and_b32 v222, 0x80000001, v221
    v_cmp_eq_u32 vcc, 0, v222
    v_cmp_ne_u32 s[76:77], 0, v221
    s_nop 0
    s_and_b64 s[76:77], s[76:77], vcc
    v_cndmask_b32 v23, v223, 0, s[76:77]
    v_and_b32 v222, 1, v221
    v_cmp_eq_u32 vcc, 0, v222
    s_nop 0
    s_andn2_b64 s[76:77], vcc, s[76:77]
    v_cndmask_b32 v19, v223, 0, s[76:77]
    v_cndmask_b32 v27, v23, v223, s[72:73]
    s_lshl_b32 s68, s28, 4
    s_lshl_b64 s[70:71], 0xffff, s68
    s_mul_i32 s66, s29, 81920
    s_add_u32 s66, s66, 7667712
    s_add_u32 s8, s64, s66
    s_addc_u32 s9, s65, 0
    s_mov_b32 s10, 81920
    s_mov_b32 s11, 0x20000
    s_lshr_b32 s66, s28, 1
    s_lshl_b32 s67, s30, 1
    s_add_u32 s66, s66, s67
    s_lshl_b32 s66, s66, 10
    s_and_b32 s67, s28, 1
    s_lshl_b32 s67, s67, 9
    s_add_u32 s66, s66, s67
    s_lshr_b32 s67, s30, 1
    s_lshl_b32 s67, s67, 10
    s_and_b32 s68, s30, 1
    s_lshl_b32 s68, s68, 3
    s_add_u32 s67, s67, s68
    s_add_u32 s67, s67, 16384
    s_mov_b32 s68, 0x3ea52b5c
    s_mov_b32 s69, s68
    s_lshl_b32 s72, s28, 9
    s_lshl_b32 s75, s28, 7
    s_add_u32 s75, s75, 128
    s_mov_b32 s76, 0x3acccccd
    s_mov_b32 s77, 0x3727c5ac
    s_mov_b32 s40, 0x00f0000f
    s_mov_b32 s41, 0xf0000f00
    s_mov_b32 s42, 0xaaaaaaaa
    s_mov_b32 s43, 0xaaaaaaaa
    s_mov_b32 s44, 0xcccccccc
    s_mov_b32 s45, 0xcccccccc
    s_mov_b64 s[46:47], 0xffff
    v_add_u32 v9, 0, v3
    v_add_u32 v10, 0, v4
    v_add_u32 v11, 0, v5
    v_add_u32 v12, 0, v6
    v_add_u32 v13, 0, v7
    v_add_u32 v14, 0, v8
    s_waitcnt lgkmcnt(0)
    s_barrier
    ds_read_b64_tr_b16 v[148:149], v13 offset:0
    ds_read_b64_tr_b16 v[150:151], v13 offset:7680
    ds_read_b128 v[124:127], v9 offset:0
    ds_read_b128 v[128:131], v9 offset:2048
    ds_read_b128 v[132:135], v9 offset:4096
    ds_read_b128 v[136:139], v9 offset:6144
    ds_read_b128 v[140:143], v9 offset:8192
    ds_read_b64_tr_b16 v[152:153], v13 offset:160
    ds_read_b64_tr_b16 v[154:155], v13 offset:7840
    ds_read_b64_tr_b16 v[156:157], v13 offset:320
    ds_read_b64_tr_b16 v[158:159], v13 offset:8000
    ds_read_b128 v[144:147], v11
    ds_read_b64_tr_b16 v[160:161], v14 offset:0
    ds_read_b64_tr_b16 v[162:163], v14 offset:7680
    ds_read_b64_tr_b16 v[164:165], v14 offset:160
    ds_read_b64_tr_b16 v[166:167], v14 offset:7840
    ds_read_b64_tr_b16 v[168:169], v14 offset:320
    ds_read_b64_tr_b16 v[170:171], v14 offset:8000
    s_waitcnt lgkmcnt(15)
    v_mfma_f32_16x16x32_bf16 v[28:31], v[148:151], v[124:127], 0
    ds_read_b64_tr_b16 v[196:197], v13 offset:15360
    s_waitcnt lgkmcnt(15)
    v_mfma_f32_16x16x32_bf16 v[32:35], v[148:151], v[128:131], 0
    ds_read_b64_tr_b16 v[198:199], v13 offset:23040
    s_waitcnt lgkmcnt(15)
    v_mfma_f32_16x16x32_bf16 v[36:39], v[148:151], v[132:135], 0
    ds_read_b128 v[172:175], v10 offset:0
    s_waitcnt lgkmcnt(15)
    v_mfma_f32_16x16x32_bf16 v[40:43], v[148:151], v[136:139], 0
    ds_read_b128 v[176:179], v10 offset:2048
    s_waitcnt lgkmcnt(15)
    v_mfma_f32_16x16x32_bf16 v[44:47], v[148:151], v[140:143], 0
    ds_read_b128 v[180:183], v10 offset:4096
    s_waitcnt lgkmcnt(14)
    v_mfma_f32_16x16x32_bf16 v[48:51], v[152:155], v[124:127], 0
    ds_read_b128 v[184:187], v10 offset:6144
    v_mfma_f32_16x16x32_bf16 v[52:55], v[152:155], v[128:131], 0
    ds_read_b128 v[188:191], v10 offset:8192
    v_mfma_f32_16x16x32_bf16 v[56:59], v[152:155], v[132:135], 0
    ds_read_b64_tr_b16 v[200:201], v13 offset:15520
    v_mfma_f32_16x16x32_bf16 v[60:63], v[152:155], v[136:139], 0
    ds_read_b64_tr_b16 v[202:203], v13 offset:23200
    v_mfma_f32_16x16x32_bf16 v[64:67], v[152:155], v[140:143], 0
    ds_read_b64_tr_b16 v[204:205], v13 offset:15680
    s_waitcnt lgkmcnt(15)
    v_mfma_f32_16x16x32_bf16 v[68:71], v[124:127], v[156:159], 0
    ds_read_b64_tr_b16 v[206:207], v13 offset:23360
    v_mfma_f32_16x16x32_bf16 v[72:75], v[128:131], v[156:159], 0
    ds_read_b128 v[192:195], v12
    v_mfma_f32_16x16x32_bf16 v[76:79], v[132:135], v[156:159], 0
    ds_read_b64_tr_b16 v[208:209], v14 offset:15360
    v_mfma_f32_16x16x32_bf16 v[80:83], v[136:139], v[156:159], 0
    ds_read_b64_tr_b16 v[210:211], v14 offset:23040
    v_mfma_f32_16x16x32_bf16 v[84:87], v[140:143], v[156:159], 0
    ds_read_b64_tr_b16 v[212:213], v14 offset:15520
    v_mfma_f32_16x16x32_bf16 v[112:115], v[124:127], v[124:127], 0
    ds_read_b64_tr_b16 v[214:215], v14 offset:23200
    v_mfma_f32_16x16x32_bf16 v[116:119], v[144:147], v[144:147], 0
    ds_read_b64_tr_b16 v[216:217], v14 offset:15680
    v_mfma_f32_16x16x32_bf16 v[120:123], v[124:127], v[144:147], 0
    ds_read_b64_tr_b16 v[218:219], v14 offset:23360
    s_waitcnt lgkmcnt(15)
    v_mfma_f32_16x16x32_bf16 v[88:91], v[160:163], v[144:147], 0
    v_mfma_f32_16x16x32_bf16 v[100:103], v[160:163], v[124:127], 0
    v_mfma_f32_16x16x32_bf16 v[92:95], v[164:167], v[144:147], 0
    v_mfma_f32_16x16x32_bf16 v[104:107], v[164:167], v[124:127], 0
    v_mfma_f32_16x16x32_bf16 v[96:99], v[144:147], v[168:171], 0
    v_mfma_f32_16x16x32_bf16 v[108:111], v[124:127], v[168:171], 0
    v_mfma_f32_16x16x32_bf16 v[28:31], v[196:199], v[172:175], v[28:31]
    s_waitcnt lgkmcnt(14)
    v_mfma_f32_16x16x32_bf16 v[32:35], v[196:199], v[176:179], v[32:35]
    s_waitcnt lgkmcnt(13)
    v_mfma_f32_16x16x32_bf16 v[36:39], v[196:199], v[180:183], v[36:39]
    s_waitcnt lgkmcnt(0)
    s_barrier
    v_add_u32 v9, 40960, v3
    v_add_u32 v10, 40960, v4
    v_add_u32 v11, 40960, v5
    v_add_u32 v12, 40960, v6
    v_add_u32 v13, 40960, v7
    v_add_u32 v14, 40960, v8
    buffer_load_dword v248, v15, s[12:15], 0 offen sc1
    v_mfma_f32_16x16x32_bf16 v[40:43], v[196:199], v[184:187], v[40:43]
    ds_read_b64_tr_b16 v[148:149], v13 offset:0
    v_mfma_f32_16x16x32_bf16 v[44:47], v[196:199], v[188:191], v[44:47]
    ds_read_b64_tr_b16 v[150:151], v13 offset:7680
    v_mfma_f32_16x16x32_bf16 v[48:51], v[200:203], v[172:175], v[48:51]
    ds_read_b128 v[124:127], v9 offset:0
    v_mfma_f32_16x16x32_bf16 v[52:55], v[200:203], v[176:179], v[52:55]
    ds_read_b128 v[128:131], v9 offset:2048
    v_mfma_f32_16x16x32_bf16 v[56:59], v[200:203], v[180:183], v[56:59]
    ds_read_b128 v[132:135], v9 offset:4096
    v_mfma_f32_16x16x32_bf16 v[60:63], v[200:203], v[184:187], v[60:63]
    ds_read_b128 v[136:139], v9 offset:6144
    v_mfma_f32_16x16x32_bf16 v[64:67], v[200:203], v[188:191], v[64:67]
    ds_read_b128 v[140:143], v9 offset:8192
    v_mfma_f32_16x16x32_bf16 v[68:71], v[172:175], v[204:207], v[68:71]
    ds_read_b64_tr_b16 v[152:153], v13 offset:160
    v_mfma_f32_16x16x32_bf16 v[72:75], v[176:179], v[204:207], v[72:75]
    ds_read_b64_tr_b16 v[154:155], v13 offset:7840
    v_mfma_f32_16x16x32_bf16 v[76:79], v[180:183], v[204:207], v[76:79]
    ds_read_b64_tr_b16 v[156:157], v13 offset:320
    v_mfma_f32_16x16x32_bf16 v[80:83], v[184:187], v[204:207], v[80:83]
    ds_read_b64_tr_b16 v[158:159], v13 offset:8000
    v_mfma_f32_16x16x32_bf16 v[84:87], v[188:191], v[204:207], v[84:87]
    ds_read_b128 v[144:147], v11
    v_mfma_f32_16x16x32_bf16 v[112:115], v[172:175], v[172:175], v[112:115]
    ds_read_b64_tr_b16 v[160:161], v14 offset:0
    v_mfma_f32_16x16x32_bf16 v[116:119], v[192:195], v[192:195], v[116:119]
    ds_read_b64_tr_b16 v[162:163], v14 offset:7680
    v_mfma_f32_16x16x32_bf16 v[120:123], v[172:175], v[192:195], v[120:123]
    ds_read_b64_tr_b16 v[164:165], v14 offset:160
    v_mfma_f32_16x16x32_bf16 v[88:91], v[208:211], v[192:195], v[88:91]
    ds_read_b64_tr_b16 v[166:167], v14 offset:7840
    v_mfma_f32_16x16x32_bf16 v[100:103], v[208:211], v[172:175], v[100:103]
    ds_read_b64_tr_b16 v[168:169], v14 offset:320
    v_mfma_f32_16x16x32_bf16 v[92:95], v[212:215], v[192:195], v[92:95]
    ds_read_b64_tr_b16 v[170:171], v14 offset:8000
    v_mfma_f32_16x16x32_bf16 v[104:107], v[212:215], v[172:175], v[104:107]
    v_mfma_f32_16x16x32_bf16 v[96:99], v[192:195], v[216:219], v[96:99]
    v_mfma_f32_16x16x32_bf16 v[108:111], v[172:175], v[216:219], v[108:111]
    s_waitcnt lgkmcnt(15)
    v_mfma_f32_16x16x32_bf16 v[28:31], v[148:151], v[124:127], v[28:31]
    ds_read_b64_tr_b16 v[196:197], v13 offset:15360
    s_waitcnt lgkmcnt(15)
    v_mfma_f32_16x16x32_bf16 v[32:35], v[148:151], v[128:131], v[32:35]
    ds_read_b64_tr_b16 v[198:199], v13 offset:23040
    s_waitcnt lgkmcnt(15)
    v_mfma_f32_16x16x32_bf16 v[36:39], v[148:151], v[132:135], v[36:39]
    ds_read_b128 v[172:175], v10 offset:0
    s_waitcnt lgkmcnt(15)
    v_mfma_f32_16x16x32_bf16 v[40:43], v[148:151], v[136:139], v[40:43]
    ds_read_b128 v[176:179], v10 offset:2048
    s_waitcnt lgkmcnt(15)
    v_mfma_f32_16x16x32_bf16 v[44:47], v[148:151], v[140:143], v[44:47]
    ds_read_b128 v[180:183], v10 offset:4096
    s_waitcnt lgkmcnt(14)
    v_mfma_f32_16x16x32_bf16 v[48:51], v[152:155], v[124:127], v[48:51]
    ds_read_b128 v[184:187], v10 offset:6144
    v_mfma_f32_16x16x32_bf16 v[52:55], v[152:155], v[128:131], v[52:55]
    ds_read_b128 v[188:191], v10 offset:8192
    v_mfma_f32_16x16x32_bf16 v[56:59], v[152:155], v[132:135], v[56:59]
    ds_read_b64_tr_b16 v[200:201], v13 offset:15520
    v_mfma_f32_16x16x32_bf16 v[60:63], v[152:155], v[136:139], v[60:63]
    ds_read_b64_tr_b16 v[202:203], v13 offset:23200
    v_mfma_f32_16x16x32_bf16 v[64:67], v[152:155], v[140:143], v[64:67]
    ds_read_b64_tr_b16 v[204:205], v13 offset:15680
    s_waitcnt lgkmcnt(15)
    v_mfma_f32_16x16x32_bf16 v[68:71], v[124:127], v[156:159], v[68:71]
    ds_read_b64_tr_b16 v[206:207], v13 offset:23360
    v_mfma_f32_16x16x32_bf16 v[72:75], v[128:131], v[156:159], v[72:75]
    ds_read_b128 v[192:195], v12
    v_mfma_f32_16x16x32_bf16 v[76:79], v[132:135], v[156:159], v[76:79]
    ds_read_b64_tr_b16 v[208:209], v14 offset:15360
    v_mfma_f32_16x16x32_bf16 v[80:83], v[136:139], v[156:159], v[80:83]
    ds_read_b64_tr_b16 v[210:211], v14 offset:23040
    v_mfma_f32_16x16x32_bf16 v[84:87], v[140:143], v[156:159], v[84:87]
    ds_read_b64_tr_b16 v[212:213], v14 offset:15520
    v_mfma_f32_16x16x32_bf16 v[112:115], v[124:127], v[124:127], v[112:115]
    ds_read_b64_tr_b16 v[214:215], v14 offset:23200
    v_mfma_f32_16x16x32_bf16 v[116:119], v[144:147], v[144:147], v[116:119]
    ds_read_b64_tr_b16 v[216:217], v14 offset:15680
    v_mfma_f32_16x16x32_bf16 v[120:123], v[124:127], v[144:147], v[120:123]
    ds_read_b64_tr_b16 v[218:219], v14 offset:23360
    s_waitcnt lgkmcnt(15)
    v_mfma_f32_16x16x32_bf16 v[88:91], v[160:163], v[144:147], v[88:91]
    v_mfma_f32_16x16x32_bf16 v[100:103], v[160:163], v[124:127], v[100:103]
    v_mfma_f32_16x16x32_bf16 v[92:95], v[164:167], v[144:147], v[92:95]
    v_mfma_f32_16x16x32_bf16 v[104:107], v[164:167], v[124:127], v[104:107]
    v_mfma_f32_16x16x32_bf16 v[96:99], v[144:147], v[168:171], v[96:99]
    v_mfma_f32_16x16x32_bf16 v[108:111], v[124:127], v[168:171], v[108:111]
    v_mfma_f32_16x16x32_bf16 v[28:31], v[196:199], v[172:175], v[28:31]
    s_waitcnt lgkmcnt(14)
    v_mfma_f32_16x16x32_bf16 v[32:35], v[196:199], v[176:179], v[32:35]
    s_waitcnt lgkmcnt(13)
    v_mfma_f32_16x16x32_bf16 v[36:39], v[196:199], v[180:183], v[36:39]
    s_waitcnt lgkmcnt(0)
    s_barrier
    v_add_u32 v9, 81920, v3
    v_add_u32 v10, 81920, v4
    v_add_u32 v11, 81920, v5
    v_add_u32 v12, 81920, v6
    v_add_u32 v13, 81920, v7
    v_add_u32 v14, 81920, v8
    v_mfma_f32_16x16x32_bf16 v[40:43], v[196:199], v[184:187], v[40:43]
    ds_read_b64_tr_b16 v[148:149], v13 offset:0
    v_mfma_f32_16x16x32_bf16 v[44:47], v[196:199], v[188:191], v[44:47]
    ds_read_b64_tr_b16 v[150:151], v13 offset:7680
    v_mfma_f32_16x16x32_bf16 v[48:51], v[200:203], v[172:175], v[48:51]
    ds_read_b128 v[124:127], v9 offset:0
    v_mfma_f32_16x16x32_bf16 v[52:55], v[200:203], v[176:179], v[52:55]
    ds_read_b128 v[128:131], v9 offset:2048
    v_mfma_f32_16x16x32_bf16 v[56:59], v[200:203], v[180:183], v[56:59]
    ds_read_b128 v[132:135], v9 offset:4096
    v_mfma_f32_16x16x32_bf16 v[60:63], v[200:203], v[184:187], v[60:63]
    ds_read_b128 v[136:139], v9 offset:6144
    v_mfma_f32_16x16x32_bf16 v[64:67], v[200:203], v[188:191], v[64:67]
    ds_read_b128 v[140:143], v9 offset:8192
    v_mfma_f32_16x16x32_bf16 v[68:71], v[172:175], v[204:207], v[68:71]
    ds_read_b64_tr_b16 v[152:153], v13 offset:160
    v_mfma_f32_16x16x32_bf16 v[72:75], v[176:179], v[204:207], v[72:75]
    ds_read_b64_tr_b16 v[154:155], v13 offset:7840
    v_mfma_f32_16x16x32_bf16 v[76:79], v[180:183], v[204:207], v[76:79]
    ds_read_b64_tr_b16 v[156:157], v13 offset:320
    v_mfma_f32_16x16x32_bf16 v[80:83], v[184:187], v[204:207], v[80:83]
    ds_read_b64_tr_b16 v[158:159], v13 offset:8000
    v_mfma_f32_16x16x32_bf16 v[84:87], v[188:191], v[204:207], v[84:87]
    ds_read_b128 v[144:147], v11
    v_mfma_f32_16x16x32_bf16 v[112:115], v[172:175], v[172:175], v[112:115]
    ds_read_b64_tr_b16 v[160:161], v14 offset:0
    v_mfma_f32_16x16x32_bf16 v[116:119], v[192:195], v[192:195], v[116:119]
    ds_read_b64_tr_b16 v[162:163], v14 offset:7680
    v_mfma_f32_16x16x32_bf16 v[120:123], v[172:175], v[192:195], v[120:123]
    ds_read_b64_tr_b16 v[164:165], v14 offset:160
    v_mfma_f32_16x16x32_bf16 v[88:91], v[208:211], v[192:195], v[88:91]
    ds_read_b64_tr_b16 v[166:167], v14 offset:7840
    v_mfma_f32_16x16x32_bf16 v[100:103], v[208:211], v[172:175], v[100:103]
    ds_read_b64_tr_b16 v[168:169], v14 offset:320
    v_mfma_f32_16x16x32_bf16 v[92:95], v[212:215], v[192:195], v[92:95]
    ds_read_b64_tr_b16 v[170:171], v14 offset:8000
    v_mfma_f32_16x16x32_bf16 v[104:107], v[212:215], v[172:175], v[104:107]
    v_mfma_f32_16x16x32_bf16 v[96:99], v[192:195], v[216:219], v[96:99]
    v_mfma_f32_16x16x32_bf16 v[108:111], v[172:175], v[216:219], v[108:111]
    s_waitcnt lgkmcnt(15)
    v_mfma_f32_16x16x32_bf16 v[28:31], v[148:151], v[124:127], v[28:31]
    ds_read_b64_tr_b16 v[196:197], v13 offset:15360
    s_waitcnt lgkmcnt(15)
    v_mfma_f32_16x16x32_bf16 v[32:35], v[148:151], v[128:131], v[32:35]
    ds_read_b64_tr_b16 v[198:199], v13 offset:23040
    s_waitcnt lgkmcnt(15)
    v_mfma_f32_16x16x32_bf16 v[36:39], v[148:151], v[132:135], v[36:39]
    ds_read_b128 v[172:175], v10 offset:0
    s_waitcnt lgkmcnt(15)
    v_mfma_f32_16x16x32_bf16 v[40:43], v[148:151], v[136:139], v[40:43]
    ds_read_b128 v[176:179], v10 offset:2048
    s_waitcnt lgkmcnt(15)
    v_mfma_f32_16x16x32_bf16 v[44:47], v[148:151], v[140:143], v[44:47]
    ds_read_b128 v[180:183], v10 offset:4096
    s_waitcnt lgkmcnt(14)
    v_mfma_f32_16x16x32_bf16 v[48:51], v[152:155], v[124:127], v[48:51]
    ds_read_b128 v[184:187], v10 offset:6144
    v_mfma_f32_16x16x32_bf16 v[52:55], v[152:155], v[128:131], v[52:55]
    ds_read_b128 v[188:191], v10 offset:8192
    v_mfma_f32_16x16x32_bf16 v[56:59], v[152:155], v[132:135], v[56:59]
    ds_read_b64_tr_b16 v[200:201], v13 offset:15520
    v_mfma_f32_16x16x32_bf16 v[60:63], v[152:155], v[136:139], v[60:63]
    ds_read_b64_tr_b16 v[202:203], v13 offset:23200
    v_mfma_f32_16x16x32_bf16 v[64:67], v[152:155], v[140:143], v[64:67]
    ds_read_b64_tr_b16 v[204:205], v13 offset:15680
    s_waitcnt lgkmcnt(15)
    v_mfma_f32_16x16x32_bf16 v[68:71], v[124:127], v[156:159], v[68:71]
    ds_read_b64_tr_b16 v[206:207], v13 offset:23360
    v_mfma_f32_16x16x32_bf16 v[72:75], v[128:131], v[156:159], v[72:75]
    ds_read_b128 v[192:195], v12
    v_mfma_f32_16x16x32_bf16 v[76:79], v[132:135], v[156:159], v[76:79]
    ds_read_b64_tr_b16 v[208:209], v14 offset:15360
    v_mfma_f32_16x16x32_bf16 v[80:83], v[136:139], v[156:159], v[80:83]
    ds_read_b64_tr_b16 v[210:211], v14 offset:23040
    v_mfma_f32_16x16x32_bf16 v[84:87], v[140:143], v[156:159], v[84:87]
    ds_read_b64_tr_b16 v[212:213], v14 offset:15520
    v_mfma_f32_16x16x32_bf16 v[112:115], v[124:127], v[124:127], v[112:115]
    ds_read_b64_tr_b16 v[214:215], v14 offset:23200
    v_mfma_f32_16x16x32_bf16 v[116:119], v[144:147], v[144:147], v[116:119]
    ds_read_b64_tr_b16 v[216:217], v14 offset:15680
    v_mfma_f32_16x16x32_bf16 v[120:123], v[124:127], v[144:147], v[120:123]
    ds_read_b64_tr_b16 v[218:219], v14 offset:23360
    s_waitcnt lgkmcnt(15)
    v_mfma_f32_16x16x32_bf16 v[88:91], v[160:163], v[144:147], v[88:91]
    v_mfma_f32_16x16x32_bf16 v[100:103], v[160:163], v[124:127], v[100:103]
    v_mfma_f32_16x16x32_bf16 v[92:95], v[164:167], v[144:147], v[92:95]
    v_mfma_f32_16x16x32_bf16 v[104:107], v[164:167], v[124:127], v[104:107]
    v_mfma_f32_16x16x32_bf16 v[96:99], v[144:147], v[168:171], v[96:99]
    v_mfma_f32_16x16x32_bf16 v[108:111], v[124:127], v[168:171], v[108:111]
    v_mfma_f32_16x16x32_bf16 v[28:31], v[196:199], v[172:175], v[28:31]
    s_waitcnt lgkmcnt(14)
    v_mfma_f32_16x16x32_bf16 v[32:35], v[196:199], v[176:179], v[32:35]
    s_waitcnt lgkmcnt(13)
    v_mfma_f32_16x16x32_bf16 v[36:39], v[196:199], v[180:183], v[36:39]
    s_waitcnt lgkmcnt(0)
    s_barrier
    v_add_u32 v9, 0, v3
    v_add_u32 v10, 0, v4
    v_add_u32 v11, 0, v5
    v_add_u32 v12, 0, v6
    v_add_u32 v13, 0, v7
    v_add_u32 v14, 0, v8
    s_mov_b32 s96, 0
L_nonce:
    s_waitcnt vmcnt(0)
    v_readfirstlane_b32 s93, v248
    s_add_u32 s96, s96, 1
    s_cmp_lg_u32 s93, 0
    s_cbranch_scc1 L_nonce_ok
    s_cmp_lt_u32 s96, 200000
    s_cbranch_scc0 L_end
    buffer_load_dword v248, v15, s[12:15], 0 offen sc1
    s_branch L_nonce
L_nonce_ok:
    s_or_b32 s97, s93, s95
    s_waitcnt vmcnt(0)
    v_mov_b32 v248, s97
    s_mov_b64 exec, 1
    buffer_store_dword v248, v15, s[24:27], s78 offen sc1
    s_mov_b64 exec, -1
    v_mfma_f32_16x16x32_bf16 v[40:43], v[196:199], v[184:187], v[40:43]
    ds_read_b64_tr_b16 v[148:149], v13 offset:0
    v_mfma_f32_16x16x32_bf16 v[44:47], v[196:199], v[188:191], v[44:47]
    ds_read_b64_tr_b16 v[150:151], v13 offset:7680
    v_mfma_f32_16x16x32_bf16 v[48:51], v[200:203], v[172:175], v[48:51]
    ds_read_b128 v[124:127], v9 offset:0
    v_mfma_f32_16x16x32_bf16 v[52:55], v[200:203], v[176:179], v[52:55]
    ds_read_b128 v[128:131], v9 offset:2048
    v_mfma_f32_16x16x32_bf16 v[56:59], v[200:203], v[180:183], v[56:59]
    ds_read_b128 v[132:135], v9 offset:4096
    v_mfma_f32_16x16x32_bf16 v[60:63], v[200:203], v[184:187], v[60:63]
    ds_read_b128 v[136:139], v9 offset:6144
    v_mfma_f32_16x16x32_bf16 v[64:67], v[200:203], v[188:191], v[64:67]
    ds_read_b128 v[140:143], v9 offset:8192
    v_mfma_f32_16x16x32_bf16 v[68:71], v[172:175], v[204:207], v[68:71]
    ds_read_b64_tr_b16 v[152:153], v13 offset:160
    v_mfma_f32_16x16x32_bf16 v[72:75], v[176:179], v[204:207], v[72:75]
    ds_read_b64_tr_b16 v[154:155], v13 offset:7840
    v_mfma_f32_16x16x32_bf16 v[76:79], v[180:183], v[204:207], v[76:79]
    ds_read_b64_tr_b16 v[156:157], v13 offset:320
    v_mfma_f32_16x16x32_bf16 v[80:83], v[184:187], v[204:207], v[80:83]
    ds_read_b64_tr_b16 v[158:159], v13 offset:8000
    v_mfma_f32_16x16x32_bf16 v[84:87], v[188:191], v[204:207], v[84:87]
    ds_read_b128 v[144:147], v11
    v_mfma_f32_16x16x32_bf16 v[112:115], v[172:175], v[172:175], v[112:115]
    ds_read_b64_tr_b16 v[160:161], v14 offset:0
    v_mfma_f32_16x16x32_bf16 v[116:119], v[192:195], v[192:195], v[116:119]
    ds_read_b64_tr_b16 v[162:163], v14 offset:7680
    v_mfma_f32_16x16x32_bf16 v[120:123], v[172:175], v[192:195], v[120:123]
    ds_read_b64_tr_b16 v[164:165], v14 offset:160
    v_mfma_f32_16x16x32_bf16 v[88:91], v[208:211], v[192:195], v[88:91]
    ds_read_b64_tr_b16 v[166:167], v14 offset:7840
    v_mfma_f32_16x16x32_bf16 v[100:103], v[208:211], v[172:175], v[100:103]
    ds_read_b64_tr_b16 v[168:169], v14 offset:320
    v_mfma_f32_16x16x32_bf16 v[92:95], v[212:215], v[192:195], v[92:95]
    ds_read_b64_tr_b16 v[170:171], v14 offset:8000
    v_mfma_f32_16x16x32_bf16 v[104:107], v[212:215], v[172:175], v[104:107]
    v_mfma_f32_16x16x32_bf16 v[96:99], v[192:195], v[216:219], v[96:99]
    v_mfma_f32_16x16x32_bf16 v[108:111], v[172:175], v[216:219], v[108:111]
    s_waitcnt lgkmcnt(15)
    v_mfma_f32_16x16x32_bf16 v[28:31], v[148:151], v[124:127], v[28:31]
    ds_read_b64_tr_b16 v[196:197], v13 offset:15360
    s_waitcnt lgkmcnt(15)
    v_mfma_f32_16x16x32_bf16 v[32:35], v[148:151], v[128:131], v[32:35]
    ds_read_b64_tr_b16 v[198:199], v13 offset:23040
    s_waitcnt lgkmcnt(15)
    v_mfma_f32_16x16x32_bf16 v[36:39], v[148:151], v[132:135], v[36:39]
    ds_read_b128 v[172:175], v10 offset:0
    s_waitcnt lgkmcnt(15)
    v_mfma_f32_16x16x32_bf16 v[40:43], v[148:151], v[136:139], v[40:43]
    ds_read_b128 v[176:179], v10 offset:2048
    s_waitcnt lgkmcnt(15)
    v_mfma_f32_16x16x32_bf16 v[44:47], v[148:151], v[140:143], v[44:47]
    ds_read_b128 v[180:183], v10 offset:4096
    s_waitcnt lgkmcnt(14)
    v_mfma_f32_16x16x32_bf16 v[48:51], v[152:155], v[124:127], v[48:51]
    ds_read_b128 v[184:187], v10 offset:6144
    v_mfma_f32_16x16x32_bf16 v[52:55], v[152:155], v[128:131], v[52:55]
    ds_read_b128 v[188:191], v10 offset:8192
    v_mfma_f32_16x16x32_bf16 v[56:59], v[152:155], v[132:135], v[56:59]
    ds_read_b64_tr_b16 v[200:201], v13 offset:15520
    v_mfma_f32_16x16x32_bf16 v[60:63], v[152:155], v[136:139], v[60:63]
    ds_read_b64_tr_b16 v[202:203], v13 offset:23200
    v_mfma_f32_16x16x32_bf16 v[64:67], v[152:155], v[140:143], v[64:67]
    ds_read_b64_tr_b16 v[204:205], v13 offset:15680
    s_waitcnt lgkmcnt(15)
    v_mfma_f32_16x16x32_bf16 v[68:71], v[124:127], v[156:159], v[68:71]
    ds_read_b64_tr_b16 v[206:207], v13 offset:23360
    v_mfma_f32_16x16x32_bf16 v[72:75], v[128:131], v[156:159], v[72:75]
    ds_read_b128 v[192:195], v12
    v_mfma_f32_16x16x32_bf16 v[76:79], v[132:135], v[156:159], v[76:79]
    ds_read_b64_tr_b16 v[208:209], v14 offset:15360
    v_mfma_f32_16x16x32_bf16 v[80:83], v[136:139], v[156:159], v[80:83]
    ds_read_b64_tr_b16 v[210:211], v14 offset:23040
    v_mfma_f32_16x16x32_bf16 v[84:87], v[140:143], v[156:159], v[84:87]
    ds_read_b64_tr_b16 v[212:213], v14 offset:15520
    v_mfma_f32_16x16x32_bf16 v[112:115], v[124:127], v[124:127], v[112:115]
    ds_read_b64_tr_b16 v[214:215], v14 offset:23200
    v_mfma_f32_16x16x32_bf16 v[116:119], v[144:147], v[144:147], v[116:119]
    ds_read_b64_tr_b16 v[216:217], v14 offset:15680
    v_mfma_f32_16x16x32_bf16 v[120:123], v[124:127], v[144:147], v[120:123]
    ds_read_b64_tr_b16 v[218:219], v14 offset:23360
    s_waitcnt lgkmcnt(15)
    v_mfma_f32_16x16x32_bf16 v[88:91], v[160:163], v[144:147], v[88:91]
    v_mfma_f32_16x16x32_bf16 v[100:103], v[160:163], v[124:127], v[100:103]
    v_mfma_f32_16x16x32_bf16 v[92:95], v[164:167], v[144:147], v[92:95]
    v_mfma_f32_16x16x32_bf16 v[104:107], v[164:167], v[124:127], v[104:107]
    v_mfma_f32_16x16x32_bf16 v[96:99], v[144:147], v[168:171], v[96:99]
    v_mfma_f32_16x16x32_bf16 v[108:111], v[124:127], v[168:171], v[108:111]
    v_mfma_f32_16x16x32_bf16 v[28:31], v[196:199], v[172:175], v[28:31]
    s_waitcnt lgkmcnt(14)
    v_mfma_f32_16x16x32_bf16 v[32:35], v[196:199], v[176:179], v[32:35]
    s_waitcnt lgkmcnt(13)
    v_mfma_f32_16x16x32_bf16 v[36:39], v[196:199], v[180:183], v[36:39]
    s_waitcnt lgkmcnt(0)
    s_barrier
    v_add_u32 v9, 40960, v3
    v_add_u32 v10, 40960, v4
    v_add_u32 v11, 40960, v5
    v_add_u32 v12, 40960, v6
    v_add_u32 v13, 40960, v7
    v_add_u32 v14, 40960, v8
    v_mfma_f32_16x16x32_bf16 v[40:43], v[196:199], v[184:187], v[40:43]
    ds_read_b64_tr_b16 v[148:149], v13 offset:0
    v_mfma_f32_16x16x32_bf16 v[44:47], v[196:199], v[188:191], v[44:47]
    ds_read_b64_tr_b16 v[150:151], v13 offset:7680
    v_mfma_f32_16x16x32_bf16 v[48:51], v[200:203], v[172:175], v[48:51]
    ds_read_b128 v[124:127], v9 offset:0
    v_mfma_f32_16x16x32_bf16 v[52:55], v[200:203], v[176:179], v[52:55]
    ds_read_b128 v[128:131], v9 offset:2048
    v_mfma_f32_16x16x32_bf16 v[56:59], v[200:203], v[180:183], v[56:59]
    ds_read_b128 v[132:135], v9 offset:4096
    v_mfma_f32_16x16x32_bf16 v[60:63], v[200:203], v[184:187], v[60:63]
    ds_read_b128 v[136:139], v9 offset:6144
    v_mfma_f32_16x16x32_bf16 v[64:67], v[200:203], v[188:191], v[64:67]
    ds_read_b128 v[140:143], v9 offset:8192
    v_mfma_f32_16x16x32_bf16 v[68:71], v[172:175], v[204:207], v[68:71]
    ds_read_b64_tr_b16 v[152:153], v13 offset:160
    v_mfma_f32_16x16x32_bf16 v[72:75], v[176:179], v[204:207], v[72:75]
    ds_read_b64_tr_b16 v[154:155], v13 offset:7840
    v_mfma_f32_16x16x32_bf16 v[76:79], v[180:183], v[204:207], v[76:79]
    ds_read_b64_tr_b16 v[156:157], v13 offset:320
    v_mfma_f32_16x16x32_bf16 v[80:83], v[184:187], v[204:207], v[80:83]
    ds_read_b64_tr_b16 v[158:159], v13 offset:8000
    v_mfma_f32_16x16x32_bf16 v[84:87], v[188:191], v[204:207], v[84:87]
    ds_read_b128 v[144:147], v11
    v_mfma_f32_16x16x32_bf16 v[112:115], v[172:175], v[172:175], v[112:115]
    ds_read_b64_tr_b16 v[160:161], v14 offset:0
    v_mfma_f32_16x16x32_bf16 v[116:119], v[192:195], v[192:195], v[116:119]
    ds_read_b64_tr_b16 v[162:163], v14 offset:7680
    v_mfma_f32_16x16x32_bf16 v[120:123], v[172:175], v[192:195], v[120:123]
    ds_read_b64_tr_b16 v[164:165], v14 offset:160
    v_mfma_f32_16x16x32_bf16 v[88:91], v[208:211], v[192:195], v[88:91]
    ds_read_b64_tr_b16 v[166:167], v14 offset:7840
    v_mfma_f32_16x16x32_bf16 v[100:103], v[208:211], v[172:175], v[100:103]
    ds_read_b64_tr_b16 v[168:169], v14 offset:320
    v_mfma_f32_16x16x32_bf16 v[92:95], v[212:215], v[192:195], v[92:95]
    ds_read_b64_tr_b16 v[170:171], v14 offset:8000
    v_mfma_f32_16x16x32_bf16 v[104:107], v[212:215], v[172:175], v[104:107]
    v_mfma_f32_16x16x32_bf16 v[96:99], v[192:195], v[216:219], v[96:99]
    v_mfma_f32_16x16x32_bf16 v[108:111], v[172:175], v[216:219], v[108:111]
    s_waitcnt lgkmcnt(15)
    v_mfma_f32_16x16x32_bf16 v[28:31], v[148:151], v[124:127], v[28:31]
    ds_read_b64_tr_b16 v[196:197], v13 offset:15360
    s_waitcnt lgkmcnt(15)
    v_mfma_f32_16x16x32_bf16 v[32:35], v[148:151], v[128:131], v[32:35]
    ds_read_b64_tr_b16 v[198:199], v13 offset:23040
    s_waitcnt lgkmcnt(15)
    v_mfma_f32_16x16x32_bf16 v[36:39], v[148:151], v[132:135], v[36:39]
    ds_read_b128 v[172:175], v10 offset:0
    s_waitcnt lgkmcnt(15)
    v_mfma_f32_16x16x32_bf16 v[40:43], v[148:151], v[136:139], v[40:43]
    ds_read_b128 v[176:179], v10 offset:2048
    s_waitcnt lgkmcnt(15)
    v_mfma_f32_16x16x32_bf16 v[44:47], v[148:151], v[140:143], v[44:47]
    ds_read_b128 v[180:183], v10 offset:4096
    s_waitcnt lgkmcnt(14)
    v_mfma_f32_16x16x32_bf16 v[48:51], v[152:155], v[124:127], v[48:51]
    ds_read_b128 v[184:187], v10 offset:6144
    v_mfma_f32_16x16x32_bf16 v[52:55], v[152:155], v[128:131], v[52:55]
    ds_read_b128 v[188:191], v10 offset:8192
    v_mfma_f32_16x16x32_bf16 v[56:59], v[152:155], v[132:135], v[56:59]
    ds_read_b64_tr_b16 v[200:201], v13 offset:15520
    v_mfma_f32_16x16x32_bf16 v[60:63], v[152:155], v[136:139], v[60:63]
    ds_read_b64_tr_b16 v[202:203], v13 offset:23200
    v_mfma_f32_16x16x32_bf16 v[64:67], v[152:155], v[140:143], v[64:67]
    ds_read_b64_tr_b16 v[204:205], v13 offset:15680
    s_waitcnt lgkmcnt(15)
    v_mfma_f32_16x16x32_bf16 v[68:71], v[124:127], v[156:159], v[68:71]
    ds_read_b64_tr_b16 v[206:207], v13 offset:23360
    v_mfma_f32_16x16x32_bf16 v[72:75], v[128:131], v[156:159], v[72:75]
    ds_read_b128 v[192:195], v12
    v_mfma_f32_16x16x32_bf16 v[76:79], v[132:135], v[156:159], v[76:79]
    ds_read_b64_tr_b16 v[208:209], v14 offset:15360
    v_mfma_f32_16x16x32_bf16 v[80:83], v[136:139], v[156:159], v[80:83]
    ds_read_b64_tr_b16 v[210:211], v14 offset:23040
    v_mfma_f32_16x16x32_bf16 v[84:87], v[140:143], v[156:159], v[84:87]
    ds_read_b64_tr_b16 v[212:213], v14 offset:15520
    v_mfma_f32_16x16x32_bf16 v[112:115], v[124:127], v[124:127], v[112:115]
    ds_read_b64_tr_b16 v[214:215], v14 offset:23200
    v_mfma_f32_16x16x32_bf16 v[116:119], v[144:147], v[144:147], v[116:119]
    ds_read_b64_tr_b16 v[216:217], v14 offset:15680
    v_mfma_f32_16x16x32_bf16 v[120:123], v[124:127], v[144:147], v[120:123]
    ds_read_b64_tr_b16 v[218:219], v14 offset:23360
    s_waitcnt lgkmcnt(15)
    v_mfma_f32_16x16x32_bf16 v[88:91], v[160:163], v[144:147], v[88:91]
    v_mfma_f32_16x16x32_bf16 v[100:103], v[160:163], v[124:127], v[100:103]
    v_mfma_f32_16x16x32_bf16 v[92:95], v[164:167], v[144:147], v[92:95]
    v_mfma_f32_16x16x32_bf16 v[104:107], v[164:167], v[124:127], v[104:107]
    v_mfma_f32_16x16x32_bf16 v[96:99], v[144:147], v[168:171], v[96:99]
    v_mfma_f32_16x16x32_bf16 v[108:111], v[124:127], v[168:171], v[108:111]
    v_mfma_f32_16x16x32_bf16 v[28:31], v[196:199], v[172:175], v[28:31]
    s_waitcnt lgkmcnt(14)
    v_mfma_f32_16x16x32_bf16 v[32:35], v[196:199], v[176:179], v[32:35]
    s_waitcnt lgkmcnt(13)
    v_mfma_f32_16x16x32_bf16 v[36:39], v[196:199], v[180:183], v[36:39]
    s_waitcnt lgkmcnt(0)
    s_barrier
    v_add_u32 v9, 122880, v3
    v_add_u32 v10, 122880, v4
    v_add_u32 v11, 122880, v5
    v_add_u32 v12, 122880, v6
    v_add_u32 v13, 122880, v7
    v_add_u32 v14, 122880, v8
    v_mfma_f32_16x16x32_bf16 v[40:43], v[196:199], v[184:187], v[40:43]
    ds_read_b64_tr_b16 v[148:149], v13 offset:0
    v_mfma_f32_16x16x32_bf16 v[44:47], v[196:199], v[188:191], v[44:47]
    ds_read_b64_tr_b16 v[150:151], v13 offset:7680
    v_mfma_f32_16x16x32_bf16 v[48:51], v[200:203], v[172:175], v[48:51]
    ds_read_b128 v[124:127], v9 offset:0
    v_mfma_f32_16x16x32_bf16 v[52:55], v[200:203], v[176:179], v[52:55]
    ds_read_b128 v[128:131], v9 offset:2048
    v_mfma_f32_16x16x32_bf16 v[56:59], v[200:203], v[180:183], v[56:59]
    ds_read_b128 v[132:135], v9 offset:4096
    v_mfma_f32_16x16x32_bf16 v[60:63], v[200:203], v[184:187], v[60:63]
    ds_read_b128 v[136:139], v9 offset:6144
    v_mfma_f32_16x16x32_bf16 v[64:67], v[200:203], v[188:191], v[64:67]
    ds_read_b128 v[140:143], v9 offset:8192
    v_mfma_f32_16x16x32_bf16 v[68:71], v[172:175], v[204:207], v[68:71]
    ds_read_b64_tr_b16 v[152:153], v13 offset:160
    v_mfma_f32_16x16x32_bf16 v[72:75], v[176:179], v[204:207], v[72:75]
    ds_read_b64_tr_b16 v[154:155], v13 offset:7840
    v_mfma_f32_16x16x32_bf16 v[76:79], v[180:183], v[204:207], v[76:79]
    ds_read_b64_tr_b16 v[156:157], v13 offset:320
    v_mfma_f32_16x16x32_bf16 v[80:83], v[184:187], v[204:207], v[80:83]
    ds_read_b64_tr_b16 v[158:159], v13 offset:8000
    v_mfma_f32_16x16x32_bf16 v[84:87], v[188:191], v[204:207], v[84:87]
    ds_read_b128 v[144:147], v11
    v_mfma_f32_16x16x32_bf16 v[112:115], v[172:175], v[172:175], v[112:115]
    ds_read_b64_tr_b16 v[160:161], v14 offset:0
    v_mfma_f32_16x16x32_bf16 v[116:119], v[192:195], v[192:195], v[116:119]
    ds_read_b64_tr_b16 v[162:163], v14 offset:7680
    v_mfma_f32_16x16x32_bf16 v[120:123], v[172:175], v[192:195], v[120:123]
    ds_read_b64_tr_b16 v[164:165], v14 offset:160
    v_mfma_f32_16x16x32_bf16 v[88:91], v[208:211], v[192:195], v[88:91]
    ds_read_b64_tr_b16 v[166:167], v14 offset:7840
    v_mfma_f32_16x16x32_bf16 v[100:103], v[208:211], v[172:175], v[100:103]
    ds_read_b64_tr_b16 v[168:169], v14 offset:320
    v_mfma_f32_16x16x32_bf16 v[92:95], v[212:215], v[192:195], v[92:95]
    ds_read_b64_tr_b16 v[170:171], v14 offset:8000
    v_mfma_f32_16x16x32_bf16 v[104:107], v[212:215], v[172:175], v[104:107]
    v_mfma_f32_16x16x32_bf16 v[96:99], v[192:195], v[216:219], v[96:99]
    v_mfma_f32_16x16x32_bf16 v[108:111], v[172:175], v[216:219], v[108:111]
    s_waitcnt lgkmcnt(15)
    v_mfma_f32_16x16x32_bf16 v[28:31], v[148:151], v[124:127], v[28:31]
    ds_read_b64_tr_b16 v[196:197], v13 offset:15360
    s_waitcnt lgkmcnt(15)
    v_mfma_f32_16x16x32_bf16 v[32:35], v[148:151], v[128:131], v[32:35]
    ds_read_b64_tr_b16 v[198:199], v13 offset:23040
    s_waitcnt lgkmcnt(15)
    v_mfma_f32_16x16x32_bf16 v[36:39], v[148:151], v[132:135], v[36:39]
    ds_read_b128 v[172:175], v10 offset:0
    s_waitcnt lgkmcnt(15)
    v_mfma_f32_16x16x32_bf16 v[40:43], v[148:151], v[136:139], v[40:43]
    ds_read_b128 v[176:179], v10 offset:2048
    s_waitcnt lgkmcnt(15)
    v_mfma_f32_16x16x32_bf16 v[44:47], v[148:151], v[140:143], v[44:47]
    ds_read_b128 v[180:183], v10 offset:4096
    s_waitcnt lgkmcnt(14)
    v_mfma_f32_16x16x32_bf16 v[48:51], v[152:155], v[124:127], v[48:51]
    ds_read_b128 v[184:187], v10 offset:6144
    v_mfma_f32_16x16x32_bf16 v[52:55], v[152:155], v[128:131], v[52:55]
    ds_read_b128 v[188:191], v10 offset:8192
    v_mfma_f32_16x16x32_bf16 v[56:59], v[152:155], v[132:135], v[56:59]
    ds_read_b64_tr_b16 v[200:201], v13 offset:15520
    v_mfma_f32_16x16x32_bf16 v[60:63], v[152:155], v[136:139], v[60:63]
    ds_read_b64_tr_b16 v[202:203], v13 offset:23200
    v_mfma_f32_16x16x32_bf16 v[64:67], v[152:155], v[140:143], v[64:67]
    ds_read_b64_tr_b16 v[204:205], v13 offset:15680
    s_waitcnt lgkmcnt(15)
    v_mfma_f32_16x16x32_bf16 v[68:71], v[124:127], v[156:159], v[68:71]
    ds_read_b64_tr_b16 v[206:207], v13 offset:23360
    v_mfma_f32_16x16x32_bf16 v[72:75], v[128:131], v[156:159], v[72:75]
    ds_read_b128 v[192:195], v12
    v_mfma_f32_16x16x32_bf16 v[76:79], v[132:135], v[156:159], v[76:79]
    ds_read_b64_tr_b16 v[208:209], v14 offset:15360
    v_mfma_f32_16x16x32_bf16 v[80:83], v[136:139], v[156:159], v[80:83]
    ds_read_b64_tr_b16 v[210:211], v14 offset:23040
    v_mfma_f32_16x16x32_bf16 v[84:87], v[140:143], v[156:159], v[84:87]
    ds_read_b64_tr_b16 v[212:213], v14 offset:15520
    v_mfma_f32_16x16x32_bf16 v[112:115], v[124:127], v[124:127], v[112:115]
    ds_read_b64_tr_b16 v[214:215], v14 offset:23200
    v_mfma_f32_16x16x32_bf16 v[116:119], v[144:147], v[144:147], v[116:119]
    ds_read_b64_tr_b16 v[216:217], v14 offset:15680
    v_mfma_f32_16x16x32_bf16 v[120:123], v[124:127], v[144:147], v[120:123]
    ds_read_b64_tr_b16 v[218:219], v14 offset:23360
    s_waitcnt lgkmcnt(15)
    v_mfma_f32_16x16x32_bf16 v[88:91], v[160:163], v[144:147], v[88:91]
    v_mfma_f32_16x16x32_bf16 v[100:103], v[160:163], v[124:127], v[100:103]
    v_mfma_f32_16x16x32_bf16 v[92:95], v[164:167], v[144:147], v[92:95]
    v_mfma_f32_16x16x32_bf16 v[104:107], v[164:167], v[124:127], v[104:107]
    v_mfma_f32_16x16x32_bf16 v[96:99], v[144:147], v[168:171], v[96:99]
    v_mfma_f32_16x16x32_bf16 v[108:111], v[124:127], v[168:171], v[108:111]
    v_mfma_f32_16x16x32_bf16 v[28:31], v[196:199], v[172:175], v[28:31]
    s_waitcnt lgkmcnt(14)
    v_mfma_f32_16x16x32_bf16 v[32:35], v[196:199], v[176:179], v[32:35]
    s_waitcnt lgkmcnt(13)
    v_mfma_f32_16x16x32_bf16 v[36:39], v[196:199], v[180:183], v[36:39]
    s_waitcnt lgkmcnt(0)
    s_barrier
    v_add_u32 v9, 81920, v3
    v_add_u32 v10, 81920, v4
    v_add_u32 v11, 81920, v5
    v_add_u32 v12, 81920, v6
    v_add_u32 v13, 81920, v7
    v_add_u32 v14, 81920, v8
    v_mfma_f32_16x16x32_bf16 v[40:43], v[196:199], v[184:187], v[40:43]
    ds_read_b64_tr_b16 v[148:149], v13 offset:0
    v_mfma_f32_16x16x32_bf16 v[44:47], v[196:199], v[188:191], v[44:47]
    ds_read_b64_tr_b16 v[150:151], v13 offset:7680
    v_mfma_f32_16x16x32_bf16 v[48:51], v[200:203], v[172:175], v[48:51]
    ds_read_b128 v[124:127], v9 offset:0
    v_mfma_f32_16x16x32_bf16 v[52:55], v[200:203], v[176:179], v[52:55]
    ds_read_b128 v[128:131], v9 offset:2048
    v_mfma_f32_16x16x32_bf16 v[56:59], v[200:203], v[180:183], v[56:59]
    ds_read_b128 v[132:135], v9 offset:4096
    v_mfma_f32_16x16x32_bf16 v[60:63], v[200:203], v[184:187], v[60:63]
    ds_read_b128 v[136:139], v9 offset:6144
    v_mfma_f32_16x16x32_bf16 v[64:67], v[200:203], v[188:191], v[64:67]
    ds_read_b128 v[140:143], v9 offset:8192
    v_mfma_f32_16x16x32_bf16 v[68:71], v[172:175], v[204:207], v[68:71]
    ds_read_b64_tr_b16 v[152:153], v13 offset:160
    v_mfma_f32_16x16x32_bf16 v[72:75], v[176:179], v[204:207], v[72:75]
    ds_read_b64_tr_b16 v[154:155], v13 offset:7840
    v_mfma_f32_16x16x32_bf16 v[76:79], v[180:183], v[204:207], v[76:79]
    ds_read_b64_tr_b16 v[156:157], v13 offset:320
    v_mfma_f32_16x16x32_bf16 v[80:83], v[184:187], v[204:207], v[80:83]
    ds_read_b64_tr_b16 v[158:159], v13 offset:8000
    v_mfma_f32_16x16x32_bf16 v[84:87], v[188:191], v[204:207], v[84:87]
    ds_read_b128 v[144:147], v11
    v_mfma_f32_16x16x32_bf16 v[112:115], v[172:175], v[172:175], v[112:115]
    ds_read_b64_tr_b16 v[160:161], v14 offset:0
    v_mfma_f32_16x16x32_bf16 v[116:119], v[192:195], v[192:195], v[116:119]
    ds_read_b64_tr_b16 v[162:163], v14 offset:7680
    v_mfma_f32_16x16x32_bf16 v[120:123], v[172:175], v[192:195], v[120:123]
    ds_read_b64_tr_b16 v[164:165], v14 offset:160
    v_mfma_f32_16x16x32_bf16 v[88:91], v[208:211], v[192:195], v[88:91]
    ds_read_b64_tr_b16 v[166:167], v14 offset:7840
    v_mfma_f32_16x16x32_bf16 v[100:103], v[208:211], v[172:175], v[100:103]
    ds_read_b64_tr_b16 v[168:169], v14 offset:320
    v_mfma_f32_16x16x32_bf16 v[92:95], v[212:215], v[192:195], v[92:95]
    ds_read_b64_tr_b16 v[170:171], v14 offset:8000
    v_mfma_f32_16x16x32_bf16 v[104:107], v[212:215], v[172:175], v[104:107]
    v_mfma_f32_16x16x32_bf16 v[96:99], v[192:195], v[216:219], v[96:99]
    v_mfma_f32_16x16x32_bf16 v[108:111], v[172:175], v[216:219], v[108:111]
    s_waitcnt lgkmcnt(15)
    v_mfma_f32_16x16x32_bf16 v[28:31], v[148:151], v[124:127], v[28:31]
    ds_read_b64_tr_b16 v[196:197], v13 offset:15360
    s_waitcnt lgkmcnt(15)
    v_mfma_f32_16x16x32_bf16 v[32:35], v[148:151], v[128:131], v[32:35]
    ds_read_b64_tr_b16 v[198:199], v13 offset:23040
    s_waitcnt lgkmcnt(15)
    v_mfma_f32_16x16x32_bf16 v[36:39], v[148:151], v[132:135], v[36:39]
    ds_read_b128 v[172:175], v10 offset:0
    s_waitcnt lgkmcnt(15)
    v_mfma_f32_16x16x32_bf16 v[40:43], v[148:151], v[136:139], v[40:43]
    ds_read_b128 v[176:179], v10 offset:2048
    s_waitcnt lgkmcnt(15)
    v_mfma_f32_16x16x32_bf16 v[44:47], v[148:151], v[140:143], v[44:47]
    ds_read_b128 v[180:183], v10 offset:4096
    s_waitcnt lgkmcnt(14)
    v_mfma_f32_16x16x32_bf16 v[48:51], v[152:155], v[124:127], v[48:51]
    ds_read_b128 v[184:187], v10 offset:6144
    v_mfma_f32_16x16x32_bf16 v[52:55], v[152:155], v[128:131], v[52:55]
    ds_read_b128 v[188:191], v10 offset:8192
    v_mfma_f32_16x16x32_bf16 v[56:59], v[152:155], v[132:135], v[56:59]
    ds_read_b64_tr_b16 v[200:201], v13 offset:15520
    v_mfma_f32_16x16x32_bf16 v[60:63], v[152:155], v[136:139], v[60:63]
    ds_read_b64_tr_b16 v[202:203], v13 offset:23200
    v_mfma_f32_16x16x32_bf16 v[64:67], v[152:155], v[140:143], v[64:67]
    ds_read_b64_tr_b16 v[204:205], v13 offset:15680
    s_waitcnt lgkmcnt(15)
    v_mfma_f32_16x16x32_bf16 v[68:71], v[124:127], v[156:159], v[68:71]
    ds_read_b64_tr_b16 v[206:207], v13 offset:23360
    v_mfma_f32_16x16x32_bf16 v[72:75], v[128:131], v[156:159], v[72:75]
    ds_read_b128 v[192:195], v12
    v_mfma_f32_16x16x32_bf16 v[76:79], v[132:135], v[156:159], v[76:79]
    ds_read_b64_tr_b16 v[208:209], v14 offset:15360
    v_mfma_f32_16x16x32_bf16 v[80:83], v[136:139], v[156:159], v[80:83]
    ds_read_b64_tr_b16 v[210:211], v14 offset:23040
    v_mfma_f32_16x16x32_bf16 v[84:87], v[140:143], v[156:159], v[84:87]
    ds_read_b64_tr_b16 v[212:213], v14 offset:15520
    v_mfma_f32_16x16x32_bf16 v[112:115], v[124:127], v[124:127], v[112:115]
    ds_read_b64_tr_b16 v[214:215], v14 offset:23200
    v_mfma_f32_16x16x32_bf16 v[116:119], v[144:147], v[144:147], v[116:119]
    ds_read_b64_tr_b16 v[216:217], v14 offset:15680
    v_mfma_f32_16x16x32_bf16 v[120:123], v[124:127], v[144:147], v[120:123]
    ds_read_b64_tr_b16 v[218:219], v14 offset:23360
    s_waitcnt lgkmcnt(15)
    v_mfma_f32_16x16x32_bf16 v[88:91], v[160:163], v[144:147], v[88:91]
    v_mfma_f32_16x16x32_bf16 v[100:103], v[160:163], v[124:127], v[100:103]
    v_mfma_f32_16x16x32_bf16 v[92:95], v[164:167], v[144:147], v[92:95]
    v_mfma_f32_16x16x32_bf16 v[104:107], v[164:167], v[124:127], v[104:107]
    v_mfma_f32_16x16x32_bf16 v[96:99], v[144:147], v[168:171], v[96:99]
    v_mfma_f32_16x16x32_bf16 v[108:111], v[124:127], v[168:171], v[108:111]
    v_mfma_f32_16x16x32_bf16 v[28:31], v[196:199], v[172:175], v[28:31]
    s_waitcnt lgkmcnt(14)
    v_mfma_f32_16x16x32_bf16 v[32:35], v[196:199], v[176:179], v[32:35]
    s_waitcnt lgkmcnt(13)
    v_mfma_f32_16x16x32_bf16 v[36:39], v[196:199], v[180:183], v[36:39]
    s_waitcnt lgkmcnt(0)
    s_barrier
    v_add_u32 v9, 0, v3
    v_add_u32 v10, 0, v4
    v_add_u32 v11, 0, v5
    v_add_u32 v12, 0, v6
    v_add_u32 v13, 0, v7
    v_add_u32 v14, 0, v8
    s_cmp_lg_u32 s28, 0
    s_cbranch_scc1 L_nopk1
    buffer_load_dwordx4 v[248:251], v2, s[24:27], s79 offen sc1
L_nopk1:
    v_mfma_f32_16x16x32_bf16 v[40:43], v[196:199], v[184:187], v[40:43]
    ds_read_b64_tr_b16 v[148:149], v13 offset:0
    v_mfma_f32_16x16x32_bf16 v[44:47], v[196:199], v[188:191], v[44:47]
    ds_read_b64_tr_b16 v[150:151], v13 offset:7680
    v_mfma_f32_16x16x32_bf16 v[48:51], v[200:203], v[172:175], v[48:51]
    ds_read_b128 v[124:127], v9 offset:0
    v_mfma_f32_16x16x32_bf16 v[52:55], v[200:203], v[176:179], v[52:55]
    ds_read_b128 v[128:131], v9 offset:2048
    v_mfma_f32_16x16x32_bf16 v[56:59], v[200:203], v[180:183], v[56:59]
    ds_read_b128 v[132:135], v9 offset:4096
    v_mfma_f32_16x16x32_bf16 v[60:63], v[200:203], v[184:187], v[60:63]
    ds_read_b128 v[136:139], v9 offset:6144
    v_mfma_f32_16x16x32_bf16 v[64:67], v[200:203], v[188:191], v[64:67]
    ds_read_b128 v[140:143], v9 offset:8192
    v_mfma_f32_16x16x32_bf16 v[68:71], v[172:175], v[204:207], v[68:71]
    ds_read_b64_tr_b16 v[152:153], v13 offset:160
    v_mfma_f32_16x16x32_bf16 v[72:75], v[176:179], v[204:207], v[72:75]
    ds_read_b64_tr_b16 v[154:155], v13 offset:7840
    v_mfma_f32_16x16x32_bf16 v[76:79], v[180:183], v[204:207], v[76:79]
    ds_read_b64_tr_b16 v[156:157], v13 offset:320
    v_mfma_f32_16x16x32_bf16 v[80:83], v[184:187], v[204:207], v[80:83]
    ds_read_b64_tr_b16 v[158:159], v13 offset:8000
    v_mfma_f32_16x16x32_bf16 v[84:87], v[188:191], v[204:207], v[84:87]
    ds_read_b128 v[144:147], v11
    v_mfma_f32_16x16x32_bf16 v[112:115], v[172:175], v[172:175], v[112:115]
    ds_read_b64_tr_b16 v[160:161], v14 offset:0
    v_mfma_f32_16x16x32_bf16 v[116:119], v[192:195], v[192:195], v[116:119]
    ds_read_b64_tr_b16 v[162:163], v14 offset:7680
    v_mfma_f32_16x16x32_bf16 v[120:123], v[172:175], v[192:195], v[120:123]
    ds_read_b64_tr_b16 v[164:165], v14 offset:160
    v_mfma_f32_16x16x32_bf16 v[88:91], v[208:211], v[192:195], v[88:91]
    ds_read_b64_tr_b16 v[166:167], v14 offset:7840
    v_mfma_f32_16x16x32_bf16 v[100:103], v[208:211], v[172:175], v[100:103]
    ds_read_b64_tr_b16 v[168:169], v14 offset:320
    v_mfma_f32_16x16x32_bf16 v[92:95], v[212:215], v[192:195], v[92:95]
    ds_read_b64_tr_b16 v[170:171], v14 offset:8000
    v_mfma_f32_16x16x32_bf16 v[104:107], v[212:215], v[172:175], v[104:107]
    v_mfma_f32_16x16x32_bf16 v[96:99], v[192:195], v[216:219], v[96:99]
    v_mfma_f32_16x16x32_bf16 v[108:111], v[172:175], v[216:219], v[108:111]
    s_waitcnt lgkmcnt(15)
    v_mfma_f32_16x16x32_bf16 v[28:31], v[148:151], v[124:127], v[28:31]
    ds_read_b64_tr_b16 v[196:197], v13 offset:15360
    s_waitcnt lgkmcnt(15)
    v_mfma_f32_16x16x32_bf16 v[32:35], v[148:151], v[128:131], v[32:35]
    ds_read_b64_tr_b16 v[198:199], v13 offset:23040
    s_waitcnt lgkmcnt(15)
    v_mfma_f32_16x16x32_bf16 v[36:39], v[148:151], v[132:135], v[36:39]
    ds_read_b128 v[172:175], v10 offset:0
    s_waitcnt lgkmcnt(15)
    v_mfma_f32_16x16x32_bf16 v[40:43], v[148:151], v[136:139], v[40:43]
    ds_read_b128 v[176:179], v10 offset:2048
    s_waitcnt lgkmcnt(15)
    v_mfma_f32_16x16x32_bf16 v[44:47], v[148:151], v[140:143], v[44:47]
    ds_read_b128 v[180:183], v10 offset:4096
    s_waitcnt lgkmcnt(14)
    v_mfma_f32_16x16x32_bf16 v[48:51], v[152:155], v[124:127], v[48:51]
    ds_read_b128 v[184:187], v10 offset:6144
    v_mfma_f32_16x16x32_bf16 v[52:55], v[152:155], v[128:131], v[52:55]
    ds_read_b128 v[188:191], v10 offset:8192
    v_mfma_f32_16x16x32_bf16 v[56:59], v[152:155], v[132:135], v[56:59]
    ds_read_b64_tr_b16 v[200:201], v13 offset:15520
    v_mfma_f32_16x16x32_bf16 v[60:63], v[152:155], v[136:139], v[60:63]
    ds_read_b64_tr_b16 v[202:203], v13 offset:23200
    v_mfma_f32_16x16x32_bf16 v[64:67], v[152:155], v[140:143], v[64:67]
    ds_read_b64_tr_b16 v[204:205], v13 offset:15680
    s_waitcnt lgkmcnt(15)
    v_mfma_f32_16x16x32_bf16 v[68:71], v[124:127], v[156:159], v[68:71]
    ds_read_b64_tr_b16 v[206:207], v13 offset:23360
    v_mfma_f32_16x16x32_bf16 v[72:75], v[128:131], v[156:159], v[72:75]
    ds_read_b128 v[192:195], v12
    v_mfma_f32_16x16x32_bf16 v[76:79], v[132:135], v[156:159], v[76:79]
    ds_read_b64_tr_b16 v[208:209], v14 offset:15360
    v_mfma_f32_16x16x32_bf16 v[80:83], v[136:139], v[156:159], v[80:83]
    ds_read_b64_tr_b16 v[210:211], v14 offset:23040
    v_mfma_f32_16x16x32_bf16 v[84:87], v[140:143], v[156:159], v[84:87]
    ds_read_b64_tr_b16 v[212:213], v14 offset:15520
    v_mfma_f32_16x16x32_bf16 v[112:115], v[124:127], v[124:127], v[112:115]
    ds_read_b64_tr_b16 v[214:215], v14 offset:23200
    v_mfma_f32_16x16x32_bf16 v[116:119], v[144:147], v[144:147], v[116:119]
    ds_read_b64_tr_b16 v[216:217], v14 offset:15680
    v_mfma_f32_16x16x32_bf16 v[120:123], v[124:127], v[144:147], v[120:123]
    ds_read_b64_tr_b16 v[218:219], v14 offset:23360
    s_waitcnt lgkmcnt(15)
    v_mfma_f32_16x16x32_bf16 v[88:91], v[160:163], v[144:147], v[88:91]
    v_mfma_f32_16x16x32_bf16 v[100:103], v[160:163], v[124:127], v[100:103]
    v_mfma_f32_16x16x32_bf16 v[92:95], v[164:167], v[144:147], v[92:95]
    v_mfma_f32_16x16x32_bf16 v[104:107], v[164:167], v[124:127], v[104:107]
    v_mfma_f32_16x16x32_bf16 v[96:99], v[144:147], v[168:171], v[96:99]
    v_mfma_f32_16x16x32_bf16 v[108:111], v[124:127], v[168:171], v[108:111]
    v_mfma_f32_16x16x32_bf16 v[28:31], v[196:199], v[172:175], v[28:31]
    s_waitcnt lgkmcnt(14)
    v_mfma_f32_16x16x32_bf16 v[32:35], v[196:199], v[176:179], v[32:35]
    s_waitcnt lgkmcnt(13)
    v_mfma_f32_16x16x32_bf16 v[36:39], v[196:199], v[180:183], v[36:39]
    s_cmp_lg_u32 s28, 0
    s_cbranch_scc1 L_nopk2
    s_mov_b32 s96, 0
    s_or_b32 s82, s93, s95
L_pk:
    s_waitcnt vmcnt(0)
    v_xor_b32 v248, s82, v248
    v_xor_b32 v249, s82, v249
    v_xor_b32 v250, s82, v250
    v_xor_b32 v251, s82, v251
    v_or3_b32 v248, v248, v249, v250
    v_or_b32 v248, v248, v251
    v_cmp_le_u32 vcc, 16, v248
    s_add_u32 s96, s96, 1
    s_cmp_eq_u64 vcc, 0
    s_cbranch_scc1 L_pk_ok
    s_cmp_lt_u32 s96, 200000
    s_cbranch_scc0 L_end
    s_sleep 2
    buffer_load_dwordx4 v[248:251], v2, s[24:27], s79 offen sc1
    s_branch L_pk
L_pk_ok:
    s_waitcnt vmcnt(0)
    v_cmp_ne_u32 vcc, 0, v248
    s_nop 0
    s_and_b64 vcc, vcc, s[80:81]
    s_cselect_b32 s82, 0, 1
    v_mov_b32 v248, 122848
    v_mov_b32 v250, s82
    v_mov_b32 v251, s93
    ds_write_b64 v248, v[250:251]
    ds_write2_b32 v248, v15, v15 offset0:2 offset1:3
    ds_write_b32 v248, v15 offset:16
L_nopk2:
    s_waitcnt lgkmcnt(0)
    s_barrier
    v_add_u32 v9, 40960, v3
    v_add_u32 v10, 40960, v4
    v_add_u32 v11, 40960, v5
    v_add_u32 v12, 40960, v6
    v_add_u32 v13, 40960, v7
    v_add_u32 v14, 40960, v8
    v_mov_b32 v248, 122848
    ds_read_b32 v249, v248
    s_waitcnt lgkmcnt(0)
    v_readfirstlane_b32 s92, v249
    v_mfma_f32_16x16x32_bf16 v[40:43], v[196:199], v[184:187], v[40:43]
    ds_read_b64_tr_b16 v[148:149], v13 offset:0
    v_mfma_f32_16x16x32_bf16 v[44:47], v[196:199], v[188:191], v[44:47]
    ds_read_b64_tr_b16 v[150:151], v13 offset:7680
    v_mfma_f32_16x16x32_bf16 v[48:51], v[200:203], v[172:175], v[48:51]
    ds_read_b128 v[124:127], v9 offset:0
    v_mfma_f32_16x16x32_bf16 v[52:55], v[200:203], v[176:179], v[52:55]
    ds_read_b128 v[128:131], v9 offset:2048
    v_mfma_f32_16x16x32_bf16 v[56:59], v[200:203], v[180:183], v[56:59]
    ds_read_b128 v[132:135], v9 offset:4096
    v_mfma_f32_16x16x32_bf16 v[60:63], v[200:203], v[184:187], v[60:63]
    ds_read_b128 v[136:139], v9 offset:6144
    v_mfma_f32_16x16x32_bf16 v[64:67], v[200:203], v[188:191], v[64:67]
    ds_read_b128 v[140:143], v9 offset:8192
    v_mfma_f32_16x16x32_bf16 v[68:71], v[172:175], v[204:207], v[68:71]
    ds_read_b64_tr_b16 v[152:153], v13 offset:160
    v_mfma_f32_16x16x32_bf16 v[72:75], v[176:179], v[204:207], v[72:75]
    ds_read_b64_tr_b16 v[154:155], v13 offset:7840
    v_mfma_f32_16x16x32_bf16 v[76:79], v[180:183], v[204:207], v[76:79]
    ds_read_b64_tr_b16 v[156:157], v13 offset:320
    v_mfma_f32_16x16x32_bf16 v[80:83], v[184:187], v[204:207], v[80:83]
    ds_read_b64_tr_b16 v[158:159], v13 offset:8000
    v_mfma_f32_16x16x32_bf16 v[84:87], v[188:191], v[204:207], v[84:87]
    ds_read_b128 v[144:147], v11
    v_mfma_f32_16x16x32_bf16 v[112:115], v[172:175], v[172:175], v[112:115]
    ds_read_b64_tr_b16 v[160:161], v14 offset:0
    v_mfma_f32_16x16x32_bf16 v[116:119], v[192:195], v[192:195], v[116:119]
    ds_read_b64_tr_b16 v[162:163], v14 offset:7680
    v_mfma_f32_16x16x32_bf16 v[120:123], v[172:175], v[192:195], v[120:123]
    ds_read_b64_tr_b16 v[164:165], v14 offset:160
    v_mfma_f32_16x16x32_bf16 v[88:91], v[208:211], v[192:195], v[88:91]
    ds_read_b64_tr_b16 v[166:167], v14 offset:7840
    v_mfma_f32_16x16x32_bf16 v[100:103], v[208:211], v[172:175], v[100:103]
    ds_read_b64_tr_b16 v[168:169], v14 offset:320
    v_mfma_f32_16x16x32_bf16 v[92:95], v[212:215], v[192:195], v[92:95]
    ds_read_b64_tr_b16 v[170:171], v14 offset:8000
    v_mfma_f32_16x16x32_bf16 v[104:107], v[212:215], v[172:175], v[104:107]
    v_mfma_f32_16x16x32_bf16 v[96:99], v[192:195], v[216:219], v[96:99]
    v_mfma_f32_16x16x32_bf16 v[108:111], v[172:175], v[216:219], v[108:111]
    s_waitcnt lgkmcnt(15)
    v_mfma_f32_16x16x32_bf16 v[28:31], v[148:151], v[124:127], v[28:31]
    ds_read_b64_tr_b16 v[196:197], v13 offset:15360
    s_waitcnt lgkmcnt(15)
    v_mfma_f32_16x16x32_bf16 v[32:35], v[148:151], v[128:131], v[32:35]
    ds_read_b64_tr_b16 v[198:199], v13 offset:23040
    s_waitcnt lgkmcnt(15)
    v_mfma_f32_16x16x32_bf16 v[36:39], v[148:151], v[132:135], v[36:39]
    ds_read_b128 v[172:175], v10 offset:0
    s_waitcnt lgkmcnt(15)
    v_mfma_f32_16x16x32_bf16 v[40:43], v[148:151], v[136:139], v[40:43]
    ds_read_b128 v[176:179], v10 offset:2048
    s_waitcnt lgkmcnt(15)
    v_mfma_f32_16x16x32_bf16 v[44:47], v[148:151], v[140:143], v[44:47]
    ds_read_b128 v[180:183], v10 offset:4096
    s_waitcnt lgkmcnt(14)
    v_mfma_f32_16x16x32_bf16 v[48:51], v[152:155], v[124:127], v[48:51]
    ds_read_b128 v[184:187], v10 offset:6144
    v_mfma_f32_16x16x32_bf16 v[52:55], v[152:155], v[128:131], v[52:55]
    ds_read_b128 v[188:191], v10 offset:8192
    v_mfma_f32_16x16x32_bf16 v[56:59], v[152:155], v[132:135], v[56:59]
    ds_read_b64_tr_b16 v[200:201], v13 offset:15520
    v_mfma_f32_16x16x32_bf16 v[60:63], v[152:155], v[136:139], v[60:63]
    ds_read_b64_tr_b16 v[202:203], v13 offset:23200
    v_mfma_f32_16x16x32_bf16 v[64:67], v[152:155], v[140:143], v[64:67]
    ds_read_b64_tr_b16 v[204:205], v13 offset:15680
    s_waitcnt lgkmcnt(15)
    v_mfma_f32_16x16x32_bf16 v[68:71], v[124:127], v[156:159], v[68:71]
    ds_read_b64_tr_b16 v[206:207], v13 offset:23360
    v_mfma_f32_16x16x32_bf16 v[72:75], v[128:131], v[156:159], v[72:75]
    ds_read_b128 v[192:195], v12
    v_mfma_f32_16x16x32_bf16 v[76:79], v[132:135], v[156:159], v[76:79]
    ds_read_b64_tr_b16 v[208:209], v14 offset:15360
    v_mfma_f32_16x16x32_bf16 v[80:83], v[136:139], v[156:159], v[80:83]
    ds_read_b64_tr_b16 v[210:211], v14 offset:23040
    v_mfma_f32_16x16x32_bf16 v[84:87], v[140:143], v[156:159], v[84:87]
    ds_read_b64_tr_b16 v[212:213], v14 offset:15520
    v_mfma_f32_16x16x32_bf16 v[112:115], v[124:127], v[124:127], v[112:115]
    ds_read_b64_tr_b16 v[214:215], v14 offset:23200
    v_mfma_f32_16x16x32_bf16 v[116:119], v[144:147], v[144:147], v[116:119]
    ds_read_b64_tr_b16 v[216:217], v14 offset:15680
    v_mfma_f32_16x16x32_bf16 v[120:123], v[124:127], v[144:147], v[120:123]
    ds_read_b64_tr_b16 v[218:219], v14 offset:23360
    s_waitcnt lgkmcnt(15)
    v_mfma_f32_16x16x32_bf16 v[88:91], v[160:163], v[144:147], v[88:91]
    v_mfma_f32_16x16x32_bf16 v[100:103], v[160:163], v[124:127], v[100:103]
    v_mfma_f32_16x16x32_bf16 v[92:95], v[164:167], v[144:147], v[92:95]
    v_mfma_f32_16x16x32_bf16 v[104:107], v[164:167], v[124:127], v[104:107]
    v_mfma_f32_16x16x32_bf16 v[96:99], v[144:147], v[168:171], v[96:99]
    v_mfma_f32_16x16x32_bf16 v[108:111], v[124:127], v[168:171], v[108:111]
    v_mfma_f32_16x16x32_bf16 v[28:31], v[196:199], v[172:175], v[28:31]
    s_waitcnt lgkmcnt(14)
    v_mfma_f32_16x16x32_bf16 v[32:35], v[196:199], v[176:179], v[32:35]
    s_waitcnt lgkmcnt(13)
    v_mfma_f32_16x16x32_bf16 v[36:39], v[196:199], v[180:183], v[36:39]
    s_waitcnt lgkmcnt(0)
    s_barrier
    v_add_u32 v9, 122880, v3
    v_add_u32 v10, 122880, v4
    v_add_u32 v11, 122880, v5
    v_add_u32 v12, 122880, v6
    v_add_u32 v13, 122880, v7
    v_add_u32 v14, 122880, v8
    v_mfma_f32_16x16x32_bf16 v[40:43], v[196:199], v[184:187], v[40:43]
    ds_read_b64_tr_b16 v[148:149], v13 offset:0
    v_mfma_f32_16x16x32_bf16 v[44:47], v[196:199], v[188:191], v[44:47]
    ds_read_b64_tr_b16 v[150:151], v13 offset:7680
    v_mfma_f32_16x16x32_bf16 v[48:51], v[200:203], v[172:175], v[48:51]
    ds_read_b128 v[124:127], v9 offset:0
    v_mfma_f32_16x16x32_bf16 v[52:55], v[200:203], v[176:179], v[52:55]
    ds_read_b128 v[128:131], v9 offset:2048
    v_mfma_f32_16x16x32_bf16 v[56:59], v[200:203], v[180:183], v[56:59]
    ds_read_b128 v[132:135], v9 offset:4096
    v_mfma_f32_16x16x32_bf16 v[60:63], v[200:203], v[184:187], v[60:63]
    ds_read_b128 v[136:139], v9 offset:6144
    v_mfma_f32_16x16x32_bf16 v[64:67], v[200:203], v[188:191], v[64:67]
    ds_read_b128 v[140:143], v9 offset:8192
    v_mfma_f32_16x16x32_bf16 v[68:71], v[172:175], v[204:207], v[68:71]
    ds_read_b64_tr_b16 v[152:153], v13 offset:160
    v_mfma_f32_16x16x32_bf16 v[72:75], v[176:179], v[204:207], v[72:75]
    ds_read_b64_tr_b16 v[154:155], v13 offset:7840
    v_mfma_f32_16x16x32_bf16 v[76:79], v[180:183], v[204:207], v[76:79]
    ds_read_b64_tr_b16 v[156:157], v13 offset:320
    v_mfma_f32_16x16x32_bf16 v[80:83], v[184:187], v[204:207], v[80:83]
    ds_read_b64_tr_b16 v[158:159], v13 offset:8000
    v_mfma_f32_16x16x32_bf16 v[84:87], v[188:191], v[204:207], v[84:87]
    ds_read_b128 v[144:147], v11
    v_mfma_f32_16x16x32_bf16 v[112:115], v[172:175], v[172:175], v[112:115]
    ds_read_b64_tr_b16 v[160:161], v14 offset:0
    v_mfma_f32_16x16x32_bf16 v[116:119], v[192:195], v[192:195], v[116:119]
    ds_read_b64_tr_b16 v[162:163], v14 offset:7680
    v_mfma_f32_16x16x32_bf16 v[120:123], v[172:175], v[192:195], v[120:123]
    ds_read_b64_tr_b16 v[164:165], v14 offset:160
    v_mfma_f32_16x16x32_bf16 v[88:91], v[208:211], v[192:195], v[88:91]
    ds_read_b64_tr_b16 v[166:167], v14 offset:7840
    v_mfma_f32_16x16x32_bf16 v[100:103], v[208:211], v[172:175], v[100:103]
    ds_read_b64_tr_b16 v[168:169], v14 offset:320
    v_mfma_f32_16x16x32_bf16 v[92:95], v[212:215], v[192:195], v[92:95]
    ds_read_b64_tr_b16 v[170:171], v14 offset:8000
    v_mfma_f32_16x16x32_bf16 v[104:107], v[212:215], v[172:175], v[104:107]
    v_mfma_f32_16x16x32_bf16 v[96:99], v[192:195], v[216:219], v[96:99]
    v_mfma_f32_16x16x32_bf16 v[108:111], v[172:175], v[216:219], v[108:111]
    s_waitcnt lgkmcnt(15)
    v_mfma_f32_16x16x32_bf16 v[28:31], v[148:151], v[124:127], v[28:31]
    ds_read_b64_tr_b16 v[196:197], v13 offset:15360
    s_waitcnt lgkmcnt(15)
    v_mfma_f32_16x16x32_bf16 v[32:35], v[148:151], v[128:131], v[32:35]
    ds_read_b64_tr_b16 v[198:199], v13 offset:23040
    s_waitcnt lgkmcnt(15)
    v_mfma_f32_16x16x32_bf16 v[36:39], v[148:151], v[132:135], v[36:39]
    ds_read_b128 v[172:175], v10 offset:0
    s_waitcnt lgkmcnt(15)
    v_mfma_f32_16x16x32_bf16 v[40:43], v[148:151], v[136:139], v[40:43]
    ds_read_b128 v[176:179], v10 offset:2048
    s_waitcnt lgkmcnt(15)
    v_mfma_f32_16x16x32_bf16 v[44:47], v[148:151], v[140:143], v[44:47]
    ds_read_b128 v[180:183], v10 offset:4096
    s_waitcnt lgkmcnt(14)
    v_mfma_f32_16x16x32_bf16 v[48:51], v[152:155], v[124:127], v[48:51]
    ds_read_b128 v[184:187], v10 offset:6144
    v_mfma_f32_16x16x32_bf16 v[52:55], v[152:155], v[128:131], v[52:55]
    ds_read_b128 v[188:191], v10 offset:8192
    v_mfma_f32_16x16x32_bf16 v[56:59], v[152:155], v[132:135], v[56:59]
    ds_read_b64_tr_b16 v[200:201], v13 offset:15520
    v_mfma_f32_16x16x32_bf16 v[60:63], v[152:155], v[136:139], v[60:63]
    ds_read_b64_tr_b16 v[202:203], v13 offset:23200
    v_mfma_f32_16x16x32_bf16 v[64:67], v[152:155], v[140:143], v[64:67]
    ds_read_b64_tr_b16 v[204:205], v13 offset:15680
    s_waitcnt lgkmcnt(15)
    v_mfma_f32_16x16x32_bf16 v[68:71], v[124:127], v[156:159], v[68:71]
    ds_read_b64_tr_b16 v[206:207], v13 offset:23360
    v_mfma_f32_16x16x32_bf16 v[72:75], v[128:131], v[156:159], v[72:75]
    ds_read_b128 v[192:195], v12
    v_mfma_f32_16x16x32_bf16 v[76:79], v[132:135], v[156:159], v[76:79]
    ds_read_b64_tr_b16 v[208:209], v14 offset:15360
    v_mfma_f32_16x16x32_bf16 v[80:83], v[136:139], v[156:159], v[80:83]
    ds_read_b64_tr_b16 v[210:211], v14 offset:23040
    v_mfma_f32_16x16x32_bf16 v[84:87], v[140:143], v[156:159], v[84:87]
    ds_read_b64_tr_b16 v[212:213], v14 offset:15520
    v_mfma_f32_16x16x32_bf16 v[112:115], v[124:127], v[124:127], v[112:115]
    ds_read_b64_tr_b16 v[214:215], v14 offset:23200
    v_mfma_f32_16x16x32_bf16 v[116:119], v[144:147], v[144:147], v[116:119]
    ds_read_b64_tr_b16 v[216:217], v14 offset:15680
    v_mfma_f32_16x16x32_bf16 v[120:123], v[124:127], v[144:147], v[120:123]
    ds_read_b64_tr_b16 v[218:219], v14 offset:23360
    s_waitcnt lgkmcnt(15)
    v_mfma_f32_16x16x32_bf16 v[88:91], v[160:163], v[144:147], v[88:91]
    v_mfma_f32_16x16x32_bf16 v[100:103], v[160:163], v[124:127], v[100:103]
    v_mfma_f32_16x16x32_bf16 v[92:95], v[164:167], v[144:147], v[92:95]
    v_mfma_f32_16x16x32_bf16 v[104:107], v[164:167], v[124:127], v[104:107]
    v_mfma_f32_16x16x32_bf16 v[96:99], v[144:147], v[168:171], v[96:99]
    v_mfma_f32_16x16x32_bf16 v[108:111], v[124:127], v[168:171], v[108:111]
    v_mfma_f32_16x16x32_bf16 v[28:31], v[196:199], v[172:175], v[28:31]
    s_waitcnt lgkmcnt(14)
    v_mfma_f32_16x16x32_bf16 v[32:35], v[196:199], v[176:179], v[32:35]
    s_waitcnt lgkmcnt(13)
    v_mfma_f32_16x16x32_bf16 v[36:39], v[196:199], v[180:183], v[36:39]
    s_waitcnt lgkmcnt(12)
    v_mfma_f32_16x16x32_bf16 v[40:43], v[196:199], v[184:187], v[40:43]
    s_waitcnt lgkmcnt(11)
    v_mfma_f32_16x16x32_bf16 v[44:47], v[196:199], v[188:191], v[44:47]
    s_waitcnt lgkmcnt(9)
    v_mfma_f32_16x16x32_bf16 v[48:51], v[200:203], v[172:175], v[48:51]
    v_mfma_f32_16x16x32_bf16 v[52:55], v[200:203], v[176:179], v[52:55]
    v_mfma_f32_16x16x32_bf16 v[56:59], v[200:203], v[180:183], v[56:59]
    v_mfma_f32_16x16x32_bf16 v[60:63], v[200:203], v[184:187], v[60:63]
    v_mfma_f32_16x16x32_bf16 v[64:67], v[200:203], v[188:191], v[64:67]
    s_waitcnt lgkmcnt(7)
    v_mfma_f32_16x16x32_bf16 v[68:71], v[172:175], v[204:207], v[68:71]
    v_mfma_f32_16x16x32_bf16 v[72:75], v[176:179], v[204:207], v[72:75]
    v_mfma_f32_16x16x32_bf16 v[76:79], v[180:183], v[204:207], v[76:79]
    v_mfma_f32_16x16x32_bf16 v[80:83], v[184:187], v[204:207], v[80:83]
    v_mfma_f32_16x16x32_bf16 v[84:87], v[188:191], v[204:207], v[84:87]
    v_mfma_f32_16x16x32_bf16 v[112:115], v[172:175], v[172:175], v[112:115]
    s_waitcnt lgkmcnt(6)
    v_mfma_f32_16x16x32_bf16 v[116:119], v[192:195], v[192:195], v[116:119]
    v_mfma_f32_16x16x32_bf16 v[120:123], v[172:175], v[192:195], v[120:123]
    s_waitcnt lgkmcnt(4)
    v_mfma_f32_16x16x32_bf16 v[88:91], v[208:211], v[192:195], v[88:91]
    v_mfma_f32_16x16x32_bf16 v[100:103], v[208:211], v[172:175], v[100:103]
    s_waitcnt lgkmcnt(2)
    v_mfma_f32_16x16x32_bf16 v[92:95], v[212:215], v[192:195], v[92:95]
    v_mfma_f32_16x16x32_bf16 v[104:107], v[212:215], v[172:175], v[104:107]
    s_waitcnt lgkmcnt(0)
    v_mfma_f32_16x16x32_bf16 v[96:99], v[192:195], v[216:219], v[96:99]
    v_mfma_f32_16x16x32_bf16 v[108:111], v[172:175], v[216:219], v[108:111]
    v_cndmask_b32 v124, v116, v117, s[42:43]
    v_cndmask_b32 v125, v118, v119, s[42:43]
    v_cndmask_b32 v224, 0, v120, s[46:47]
    v_cndmask_b32 v124, v124, v125, s[44:45]
    v_cndmask_b32 v225, 0, v124, s[40:41]
    v_cndmask_b32 v124, v112, v113, s[42:43]
    v_cndmask_b32 v125, v114, v115, s[42:43]
    v_cndmask_b32 v226, 0, v112, s[46:47]
    v_cndmask_b32 v124, v124, v125, s[44:45]
    v_cndmask_b32 v227, 0, v124, s[40:41]
    v_mov_b32 v124, v224
    v_mov_b32 v125, v225
    v_mov_b32 v126, v226
    v_mov_b32 v127, v227
    v_permlane32_swap_b32 v224, v124
    v_permlane32_swap_b32 v225, v125
    v_permlane32_swap_b32 v226, v126
    v_permlane32_swap_b32 v227, v127
    v_add_f32 v224, v224, v124
    v_add_f32 v225, v225, v125
    v_add_f32 v226, v226, v126
    v_add_f32 v227, v227, v127
    v_mov_b32 v124, v224
    v_mov_b32 v125, v225
    v_mov_b32 v126, v226
    v_mov_b32 v127, v227
    v_permlane16_swap_b32 v224, v124
    v_permlane16_swap_b32 v225, v125
    v_permlane16_swap_b32 v226, v126
    v_permlane16_swap_b32 v227, v127
    v_add_f32 v224, v224, v124
    v_add_f32 v225, v225, v125
    v_add_f32 v226, v226, v126
    v_add_f32 v227, v227, v127
    v_mul_f32 v224, s76, v224
    v_mul_f32 v225, s76, v225
    v_fma_f32 v225, -v224, v224, v225
    v_max_f32 v225, 0, v225
    v_add_f32 v225, s77, v225
    v_rsq_f32 v128, v225
    s_nop 0
    v_mul_f32 v129, -v224, v128
    v_mul_f32 v226, s76, v226
    v_mul_f32 v227, s76, v227
    v_fma_f32 v227, -v226, v226, v227
    v_max_f32 v227, 0, v227
    v_add_f32 v227, s77, v227
    v_rsq_f32 v130, v227
    s_nop 0
    v_mul_f32 v131, -v226, v130
    v_add_u32 v221, s75, v252
    v_add_u32 v222, s75, v253
    v_add_u32 v223, s72, v254
    ds_write2_b32 v221, v128, v129 offset0:0 offset1:16
    ds_write2_b32 v252, v130, v131 offset0:0 offset1:16
    ds_read_b128 v[138:141], v222
    ds_read_b128 v[142:145], v222 offset:64
    ds_read_b128 v[146:149], v253
    ds_read_b128 v[150:153], v253 offset:64
    ds_bpermute_b32 v170, v255, v68
    ds_bpermute_b32 v172, v255, v108
    v_mov_b32_dpp v162, v100 row_newbcast:0 row_mask:0xf bank_mask:0xf
    v_mov_b32_dpp v163, v101 row_newbcast:0 row_mask:0xf bank_mask:0xf
    v_mov_b32_dpp v164, v102 row_newbcast:0 row_mask:0xf bank_mask:0xf
    v_mov_b32_dpp v165, v103 row_newbcast:0 row_mask:0xf bank_mask:0xf
    v_mov_b32_dpp v166, v104 row_newbcast:0 row_mask:0xf bank_mask:0xf
    v_mov_b32_dpp v167, v105 row_newbcast:0 row_mask:0xf bank_mask:0xf
    v_mov_b32_dpp v168, v106 row_newbcast:0 row_mask:0xf bank_mask:0xf
    v_mov_b32_dpp v169, v107 row_newbcast:0 row_mask:0xf bank_mask:0xf
    v_mov_b32_dpp v154, v28 row_newbcast:0 row_mask:0xf bank_mask:0xf
    v_mov_b32_dpp v155, v29 row_newbcast:0 row_mask:0xf bank_mask:0xf
    v_mov_b32_dpp v156, v30 row_newbcast:0 row_mask:0xf bank_mask:0xf
    v_mov_b32_dpp v157, v31 row_newbcast:0 row_mask:0xf bank_mask:0xf
    v_mov_b32_dpp v158, v48 row_newbcast:0 row_mask:0xf bank_mask:0xf
    v_mov_b32_dpp v159, v49 row_newbcast:0 row_mask:0xf bank_mask:0xf
    v_mov_b32_dpp v160, v50 row_newbcast:0 row_mask:0xf bank_mask:0xf
    v_mov_b32_dpp v161, v51 row_newbcast:0 row_mask:0xf bank_mask:0xf
    v_pk_mul_f32 v[228:229], v[162:163], v[128:129] op_sel:[0,1] op_sel_hi:[1,1]
    v_pk_mul_f32 v[230:231], v[164:165], v[128:129] op_sel:[0,1] op_sel_hi:[1,1]
    v_pk_fma_f32 v[88:89], v[88:89], v[128:129], v[228:229] op_sel_hi:[1,0,1]
    v_pk_fma_f32 v[90:91], v[90:91], v[128:129], v[230:231] op_sel_hi:[1,0,1]
    v_cvt_pk_bf16_f32 v132, v88, v89
    v_cvt_pk_bf16_f32 v133, v90, v91
    v_pk_mul_f32 v[228:229], v[166:167], v[128:129] op_sel:[0,1] op_sel_hi:[1,1]
    v_pk_mul_f32 v[230:231], v[168:169], v[128:129] op_sel:[0,1] op_sel_hi:[1,1]
    v_pk_fma_f32 v[92:93], v[92:93], v[128:129], v[228:229] op_sel_hi:[1,0,1]
    v_pk_fma_f32 v[94:95], v[94:95], v[128:129], v[230:231] op_sel_hi:[1,0,1]
    v_cvt_pk_bf16_f32 v134, v92, v93
    v_cvt_pk_bf16_f32 v135, v94, v95
    s_waitcnt lgkmcnt(0)
    v_pk_mul_f32 v[228:229], v[142:143], v[172:173] op_sel_hi:[1,0]
    v_pk_mul_f32 v[230:231], v[144:145], v[172:173] op_sel_hi:[1,0]
    v_pk_fma_f32 v[96:97], v[96:97], v[138:139], v[228:229]
    v_pk_fma_f32 v[98:99], v[98:99], v[140:141], v[230:231]
    v_cvt_pk_bf16_f32 v136, v96, v97
    v_cvt_pk_bf16_f32 v137, v98, v99
    ds_write_b64 v223, v[132:133] offset:1536
    ds_write_b64 v223, v[134:135] offset:4608
    ds_write_b64 v223, v[136:137] offset:7680
    v_pk_mul_f32 v[228:229], v[166:167], v[130:131] op_sel:[0,1] op_sel_hi:[1,1]
    v_pk_mul_f32 v[230:231], v[168:169], v[130:131] op_sel:[0,1] op_sel_hi:[1,1]
    v_pk_fma_f32 v[104:105], v[104:105], v[130:131], v[228:229] op_sel_hi:[1,0,1]
    v_pk_fma_f32 v[106:107], v[106:107], v[130:131], v[230:231] op_sel_hi:[1,0,1]
    v_cvt_pk_bf16_f32 v192, v104, v105
    v_cvt_pk_bf16_f32 v193, v106, v107
    v_pk_mul_f32 v[228:229], v[150:151], v[172:173] op_sel_hi:[1,0]
    v_pk_mul_f32 v[230:231], v[152:153], v[172:173] op_sel_hi:[1,0]
    v_pk_fma_f32 v[108:109], v[108:109], v[146:147], v[228:229]
    v_pk_fma_f32 v[110:111], v[110:111], v[148:149], v[230:231]
    v_cvt_pk_bf16_f32 v242, v108, v109
    v_cvt_pk_bf16_f32 v243, v110, v111
    v_pk_mul_f32 v[228:229], v[158:159], v[130:131] op_sel:[0,1] op_sel_hi:[1,1]
    v_pk_mul_f32 v[230:231], v[160:161], v[130:131] op_sel:[0,1] op_sel_hi:[1,1]
    v_pk_fma_f32 v[48:49], v[48:49], v[130:131], v[228:229] op_sel_hi:[1,0,1]
    v_pk_fma_f32 v[50:51], v[50:51], v[130:131], v[230:231] op_sel_hi:[1,0,1]
    v_cvt_pk_bf16_f32 v190, v48, v49
    v_cvt_pk_bf16_f32 v191, v50, v51
    v_pk_mul_f32 v[228:229], v[150:151], v[170:171] op_sel_hi:[1,0]
    v_pk_mul_f32 v[230:231], v[152:153], v[170:171] op_sel_hi:[1,0]
    v_pk_fma_f32 v[68:69], v[68:69], v[146:147], v[228:229]
    v_pk_fma_f32 v[70:71], v[70:71], v[148:149], v[230:231]
    v_cvt_pk_bf16_f32 v232, v68, v69
    v_cvt_pk_bf16_f32 v233, v70, v71
    s_waitcnt lgkmcnt(0)
    v_mov_b32 v228, 122848
    v_mov_b32 v229, 1
    s_mov_b64 exec, 1
    ds_add_u32 v228, v229 offset:16
    s_mov_b64 exec, -1
    s_mov_b32 s96, 0
L_bac:
    ds_read_b32 v229, v228 offset:16
    s_add_u32 s96, s96, 1
    s_waitcnt lgkmcnt(0)
    v_readfirstlane_b32 s97, v229
    s_cmp_ge_u32 s96, 1600000
    s_cbranch_scc1 L_end
    s_cmp_lt_u32 s97, 4
    s_cbranch_scc1 L_bac
    ds_read2_b32 v[210:211], v252 offset0:32 offset1:48
    ds_read2_b32 v[212:213], v252 offset0:64 offset1:80
    ds_read2_b32 v[214:215], v252 offset0:96 offset1:112
    ds_read2_b32 v[216:217], v252 offset0:128 offset1:144
    ds_read_b128 v[138:141], v253 offset:128
    ds_read_b128 v[142:145], v253 offset:192
    ds_read_b64 v[176:177], v254 offset:1536
    ds_read_b64 v[196:197], v254 offset:4608
    ds_read_b64 v[180:181], v254 offset:2048
    ds_read_b64 v[200:201], v254 offset:5120
    ds_read_b64 v[184:185], v254 offset:2560
    ds_read_b64 v[204:205], v254 offset:5632
    ds_read_b64 v[188:189], v254 offset:3072
    ds_read_b64 v[208:209], v254 offset:6144
    ds_read_b128 v[146:149], v253 offset:256
    ds_read_b128 v[150:153], v253 offset:320
    ds_read_b64 v[244:245], v254 offset:7680
    s_waitcnt lgkmcnt(15)
    v_pk_mul_f32 v[228:229], v[154:155], v[210:211] op_sel:[0,1] op_sel_hi:[1,1]
    v_pk_mul_f32 v[230:231], v[156:157], v[210:211] op_sel:[0,1] op_sel_hi:[1,1]
    v_pk_fma_f32 v[32:33], v[32:33], v[210:211], v[228:229] op_sel_hi:[1,0,1]
    v_pk_fma_f32 v[34:35], v[34:35], v[210:211], v[230:231] op_sel_hi:[1,0,1]
    v_cvt_pk_bf16_f32 v174, v32, v33
    v_cvt_pk_bf16_f32 v175, v34, v35
    v_pk_mul_f32 v[228:229], v[158:159], v[210:211] op_sel:[0,1] op_sel_hi:[1,1]
    v_pk_mul_f32 v[230:231], v[160:161], v[210:211] op_sel:[0,1] op_sel_hi:[1,1]
    v_pk_fma_f32 v[52:53], v[52:53], v[210:211], v[228:229] op_sel_hi:[1,0,1]
    v_pk_fma_f32 v[54:55], v[54:55], v[210:211], v[230:231] op_sel_hi:[1,0,1]
    v_cvt_pk_bf16_f32 v194, v52, v53
    v_cvt_pk_bf16_f32 v195, v54, v55
    s_waitcnt lgkmcnt(11)
    v_pk_mul_f32 v[228:229], v[142:143], v[170:171] op_sel_hi:[1,0]
    v_pk_mul_f32 v[230:231], v[144:145], v[170:171] op_sel_hi:[1,0]
    v_pk_fma_f32 v[72:73], v[72:73], v[138:139], v[228:229]
    v_pk_fma_f32 v[74:75], v[74:75], v[140:141], v[230:231]
    v_cvt_pk_bf16_f32 v234, v72, v73
    v_cvt_pk_bf16_f32 v235, v74, v75
    ds_read_b128 v[138:141], v253 offset:384
    ds_read_b128 v[142:145], v253 offset:448
    ds_read_b64 v[246:247], v254 offset:8192
    v_pk_mul_f32 v[228:229], v[154:155], v[212:213] op_sel:[0,1] op_sel_hi:[1,1]
    v_pk_mul_f32 v[230:231], v[156:157], v[212:213] op_sel:[0,1] op_sel_hi:[1,1]
    v_pk_fma_f32 v[36:37], v[36:37], v[212:213], v[228:229] op_sel_hi:[1,0,1]
    v_pk_fma_f32 v[38:39], v[38:39], v[212:213], v[230:231] op_sel_hi:[1,0,1]
    v_cvt_pk_bf16_f32 v178, v36, v37
    v_cvt_pk_bf16_f32 v179, v38, v39
    v_pk_mul_f32 v[228:229], v[158:159], v[212:213] op_sel:[0,1] op_sel_hi:[1,1]
    v_pk_mul_f32 v[230:231], v[160:161], v[212:213] op_sel:[0,1] op_sel_hi:[1,1]
    v_pk_fma_f32 v[56:57], v[56:57], v[212:213], v[228:229] op_sel_hi:[1,0,1]
    v_pk_fma_f32 v[58:59], v[58:59], v[212:213], v[230:231] op_sel_hi:[1,0,1]
    v_cvt_pk_bf16_f32 v198, v56, v57
    v_cvt_pk_bf16_f32 v199, v58, v59
    s_waitcnt lgkmcnt(4)
    v_pk_mul_f32 v[228:229], v[150:151], v[170:171] op_sel_hi:[1,0]
    v_pk_mul_f32 v[230:231], v[152:153], v[170:171] op_sel_hi:[1,0]
    v_pk_fma_f32 v[76:77], v[76:77], v[146:147], v[228:229]
    v_pk_fma_f32 v[78:79], v[78:79], v[148:149], v[230:231]
    v_cvt_pk_bf16_f32 v236, v76, v77
    v_cvt_pk_bf16_f32 v237, v78, v79
    ds_read_b128 v[146:149], v253 offset:512
    ds_read_b128 v[150:153], v253 offset:576
    ds_read_b64 v[248:249], v254 offset:8704
    v_pk_mul_f32 v[228:229], v[154:155], v[214:215] op_sel:[0,1] op_sel_hi:[1,1]
    v_pk_mul_f32 v[230:231], v[156:157], v[214:215] op_sel:[0,1] op_sel_hi:[1,1]
    v_pk_fma_f32 v[40:41], v[40:41], v[214:215], v[228:229] op_sel_hi:[1,0,1]
    v_pk_fma_f32 v[42:43], v[42:43], v[214:215], v[230:231] op_sel_hi:[1,0,1]
    v_cvt_pk_bf16_f32 v182, v40, v41
    v_cvt_pk_bf16_f32 v183, v42, v43
    v_pk_mul_f32 v[228:229], v[158:159], v[214:215] op_sel:[0,1] op_sel_hi:[1,1]
    v_pk_mul_f32 v[230:231], v[160:161], v[214:215] op_sel:[0,1] op_sel_hi:[1,1]
    v_pk_fma_f32 v[60:61], v[60:61], v[214:215], v[228:229] op_sel_hi:[1,0,1]
    v_pk_fma_f32 v[62:63], v[62:63], v[214:215], v[230:231] op_sel_hi:[1,0,1]
    v_cvt_pk_bf16_f32 v202, v60, v61
    v_cvt_pk_bf16_f32 v203, v62, v63
    s_waitcnt lgkmcnt(4)
    v_pk_mul_f32 v[228:229], v[142:143], v[170:171] op_sel_hi:[1,0]
    v_pk_mul_f32 v[230:231], v[144:145], v[170:171] op_sel_hi:[1,0]
    v_pk_fma_f32 v[80:81], v[80:81], v[138:139], v[228:229]
    v_pk_fma_f32 v[82:83], v[82:83], v[140:141], v[230:231]
    v_cvt_pk_bf16_f32 v238, v80, v81
    v_cvt_pk_bf16_f32 v239, v82, v83
    ds_read_b64 v[250:251], v254 offset:9216
    v_pk_mul_f32 v[228:229], v[154:155], v[216:217] op_sel:[0,1] op_sel_hi:[1,1]
    v_pk_mul_f32 v[230:231], v[156:157], v[216:217] op_sel:[0,1] op_sel_hi:[1,1]
    v_pk_fma_f32 v[44:45], v[44:45], v[216:217], v[228:229] op_sel_hi:[1,0,1]
    v_pk_fma_f32 v[46:47], v[46:47], v[216:217], v[230:231] op_sel_hi:[1,0,1]
    v_cvt_pk_bf16_f32 v186, v44, v45
    v_cvt_pk_bf16_f32 v187, v46, v47
    v_pk_mul_f32 v[228:229], v[158:159], v[216:217] op_sel:[0,1] op_sel_hi:[1,1]
    v_pk_mul_f32 v[230:231], v[160:161], v[216:217] op_sel:[0,1] op_sel_hi:[1,1]
    v_pk_fma_f32 v[64:65], v[64:65], v[216:217], v[228:229] op_sel_hi:[1,0,1]
    v_pk_fma_f32 v[66:67], v[66:67], v[216:217], v[230:231] op_sel_hi:[1,0,1]
    v_cvt_pk_bf16_f32 v206, v64, v65
    v_cvt_pk_bf16_f32 v207, v66, v67
    s_waitcnt lgkmcnt(2)
    v_pk_mul_f32 v[228:229], v[150:151], v[170:171] op_sel_hi:[1,0]
    v_pk_mul_f32 v[230:231], v[152:153], v[170:171] op_sel_hi:[1,0]
    v_pk_fma_f32 v[84:85], v[84:85], v[146:147], v[228:229]
    v_pk_fma_f32 v[86:87], v[86:87], v[148:149], v[230:231]
    v_cvt_pk_bf16_f32 v240, v84, v85
    v_cvt_pk_bf16_f32 v241, v86, v87
    v_cndmask_b32 v192, 0, v192, s[70:71]
    v_cndmask_b32 v193, 0, v193, s[70:71]
    v_cndmask_b32 v196, 0, v196, s[70:71]
    v_cndmask_b32 v197, 0, v197, s[70:71]
    v_cndmask_b32 v200, 0, v200, s[70:71]
    v_cndmask_b32 v201, 0, v201, s[70:71]
    v_cndmask_b32 v204, 0, v204, s[70:71]
    v_cndmask_b32 v205, 0, v205, s[70:71]
    v_cndmask_b32 v208, 0, v208, s[70:71]
    v_cndmask_b32 v209, 0, v209, s[70:71]
    v_mfma_f32_16x16x32_bf16 v[28:31], v[190:193], v[174:177], v[24:27]
    v_mfma_f32_16x16x32_bf16 v[32:35], v[194:197], v[174:177], v[16:19]
    v_mfma_f32_16x16x32_bf16 v[36:39], v[194:197], v[178:181], v[20:23]
    v_mfma_f32_16x16x32_bf16 v[40:43], v[198:201], v[178:181], v[16:19]
    v_mfma_f32_16x16x32_bf16 v[44:47], v[198:201], v[182:185], v[20:23]
    v_mfma_f32_16x16x32_bf16 v[48:51], v[202:205], v[182:185], v[16:19]
    v_mfma_f32_16x16x32_bf16 v[52:55], v[202:205], v[186:189], v[20:23]
    v_mfma_f32_16x16x32_bf16 v[56:59], v[206:209], v[186:189], v[16:19]
    v_bfe_u32 v220, v0, 4, 1
    v_mul_u32_u24 v220, 20480, v220
    v_lshrrev_b32 v221, 5, v0
    v_lshl_add_u32 v220, v221, 8, v220
    v_and_b32 v221, 15, v0
    v_lshl_add_u32 v220, v221, 4, v220
    v_max3_f32 v60, v28, v29, v30
    v_max3_f32 v61, v31, v32, v33
    v_max3_f32 v60, v60, v34, v35
    v_max_f32 v60, v60, v61
    v_max3_f32 v62, v36, v37, v38
    v_max3_f32 v63, v39, v40, v41
    v_max3_f32 v62, v62, v42, v43
    v_max_f32 v62, v62, v63
    v_max3_f32 v64, v44, v45, v46
    v_max3_f32 v65, v47, v48, v49
    v_max3_f32 v64, v64, v50, v51
    v_max_f32 v64, v64, v65
    v_max3_f32 v66, v52, v53, v54
    v_max3_f32 v67, v55, v56, v57
    v_max3_f32 v66, v66, v58, v59
    v_max_f32 v66, v66, v67
    v_mov_b32 v61, v60
    v_mov_b32 v63, v62
    v_mov_b32 v65, v64
    v_mov_b32 v67, v66
    v_permlane32_swap_b32 v60, v61
    v_permlane32_swap_b32 v62, v63
    v_permlane32_swap_b32 v64, v65
    v_permlane32_swap_b32 v66, v67
    v_max_f32 v60, v60, v61
    v_max_f32 v62, v62, v63
    v_max_f32 v64, v64, v65
    v_max_f32 v66, v66, v67
    v_mov_b32 v61, v60
    v_mov_b32 v63, v62
    v_mov_b32 v65, v64
    v_mov_b32 v67, v66
    v_permlane16_swap_b32 v60, v61
    v_permlane16_swap_b32 v62, v63
    v_permlane16_swap_b32 v64, v65
    v_permlane16_swap_b32 v66, v67
    v_max_f32 v60, v60, v61
    v_max_f32 v62, v62, v63
    v_max_f32 v64, v64, v65
    v_max_f32 v66, v66, v67
    v_mul_f32 v60, -s68, v60
    v_mul_f32 v62, -s68, v62
    v_mul_f32 v64, -s68, v64
    v_mul_f32 v66, -s68, v66
    v_pk_fma_f32 v[28:29], v[28:29], s[68:69], v[60:61] op_sel_hi:[1,1,0]
    v_pk_fma_f32 v[30:31], v[30:31], s[68:69], v[60:61] op_sel_hi:[1,1,0]
    v_pk_fma_f32 v[32:33], v[32:33], s[68:69], v[60:61] op_sel_hi:[1,1,0]
    v_pk_fma_f32 v[34:35], v[34:35], s[68:69], v[60:61] op_sel_hi:[1,1,0]
    v_exp_f32 v28, v28
    v_exp_f32 v29, v29
    v_exp_f32 v30, v30
    v_exp_f32 v31, v31
    v_exp_f32 v32, v32
    v_exp_f32 v33, v33
    v_exp_f32 v34, v34
    v_exp_f32 v35, v35
    v_cvt_pk_bf16_f32 v138, v28, v29
    v_cvt_pk_bf16_f32 v139, v30, v31
    v_cvt_pk_bf16_f32 v140, v32, v33
    v_cvt_pk_bf16_f32 v141, v34, v35
    v_pk_add_f32 v[28:29], v[28:29], v[30:31]
    v_pk_add_f32 v[32:33], v[32:33], v[34:35]
    v_mfma_f32_16x16x32_bf16 v[76:79], v[232:235], v[138:141], 0
    v_pk_add_f32 v[28:29], v[28:29], v[32:33]
    v_mfma_f32_16x16x32_bf16 v[80:83], v[242:245], v[138:141], 0
    v_add_f32 v68, v28, v29
    v_pk_fma_f32 v[36:37], v[36:37], s[68:69], v[62:63] op_sel_hi:[1,1,0]
    v_pk_fma_f32 v[38:39], v[38:39], s[68:69], v[62:63] op_sel_hi:[1,1,0]
    v_pk_fma_f32 v[40:41], v[40:41], s[68:69], v[62:63] op_sel_hi:[1,1,0]
    v_pk_fma_f32 v[42:43], v[42:43], s[68:69], v[62:63] op_sel_hi:[1,1,0]
    v_exp_f32 v36, v36
    v_exp_f32 v37, v37
    v_exp_f32 v38, v38
    v_exp_f32 v39, v39
    v_exp_f32 v40, v40
    v_exp_f32 v41, v41
    v_exp_f32 v42, v42
    v_exp_f32 v43, v43
    v_cvt_pk_bf16_f32 v142, v36, v37
    v_cvt_pk_bf16_f32 v143, v38, v39
    v_cvt_pk_bf16_f32 v144, v40, v41
    v_cvt_pk_bf16_f32 v145, v42, v43
    v_pk_add_f32 v[36:37], v[36:37], v[38:39]
    v_pk_add_f32 v[40:41], v[40:41], v[42:43]
    v_mfma_f32_16x16x32_bf16 v[84:87], v[234:237], v[142:145], 0
    v_pk_add_f32 v[36:37], v[36:37], v[40:41]
    v_mfma_f32_16x16x32_bf16 v[88:91], v[244:247], v[142:145], 0
    v_add_f32 v70, v36, v37
    v_pk_fma_f32 v[44:45], v[44:45], s[68:69], v[64:65] op_sel_hi:[1,1,0]
    v_pk_fma_f32 v[46:47], v[46:47], s[68:69], v[64:65] op_sel_hi:[1,1,0]
    v_pk_fma_f32 v[48:49], v[48:49], s[68:69], v[64:65] op_sel_hi:[1,1,0]
    v_pk_fma_f32 v[50:51], v[50:51], s[68:69], v[64:65] op_sel_hi:[1,1,0]
    v_exp_f32 v44, v44
    v_exp_f32 v45, v45
    v_exp_f32 v46, v46
    v_exp_f32 v47, v47
    v_exp_f32 v48, v48
    v_exp_f32 v49, v49
    v_exp_f32 v50, v50
    v_exp_f32 v51, v51
    v_cvt_pk_bf16_f32 v146, v44, v45
    v_cvt_pk_bf16_f32 v147, v46, v47
    v_cvt_pk_bf16_f32 v148, v48, v49
    v_cvt_pk_bf16_f32 v149, v50, v51
    v_pk_add_f32 v[44:45], v[44:45], v[46:47]
    v_pk_add_f32 v[48:49], v[48:49], v[50:51]
    v_mfma_f32_16x16x32_bf16 v[92:95], v[236:239], v[146:149], 0
    v_pk_add_f32 v[44:45], v[44:45], v[48:49]
    s_waitcnt lgkmcnt(1)
    v_mfma_f32_16x16x32_bf16 v[96:99], v[246:249], v[146:149], 0
    v_add_f32 v72, v44, v45
    v_pk_fma_f32 v[52:53], v[52:53], s[68:69], v[66:67] op_sel_hi:[1,1,0]
    v_pk_fma_f32 v[54:55], v[54:55], s[68:69], v[66:67] op_sel_hi:[1,1,0]
    v_pk_fma_f32 v[56:57], v[56:57], s[68:69], v[66:67] op_sel_hi:[1,1,0]
    v_pk_fma_f32 v[58:59], v[58:59], s[68:69], v[66:67] op_sel_hi:[1,1,0]
    v_exp_f32 v52, v52
    v_exp_f32 v53, v53
    v_exp_f32 v54, v54
    v_exp_f32 v55, v55
    v_exp_f32 v56, v56
    v_exp_f32 v57, v57
    v_exp_f32 v58, v58
    v_exp_f32 v59, v59
    v_cvt_pk_bf16_f32 v150, v52, v53
    v_cvt_pk_bf16_f32 v151, v54, v55
    v_cvt_pk_bf16_f32 v152, v56, v57
    v_cvt_pk_bf16_f32 v153, v58, v59
    v_pk_add_f32 v[52:53], v[52:53], v[54:55]
    v_pk_add_f32 v[56:57], v[56:57], v[58:59]
    v_mfma_f32_16x16x32_bf16 v[100:103], v[238:241], v[150:153], 0
    v_pk_add_f32 v[52:53], v[52:53], v[56:57]
    s_waitcnt lgkmcnt(0)
    v_mfma_f32_16x16x32_bf16 v[104:107], v[248:251], v[150:153], 0
    v_add_f32 v74, v52, v53
    v_mov_b32 v69, v68
    v_mov_b32 v71, v70
    v_mov_b32 v73, v72
    v_mov_b32 v75, v74
    v_permlane32_swap_b32 v68, v69
    v_permlane32_swap_b32 v70, v71
    v_permlane32_swap_b32 v72, v73
    v_permlane32_swap_b32 v74, v75
    v_add_f32 v68, v68, v69
    v_add_f32 v70, v70, v71
    v_add_f32 v72, v72, v73
    v_add_f32 v74, v74, v75
    v_mov_b32 v69, v68
    v_mov_b32 v71, v70
    v_mov_b32 v73, v72
    v_mov_b32 v75, v74
    v_permlane16_swap_b32 v68, v69
    v_permlane16_swap_b32 v70, v71
    v_permlane16_swap_b32 v72, v73
    v_permlane16_swap_b32 v74, v75
    v_add_f32 v68, v68, v69
    v_add_f32 v70, v70, v71
    v_add_f32 v72, v72, v73
    v_add_f32 v74, v74, v75
    v_rcp_f32 v68, v68
    v_rcp_f32 v70, v70
    v_rcp_f32 v72, v72
    v_rcp_f32 v74, v74
    v_pk_mul_f32 v[76:77], v[76:77], v[68:69] op_sel_hi:[1,0]
    v_pk_mul_f32 v[78:79], v[78:79], v[68:69] op_sel_hi:[1,0]
    v_pk_mul_f32 v[80:81], v[80:81], v[68:69] op_sel_hi:[1,0]
    v_pk_mul_f32 v[82:83], v[82:83], v[68:69] op_sel_hi:[1,0]
    v_cvt_pk_bf16_f32 v138, v76, v77
    v_cvt_pk_bf16_f32 v139, v78, v79
    v_cvt_pk_bf16_f32 v146, v80, v81
    v_cvt_pk_bf16_f32 v147, v82, v83
    v_pk_mul_f32 v[84:85], v[84:85], v[70:71] op_sel_hi:[1,0]
    v_pk_mul_f32 v[86:87], v[86:87], v[70:71] op_sel_hi:[1,0]
    v_pk_mul_f32 v[88:89], v[88:89], v[70:71] op_sel_hi:[1,0]
    v_pk_mul_f32 v[90:91], v[90:91], v[70:71] op_sel_hi:[1,0]
    v_cvt_pk_bf16_f32 v140, v84, v85
    v_cvt_pk_bf16_f32 v141, v86, v87
    v_cvt_pk_bf16_f32 v148, v88, v89
    v_cvt_pk_bf16_f32 v149, v90, v91
    v_permlane16_swap_b32 v138, v140
    v_permlane16_swap_b32 v139, v141
    buffer_store_dwordx4 v[138:141], v220, s[8:11], s66 offen
    s_add_u32 s66, s66, 40960
    v_pk_mul_f32 v[92:93], v[92:93], v[72:73] op_sel_hi:[1,0]
    v_pk_mul_f32 v[94:95], v[94:95], v[72:73] op_sel_hi:[1,0]
    v_pk_mul_f32 v[96:97], v[96:97], v[72:73] op_sel_hi:[1,0]
    v_pk_mul_f32 v[98:99], v[98:99], v[72:73] op_sel_hi:[1,0]
    v_cvt_pk_bf16_f32 v142, v92, v93
    v_cvt_pk_bf16_f32 v143, v94, v95
    v_cvt_pk_bf16_f32 v150, v96, v97
    v_cvt_pk_bf16_f32 v151, v98, v99
    v_pk_mul_f32 v[100:101], v[100:101], v[74:75] op_sel_hi:[1,0]
    v_pk_mul_f32 v[102:103], v[102:103], v[74:75] op_sel_hi:[1,0]
    v_pk_mul_f32 v[104:105], v[104:105], v[74:75] op_sel_hi:[1,0]
    v_pk_mul_f32 v[106:107], v[106:107], v[74:75] op_sel_hi:[1,0]
    v_cvt_pk_bf16_f32 v144, v100, v101
    v_cvt_pk_bf16_f32 v145, v102, v103
    v_cvt_pk_bf16_f32 v152, v104, v105
    v_cvt_pk_bf16_f32 v153, v106, v107
    v_permlane16_swap_b32 v142, v144
    v_permlane16_swap_b32 v143, v145
    buffer_store_dwordx4 v[142:145], v220, s[8:11], s66 offen
    s_add_u32 s66, s66, 40960
    s_mov_b64 exec, s[70:71]
    buffer_store_dwordx2 v[146:147], v2, s[8:11], s67 offen
    s_add_u32 s67, s67, 20480
    buffer_store_dwordx2 v[148:149], v2, s[8:11], s67 offen
    s_add_u32 s67, s67, 20480
    buffer_store_dwordx2 v[150:151], v2, s[8:11], s67 offen
    s_add_u32 s67, s67, 20480
    buffer_store_dwordx2 v[152:153], v2, s[8:11], s67 offen
    s_add_u32 s67, s67, 20480
    s_mov_b64 exec, -1
    s_mul_i32 s37, s31, 20480
    s_add_u32 s38, s37, 10289152
    s_add_u32 s35, s37, 7667712
    v_and_b32 v7, 15, v0
    v_lshrrev_b32 v6, 4, v0
    v_mul_u32_u24 v7, 1280, v7
    v_lshl_add_u32 v7, v6, 4, v7
    s_mul_i32 s39, s30, 5
    s_and_b32 s50, s30, 1
    s_add_u32 s51, s39, s50
    s_lshr_b32 s51, s51, 1
    s_lshl_b32 s40, s51, 10
    s_lshl_b32 s41, s51, 6
    s_add_u32 s51, s39, 4
    s_cmp_eq_u32 s50, 1
    s_cselect_b32 s51, s39, s51
    s_lshr_b32 s51, s51, 1
    s_lshl_b32 s50, s50, 3
    s_lshl_b32 s42, s51, 10
    s_add_u32 s42, s42, s50
    s_lshl_b32 s43, s51, 6
    s_add_u32 s43, s43, s50
    v_add_u32 v3, 61440, v2
    v_add_u32 v4, 122880, v2
    v_lshlrev_b32 v5, 2, v0
    s_lshl_b32 s44, s29, 7
    s_lshl_b32 s45, s31, 10
    s_lshl_b32 s46, s30, 3
    s_add_u32 s45, s45, s46
    s_add_u32 s45, s45, 12910592
    s_mov_b32 s83, 0x3f803f80
    s_add_u32 s12, s4, s37
    s_addc_u32 s13, s5, 0
    s_mov_b32 s14, 20480
    s_mov_b32 s15, 0x20000
    s_add_u32 s16, s64, s38
    s_addc_u32 s17, s65, 0
    s_mov_b32 s18, 20480
    s_mov_b32 s19, 0x20000
    s_add_u32 s20, s64, s45
    s_addc_u32 s21, s65, 0
    s_mov_b32 s22, 1024
    s_mov_b32 s23, 0x20000
    v_mov_b32 v14, s93
    s_waitcnt vmcnt(0)
    s_mov_b64 exec, 1
    s_cmp_eq_u32 s92, 1
    s_cbranch_scc1 L_pubf_84
    buffer_wbl2 sc1
    s_waitcnt vmcnt(0)
    buffer_store_dword v14, v15, s[24:27], s84 offen sc1
    s_branch L_pubd_84
L_pubf_84:
    buffer_store_dword v14, v15, s[24:27], s84 offen
L_pubd_84:
    s_mov_b64 exec, -1
    s_add_u32 s8, s64, s35
    s_addc_u32 s9, s65, 0
    s_mov_b32 s10, 20480
    s_mov_b32 s11, 0x20000
    buffer_load_dwordx4 v[196:199], v7, s[12:15], s41 offen
    buffer_load_dwordx4 v[200:203], v7, s[12:15], s41 offen offset:64
    buffer_load_dwordx2 v[204:205], v7, s[12:15], s43 offen
    s_mov_b32 s66, 0
    s_mov_b32 s67, 4096
    s_mov_b32 s68, 8192
    s_mov_b32 s69, 12288
    s_mov_b32 s70, 16384
    s_mov_b32 s48, -1
    s_mov_b32 s49, 0
    s_mov_b64 exec, s[48:49]
    s_mov_b32 s96, 0
L_poll_o:
    s_cmp_eq_u32 s92, 1
    s_cbranch_scc1 L_pl_o
    buffer_load_dword v6, v5, s[24:27], s44 offen sc1
    s_branch L_pw_o
L_pl_o:
    buffer_load_dword v6, v5, s[24:27], s44 offen sc1
L_pw_o:
    s_waitcnt vmcnt(0)
    v_cmp_ne_u32 vcc, s93, v6
    s_add_u32 s96, s96, 1
    s_cmp_eq_u64 vcc, 0
    s_cbranch_scc1 L_pdone_o
    s_cmp_lt_u32 s96, 200000
    s_sleep 1
    s_cbranch_scc1 L_poll_o
    s_endpgm
L_pdone_o:
    s_mov_b64 exec, -1
    s_cmp_eq_u32 s92, 1
    s_cbranch_scc1 L_pfast_o
    buffer_inv sc1
    s_waitcnt vmcnt(0)
L_pfast_o:
    buffer_load_dwordx4 v[116:119], v2, s[8:11], s66 offen offset:0 sc1
    buffer_load_dwordx4 v[120:123], v2, s[8:11], s66 offen offset:1024 sc1
    buffer_load_dwordx4 v[124:127], v2, s[8:11], s66 offen offset:2048 sc1
    buffer_load_dwordx4 v[128:131], v2, s[8:11], s66 offen offset:3072 sc1
    buffer_load_dwordx4 v[132:135], v2, s[8:11], s67 offen offset:0 sc1
    buffer_load_dwordx4 v[136:139], v2, s[8:11], s67 offen offset:1024 sc1
    buffer_load_dwordx4 v[140:143], v2, s[8:11], s67 offen offset:2048 sc1
    buffer_load_dwordx4 v[144:147], v2, s[8:11], s67 offen offset:3072 sc1
    buffer_load_dwordx4 v[148:151], v2, s[8:11], s68 offen offset:0 sc1
    buffer_load_dwordx4 v[152:155], v2, s[8:11], s68 offen offset:1024 sc1
    buffer_load_dwordx4 v[156:159], v2, s[8:11], s68 offen offset:2048 sc1
    buffer_load_dwordx4 v[160:163], v2, s[8:11], s68 offen offset:3072 sc1
    buffer_load_dwordx4 v[164:167], v2, s[8:11], s69 offen offset:0 sc1
    buffer_load_dwordx4 v[168:171], v2, s[8:11], s69 offen offset:1024 sc1
    buffer_load_dwordx4 v[172:175], v2, s[8:11], s69 offen offset:2048 sc1
    buffer_load_dwordx4 v[176:179], v2, s[8:11], s69 offen offset:3072 sc1
    buffer_load_dwordx4 v[180:183], v2, s[8:11], s70 offen offset:0 sc1
    buffer_load_dwordx4 v[184:187], v2, s[8:11], s70 offen offset:1024 sc1
    buffer_load_dwordx4 v[188:191], v2, s[8:11], s70 offen offset:2048 sc1
    buffer_load_dwordx4 v[192:195], v2, s[8:11], s70 offen offset:3072 sc1
    s_barrier
    ds_read_b128 v[36:39], v2 offset:0
    ds_read_b128 v[40:43], v2 offset:1024
    ds_read_b128 v[44:47], v2 offset:2048
    ds_read_b128 v[48:51], v2 offset:3072
    ds_read_b128 v[52:55], v2 offset:4096
    ds_read_b128 v[56:59], v2 offset:5120
    ds_read_b128 v[60:63], v2 offset:6144
    ds_read_b128 v[64:67], v2 offset:7168
    ds_read_b128 v[68:71], v2 offset:8192
    ds_read_b128 v[72:75], v2 offset:9216
    s_waitcnt vmcnt(19) lgkmcnt(5)
    v_mfma_f32_16x16x32_bf16 v[16:19], v[36:39], v[116:119], 0
    ds_read_b128 v[76:79], v2 offset:10240
    v_mfma_f32_16x16x32_bf16 v[20:23], v[40:43], v[116:119], 0
    ds_read_b128 v[80:83], v2 offset:11264
    v_mfma_f32_16x16x32_bf16 v[24:27], v[44:47], v[116:119], 0
    ds_read_b128 v[84:87], v2 offset:12288
    v_mfma_f32_16x16x32_bf16 v[28:31], v[48:51], v[116:119], 0
    ds_read_b128 v[88:91], v2 offset:13312
    v_mfma_f32_16x16x32_bf16 v[32:35], v[52:55], v[116:119], 0
    ds_read_b128 v[92:95], v2 offset:14336
    s_waitcnt vmcnt(18) lgkmcnt(5)
    v_mfma_f32_16x16x32_bf16 v[16:19], v[56:59], v[120:123], v[16:19]
    ds_read_b128 v[96:99], v2 offset:15360
    v_mfma_f32_16x16x32_bf16 v[20:23], v[60:63], v[120:123], v[20:23]
    ds_read_b128 v[100:103], v2 offset:16384
    v_mfma_f32_16x16x32_bf16 v[24:27], v[64:67], v[120:123], v[24:27]
    ds_read_b128 v[104:107], v2 offset:17408
    v_mfma_f32_16x16x32_bf16 v[28:31], v[68:71], v[120:123], v[28:31]
    ds_read_b128 v[108:111], v2 offset:18432
    v_mfma_f32_16x16x32_bf16 v[32:35], v[72:75], v[120:123], v[32:35]
    ds_read_b128 v[112:115], v2 offset:19456
    s_waitcnt vmcnt(17) lgkmcnt(5)
    v_mfma_f32_16x16x32_bf16 v[16:19], v[76:79], v[124:127], v[16:19]
    ds_read_b128 v[36:39], v2 offset:20480
    v_mfma_f32_16x16x32_bf16 v[20:23], v[80:83], v[124:127], v[20:23]
    ds_read_b128 v[40:43], v2 offset:21504
    v_mfma_f32_16x16x32_bf16 v[24:27], v[84:87], v[124:127], v[24:27]
    ds_read_b128 v[44:47], v2 offset:22528
    v_mfma_f32_16x16x32_bf16 v[28:31], v[88:91], v[124:127], v[28:31]
    ds_read_b128 v[48:51], v2 offset:23552
    v_mfma_f32_16x16x32_bf16 v[32:35], v[92:95], v[124:127], v[32:35]
    ds_read_b128 v[52:55], v2 offset:24576
    s_waitcnt vmcnt(16) lgkmcnt(5)
    v_mfma_f32_16x16x32_bf16 v[16:19], v[96:99], v[128:131], v[16:19]
    ds_read_b128 v[56:59], v2 offset:25600
    v_mfma_f32_16x16x32_bf16 v[20:23], v[100:103], v[128:131], v[20:23]
    ds_read_b128 v[60:63], v2 offset:26624
    v_mfma_f32_16x16x32_bf16 v[24:27], v[104:107], v[128:131], v[24:27]
    ds_read_b128 v[64:67], v2 offset:27648
    v_mfma_f32_16x16x32_bf16 v[28:31], v[108:111], v[128:131], v[28:31]
    ds_read_b128 v[68:71], v2 offset:28672
    v_mfma_f32_16x16x32_bf16 v[32:35], v[112:115], v[128:131], v[32:35]
    ds_read_b128 v[72:75], v2 offset:29696
    s_waitcnt vmcnt(15) lgkmcnt(5)
    v_mfma_f32_16x16x32_bf16 v[16:19], v[36:39], v[132:135], v[16:19]
    ds_read_b128 v[76:79], v2 offset:30720
    v_mfma_f32_16x16x32_bf16 v[20:23], v[40:43], v[132:135], v[20:23]
    ds_read_b128 v[80:83], v2 offset:31744
    v_mfma_f32_16x16x32_bf16 v[24:27], v[44:47], v[132:135], v[24:27]
    ds_read_b128 v[84:87], v2 offset:32768
    v_mfma_f32_16x16x32_bf16 v[28:31], v[48:51], v[132:135], v[28:31]
    ds_read_b128 v[88:91], v2 offset:33792
    v_mfma_f32_16x16x32_bf16 v[32:35], v[52:55], v[132:135], v[32:35]
    ds_read_b128 v[92:95], v2 offset:34816
    s_waitcnt vmcnt(14) lgkmcnt(5)
    v_mfma_f32_16x16x32_bf16 v[16:19], v[56:59], v[136:139], v[16:19]
    ds_read_b128 v[96:99], v2 offset:35840
    v_mfma_f32_16x16x32_bf16 v[20:23], v[60:63], v[136:139], v[20:23]
    ds_read_b128 v[100:103], v2 offset:36864
    v_mfma_f32_16x16x32_bf16 v[24:27], v[64:67], v[136:139], v[24:27]
    ds_read_b128 v[104:107], v2 offset:37888
    v_mfma_f32_16x16x32_bf16 v[28:31], v[68:71], v[136:139], v[28:31]
    ds_read_b128 v[108:111], v2 offset:38912
    v_mfma_f32_16x16x32_bf16 v[32:35], v[72:75], v[136:139], v[32:35]
    ds_read_b128 v[112:115], v2 offset:39936
    s_waitcnt vmcnt(13) lgkmcnt(5)
    v_mfma_f32_16x16x32_bf16 v[16:19], v[76:79], v[140:143], v[16:19]
    ds_read_b128 v[36:39], v2 offset:40960
    v_mfma_f32_16x16x32_bf16 v[20:23], v[80:83], v[140:143], v[20:23]
    ds_read_b128 v[40:43], v2 offset:41984
    v_mfma_f32_16x16x32_bf16 v[24:27], v[84:87], v[140:143], v[24:27]
    ds_read_b128 v[44:47], v2 offset:43008
    v_mfma_f32_16x16x32_bf16 v[28:31], v[88:91], v[140:143], v[28:31]
    ds_read_b128 v[48:51], v2 offset:44032
    v_mfma_f32_16x16x32_bf16 v[32:35], v[92:95], v[140:143], v[32:35]
    ds_read_b128 v[52:55], v2 offset:45056
    s_waitcnt vmcnt(12) lgkmcnt(5)
    v_mfma_f32_16x16x32_bf16 v[16:19], v[96:99], v[144:147], v[16:19]
    ds_read_b128 v[56:59], v2 offset:46080
    v_mfma_f32_16x16x32_bf16 v[20:23], v[100:103], v[144:147], v[20:23]
    ds_read_b128 v[60:63], v2 offset:47104
    v_mfma_f32_16x16x32_bf16 v[24:27], v[104:107], v[144:147], v[24:27]
    ds_read_b128 v[64:67], v2 offset:48128
    v_mfma_f32_16x16x32_bf16 v[28:31], v[108:111], v[144:147], v[28:31]
    ds_read_b128 v[68:71], v2 offset:49152
    v_mfma_f32_16x16x32_bf16 v[32:35], v[112:115], v[144:147], v[32:35]
    ds_read_b128 v[72:75], v2 offset:50176
    s_waitcnt vmcnt(11) lgkmcnt(5)
    v_mfma_f32_16x16x32_bf16 v[16:19], v[36:39], v[148:151], v[16:19]
    ds_read_b128 v[76:79], v2 offset:51200
    v_mfma_f32_16x16x32_bf16 v[20:23], v[40:43], v[148:151], v[20:23]
    ds_read_b128 v[80:83], v2 offset:52224
    v_mfma_f32_16x16x32_bf16 v[24:27], v[44:47], v[148:151], v[24:27]
    ds_read_b128 v[84:87], v2 offset:53248
    v_mfma_f32_16x16x32_bf16 v[28:31], v[48:51], v[148:151], v[28:31]
    ds_read_b128 v[88:91], v2 offset:54272
    v_mfma_f32_16x16x32_bf16 v[32:35], v[52:55], v[148:151], v[32:35]
    ds_read_b128 v[92:95], v2 offset:55296
    s_waitcnt vmcnt(10) lgkmcnt(5)
    v_mfma_f32_16x16x32_bf16 v[16:19], v[56:59], v[152:155], v[16:19]
    ds_read_b128 v[96:99], v2 offset:56320
    v_mfma_f32_16x16x32_bf16 v[20:23], v[60:63], v[152:155], v[20:23]
    ds_read_b128 v[100:103], v2 offset:57344
    v_mfma_f32_16x16x32_bf16 v[24:27], v[64:67], v[152:155], v[24:27]
    ds_read_b128 v[104:107], v2 offset:58368
    v_mfma_f32_16x16x32_bf16 v[28:31], v[68:71], v[152:155], v[28:31]
    ds_read_b128 v[108:111], v2 offset:59392
    v_mfma_f32_16x16x32_bf16 v[32:35], v[72:75], v[152:155], v[32:35]
    ds_read_b128 v[112:115], v2 offset:60416
    s_waitcnt vmcnt(9) lgkmcnt(5)
    v_mfma_f32_16x16x32_bf16 v[16:19], v[76:79], v[156:159], v[16:19]
    ds_read_b128 v[36:39], v3 offset:0
    v_mfma_f32_16x16x32_bf16 v[20:23], v[80:83], v[156:159], v[20:23]
    ds_read_b128 v[40:43], v3 offset:1024
    v_mfma_f32_16x16x32_bf16 v[24:27], v[84:87], v[156:159], v[24:27]
    ds_read_b128 v[44:47], v3 offset:2048
    v_mfma_f32_16x16x32_bf16 v[28:31], v[88:91], v[156:159], v[28:31]
    ds_read_b128 v[48:51], v3 offset:3072
    v_mfma_f32_16x16x32_bf16 v[32:35], v[92:95], v[156:159], v[32:35]
    ds_read_b128 v[52:55], v3 offset:4096
    s_waitcnt vmcnt(8) lgkmcnt(5)
    v_mfma_f32_16x16x32_bf16 v[16:19], v[96:99], v[160:163], v[16:19]
    ds_read_b128 v[56:59], v3 offset:5120
    v_mfma_f32_16x16x32_bf16 v[20:23], v[100:103], v[160:163], v[20:23]
    ds_read_b128 v[60:63], v3 offset:6144
    v_mfma_f32_16x16x32_bf16 v[24:27], v[104:107], v[160:163], v[24:27]
    ds_read_b128 v[64:67], v3 offset:7168
    v_mfma_f32_16x16x32_bf16 v[28:31], v[108:111], v[160:163], v[28:31]
    ds_read_b128 v[68:71], v3 offset:8192
    v_mfma_f32_16x16x32_bf16 v[32:35], v[112:115], v[160:163], v[32:35]
    ds_read_b128 v[72:75], v3 offset:9216
    s_waitcnt vmcnt(7) lgkmcnt(5)
    v_mfma_f32_16x16x32_bf16 v[16:19], v[36:39], v[164:167], v[16:19]
    ds_read_b128 v[76:79], v3 offset:10240
    v_mfma_f32_16x16x32_bf16 v[20:23], v[40:43], v[164:167], v[20:23]
    ds_read_b128 v[80:83], v3 offset:11264
    v_mfma_f32_16x16x32_bf16 v[24:27], v[44:47], v[164:167], v[24:27]
    ds_read_b128 v[84:87], v3 offset:12288
    v_mfma_f32_16x16x32_bf16 v[28:31], v[48:51], v[164:167], v[28:31]
    ds_read_b128 v[88:91], v3 offset:13312
    v_mfma_f32_16x16x32_bf16 v[32:35], v[52:55], v[164:167], v[32:35]
    ds_read_b128 v[92:95], v3 offset:14336
    s_waitcnt vmcnt(6) lgkmcnt(5)
    v_mfma_f32_16x16x32_bf16 v[16:19], v[56:59], v[168:171], v[16:19]
    ds_read_b128 v[96:99], v3 offset:15360
    v_mfma_f32_16x16x32_bf16 v[20:23], v[60:63], v[168:171], v[20:23]
    ds_read_b128 v[100:103], v3 offset:16384
    v_mfma_f32_16x16x32_bf16 v[24:27], v[64:67], v[168:171], v[24:27]
    ds_read_b128 v[104:107], v3 offset:17408
    v_mfma_f32_16x16x32_bf16 v[28:31], v[68:71], v[168:171], v[28:31]
    ds_read_b128 v[108:111], v3 offset:18432
    v_mfma_f32_16x16x32_bf16 v[32:35], v[72:75], v[168:171], v[32:35]
    ds_read_b128 v[112:115], v3 offset:19456
    s_waitcnt vmcnt(5) lgkmcnt(5)
    v_mfma_f32_16x16x32_bf16 v[16:19], v[76:79], v[172:175], v[16:19]
    ds_read_b128 v[36:39], v4 offset:0
    v_mfma_f32_16x16x32_bf16 v[20:23], v[80:83], v[172:175], v[20:23]
    ds_read_b128 v[40:43], v4 offset:1024
    v_mfma_f32_16x16x32_bf16 v[24:27], v[84:87], v[172:175], v[24:27]
    ds_read_b128 v[44:47], v4 offset:2048
    v_mfma_f32_16x16x32_bf16 v[28:31], v[88:91], v[172:175], v[28:31]
    ds_read_b128 v[48:51], v4 offset:3072
    v_mfma_f32_16x16x32_bf16 v[32:35], v[92:95], v[172:175], v[32:35]
    ds_read_b128 v[52:55], v4 offset:4096
    s_waitcnt vmcnt(4) lgkmcnt(5)
    v_mfma_f32_16x16x32_bf16 v[16:19], v[96:99], v[176:179], v[16:19]
    ds_read_b128 v[56:59], v4 offset:5120
    v_mfma_f32_16x16x32_bf16 v[20:23], v[100:103], v[176:179], v[20:23]
    ds_read_b128 v[60:63], v4 offset:6144
    v_mfma_f32_16x16x32_bf16 v[24:27], v[104:107], v[176:179], v[24:27]
    ds_read_b128 v[64:67], v4 offset:7168
    v_mfma_f32_16x16x32_bf16 v[28:31], v[108:111], v[176:179], v[28:31]
    ds_read_b128 v[68:71], v4 offset:8192
    v_mfma_f32_16x16x32_bf16 v[32:35], v[112:115], v[176:179], v[32:35]
    ds_read_b128 v[72:75], v4 offset:9216
    s_waitcnt vmcnt(3) lgkmcnt(5)
    v_mfma_f32_16x16x32_bf16 v[16:19], v[36:39], v[180:183], v[16:19]
    ds_read_b128 v[76:79], v4 offset:10240
    v_mfma_f32_16x16x32_bf16 v[20:23], v[40:43], v[180:183], v[20:23]
    ds_read_b128 v[80:83], v4 offset:11264
    v_mfma_f32_16x16x32_bf16 v[24:27], v[44:47], v[180:183], v[24:27]
    ds_read_b128 v[84:87], v4 offset:12288
    v_mfma_f32_16x16x32_bf16 v[28:31], v[48:51], v[180:183], v[28:31]
    ds_read_b128 v[88:91], v4 offset:13312
    v_mfma_f32_16x16x32_bf16 v[32:35], v[52:55], v[180:183], v[32:35]
    ds_read_b128 v[92:95], v4 offset:14336
    s_waitcnt vmcnt(2) lgkmcnt(5)
    v_mfma_f32_16x16x32_bf16 v[16:19], v[56:59], v[184:187], v[16:19]
    ds_read_b128 v[96:99], v4 offset:15360
    v_mfma_f32_16x16x32_bf16 v[20:23], v[60:63], v[184:187], v[20:23]
    ds_read_b128 v[100:103], v4 offset:16384
    v_mfma_f32_16x16x32_bf16 v[24:27], v[64:67], v[184:187], v[24:27]
    ds_read_b128 v[104:107], v4 offset:17408
    v_mfma_f32_16x16x32_bf16 v[28:31], v[68:71], v[184:187], v[28:31]
    ds_read_b128 v[108:111], v4 offset:18432
    v_mfma_f32_16x16x32_bf16 v[32:35], v[72:75], v[184:187], v[32:35]
    ds_read_b128 v[112:115], v4 offset:19456
    s_waitcnt vmcnt(1) lgkmcnt(5)
    v_mfma_f32_16x16x32_bf16 v[16:19], v[76:79], v[188:191], v[16:19]
    v_mfma_f32_16x16x32_bf16 v[20:23], v[80:83], v[188:191], v[20:23]
    v_mfma_f32_16x16x32_bf16 v[24:27], v[84:87], v[188:191], v[24:27]
    v_mfma_f32_16x16x32_bf16 v[28:31], v[88:91], v[188:191], v[28:31]
    v_mfma_f32_16x16x32_bf16 v[32:35], v[92:95], v[188:191], v[32:35]
    s_waitcnt vmcnt(0) lgkmcnt(0)
    v_mfma_f32_16x16x32_bf16 v[16:19], v[96:99], v[192:195], v[16:19]
    v_mfma_f32_16x16x32_bf16 v[20:23], v[100:103], v[192:195], v[20:23]
    v_mfma_f32_16x16x32_bf16 v[24:27], v[104:107], v[192:195], v[24:27]
    v_mfma_f32_16x16x32_bf16 v[28:31], v[108:111], v[192:195], v[28:31]
    v_mfma_f32_16x16x32_bf16 v[32:35], v[112:115], v[192:195], v[32:35]
    v_lshlrev_b32 v218, 16, v196
    v_and_b32 v219, 0xffff0000, v196
    v_lshlrev_b32 v220, 16, v197
    v_and_b32 v221, 0xffff0000, v197
    v_pk_add_f32 v[218:219], v[218:219], v[16:17]
    v_pk_add_f32 v[220:221], v[220:221], v[18:19]
    v_cvt_pk_bf16_f32 v208, v218, v219
    v_cvt_pk_bf16_f32 v209, v220, v221
    v_lshlrev_b32 v218, 16, v198
    v_and_b32 v219, 0xffff0000, v198
    v_lshlrev_b32 v220, 16, v199
    v_and_b32 v221, 0xffff0000, v199
    v_pk_add_f32 v[218:219], v[218:219], v[20:21]
    v_pk_add_f32 v[220:221], v[220:221], v[22:23]
    v_cvt_pk_bf16_f32 v210, v218, v219
    v_cvt_pk_bf16_f32 v211, v220, v221
    buffer_store_dwordx4 v[208:211], v2, s[16:19], s40 offen offset:0
    v_lshlrev_b32 v218, 16, v200
    v_and_b32 v219, 0xffff0000, v200
    v_lshlrev_b32 v220, 16, v201
    v_and_b32 v221, 0xffff0000, v201
    v_pk_add_f32 v[218:219], v[218:219], v[24:25]
    v_pk_add_f32 v[220:221], v[220:221], v[26:27]
    v_cvt_pk_bf16_f32 v212, v218, v219
    v_cvt_pk_bf16_f32 v213, v220, v221
    v_lshlrev_b32 v218, 16, v202
    v_and_b32 v219, 0xffff0000, v202
    v_lshlrev_b32 v220, 16, v203
    v_and_b32 v221, 0xffff0000, v203
    v_pk_add_f32 v[218:219], v[218:219], v[28:29]
    v_pk_add_f32 v[220:221], v[220:221], v[30:31]
    v_cvt_pk_bf16_f32 v214, v218, v219
    v_cvt_pk_bf16_f32 v215, v220, v221
    buffer_store_dwordx4 v[212:215], v2, s[16:19], s40 offen offset:1024
    v_lshlrev_b32 v218, 16, v204
    v_and_b32 v219, 0xffff0000, v204
    v_lshlrev_b32 v220, 16, v205
    v_and_b32 v221, 0xffff0000, v205
    v_pk_add_f32 v[218:219], v[218:219], v[32:33]
    v_pk_add_f32 v[220:221], v[220:221], v[34:35]
    v_cvt_pk_bf16_f32 v216, v218, v219
    v_cvt_pk_bf16_f32 v217, v220, v221
    buffer_store_dwordx2 v[216:217], v2, s[16:19], s42 offen
    v_mov_b32 v222, 0
    v_mov_b32 v223, 0
    v_mov_b32 v224, 0
    v_mov_b32 v225, 0
    v_dot2c_f32_bf16 v222, s83, v208
    v_dot2c_f32_bf16 v223, v208, v208
    v_dot2c_f32_bf16 v224, s83, v209
    v_dot2c_f32_bf16 v225, v209, v209
    v_dot2c_f32_bf16 v222, s83, v210
    v_dot2c_f32_bf16 v223, v210, v210
    v_dot2c_f32_bf16 v224, s83, v211
    v_dot2c_f32_bf16 v225, v211, v211
    v_dot2c_f32_bf16 v222, s83, v212
    v_dot2c_f32_bf16 v223, v212, v212
    v_dot2c_f32_bf16 v224, s83, v213
    v_dot2c_f32_bf16 v225, v213, v213
    v_dot2c_f32_bf16 v222, s83, v214
    v_dot2c_f32_bf16 v223, v214, v214
    v_dot2c_f32_bf16 v224, s83, v215
    v_dot2c_f32_bf16 v225, v215, v215
    v_dot2c_f32_bf16 v222, s83, v216
    v_dot2c_f32_bf16 v223, v216, v216
    v_dot2c_f32_bf16 v224, s83, v217
    v_dot2c_f32_bf16 v225, v217, v217
    s_nop 2
    v_pk_add_f32 v[222:223], v[222:223], v[224:225]
    v_mov_b32 v224, v222
    v_mov_b32 v225, v223
    s_nop 0
    v_permlane32_swap_b32 v222, v224
    v_permlane32_swap_b32 v223, v225
    v_add_f32 v222, v222, v224
    v_add_f32 v223, v223, v225
    v_mov_b32 v224, v222
    v_mov_b32 v225, v223
    s_nop 0
    v_permlane16_swap_b32 v222, v224
    v_permlane16_swap_b32 v223, v225
    v_add_f32 v222, v222, v224
    v_add_f32 v223, v223, v225
    v_lshlrev_b32 v6, 6, v0
    s_mov_b64 exec, 0xffff
    buffer_store_dwordx2 v[222:223], v6, s[20:23], 0 offen
    s_mov_b64 exec, -1
    s_lshl_b32 s34, s28, 12
    v_add_u32 v3, 81920, v2
    v_add_u32 v4, s34, v2
    v_add_u32 v5, 110592, v4
    v_add_u32 v4, 57344, v4
    v_lshrrev_b32 v6, 4, v0
    v_lshlrev_b32 v8, 4, v6
    v_add_u32 v8, 143360, v8
    v_and_b32 v9, 15, v0
    v_lshl_add_u32 v9, v9, 6, v8
    s_lshl_b32 s35, s28, 11
    v_add_u32 v9, s35, v9
    s_mul_i32 s39, s87, 57344
    s_add_u32 s39, s39, 13041664
    s_lshr_b32 s44, s94, 1
    s_mul_i32 s44, s44, 7
    s_and_b32 s45, s94, 1
    s_add_u32 s46, s44, 3
    s_lshl_b32 s46, s46, 10
    s_lshl_b32 s47, s45, 3
    s_add_u32 s46, s46, s47
    s_lshl_b32 s45, s45, 2
    s_add_u32 s44, s44, s45
    s_lshl_b32 s44, s44, 10
    s_mov_b32 s49, 0xbfb8aa3b
    s_mov_b32 s8, s64
    s_mov_b32 s9, s65
    s_mov_b32 s10, 20381696
    s_mov_b32 s11, 0x20000
    s_mul_i32 s45, s87, 20480
    s_add_u32 s45, s45, 7667712
    s_mov_b32 s47, 57344
    s_cmp_eq_u32 s92, 1
    s_cselect_b32 s45, s45, s39
    s_cselect_b32 s47, 20480, s47
    s_add_u32 s52, s44, 0
    s_cmp_lt_u32 s52, 20480
    s_cselect_b32 s53, s45, s39
    s_add_u32 s66, s52, s53
    s_add_u32 s52, s44, 1024
    s_cmp_lt_u32 s52, 20480
    s_cselect_b32 s53, s45, s39
    s_add_u32 s67, s52, s53
    s_add_u32 s52, s44, 2048
    s_cmp_lt_u32 s52, 20480
    s_cselect_b32 s53, s45, s39
    s_add_u32 s68, s52, s53
    s_add_u32 s52, s46, 0
    s_cmp_lt_u32 s52, 20480
    s_cselect_b32 s53, s45, s39
    s_add_u32 s69, s52, s53
    s_add_u32 s45, s45, s47
    s_add_u32 s39, s39, 57344
    s_add_u32 s52, s44, 0
    s_cmp_lt_u32 s52, 20480
    s_cselect_b32 s53, s45, s39
    s_add_u32 s70, s52, s53
    s_add_u32 s52, s44, 1024
    s_cmp_lt_u32 s52, 20480
    s_cselect_b32 s53, s45, s39
    s_add_u32 s71, s52, s53
    s_add_u32 s52, s44, 2048
    s_cmp_lt_u32 s52, 20480
    s_cselect_b32 s53, s45, s39
    s_add_u32 s72, s52, s53
    s_add_u32 s52, s46, 0
    s_cmp_lt_u32 s52, 20480
    s_cselect_b32 s53, s45, s39
    s_add_u32 s73, s52, s53
    v_mov_b32 v14, s93
    s_waitcnt vmcnt(0)
    s_mov_b64 exec, 1
    s_cmp_eq_u32 s92, 1
    s_cbranch_scc1 L_pubf_85
    buffer_wbl2 sc1
    s_waitcnt vmcnt(0)
    buffer_store_dword v14, v15, s[24:27], s85 offen sc1
    s_branch L_pubd_85
L_pubf_85:
    buffer_store_dword v14, v15, s[24:27], s85 offen
L_pubd_85:
    s_mov_b64 exec, -1
    s_lshl_b32 s48, s87, 5
    s_add_u32 s48, s48, 4096
    v_lshlrev_b32 v10, 2, v0
    v_add_u32 v11, 18432, v2
    s_mul_i32 s50, s87, 20480
    s_add_u32 s50, s50, 10289152
    s_add_u32 s12, s64, s50
    s_addc_u32 s13, s65, 0
    s_mov_b32 s14, 40960
    s_mov_b32 s15, 0x20000
    s_mov_b32 s50, 0
    s_mov_b32 s51, 2048
    s_mov_b64 exec, 0xffff
    s_mov_b32 s96, 0
L_poll_h:
    s_cmp_eq_u32 s92, 1
    s_cbranch_scc1 L_pl_h
    buffer_load_dword v12, v10, s[24:27], s48 offen sc1
    s_branch L_pw_h
L_pl_h:
    buffer_load_dword v12, v10, s[24:27], s48 offen sc1
L_pw_h:
    s_waitcnt vmcnt(0)
    v_cmp_ne_u32 vcc, s93, v12
    s_add_u32 s96, s96, 1
    s_cmp_eq_u64 vcc, 0
    s_cbranch_scc1 L_pdone_h
    s_cmp_lt_u32 s96, 200000
    s_sleep 1
    s_cbranch_scc1 L_poll_h
    s_endpgm
L_pdone_h:
    s_mov_b64 exec, -1
    s_cmp_eq_u32 s92, 1
    s_cbranch_scc1 L_pfast_h
    buffer_inv sc1
    s_waitcnt vmcnt(0)
L_pfast_h:
    s_barrier
    s_add_u32 m0, s34, 57344
    s_nop 0
    buffer_load_dwordx4 v2, s[12:15], s50 offen offset:0 sc1 lds
    buffer_load_dwordx4 v2, s[12:15], s50 offen offset:1024 sc1 lds
    buffer_load_dwordx4 v11, s[12:15], s50 offen offset:2048 sc1 lds
    buffer_load_dwordx4 v11, s[12:15], s50 offen offset:3072 sc1 lds
    s_add_u32 m0, s34, 110592
    s_nop 0
    buffer_load_dwordx4 v2, s[12:15], s51 offen offset:0 sc1 lds
    buffer_load_dwordx4 v2, s[12:15], s51 offen offset:1024 sc1 lds
    buffer_load_dwordx4 v11, s[12:15], s51 offen offset:2048 sc1 lds
    buffer_load_dwordx4 v11, s[12:15], s51 offen offset:3072 sc1 lds
    s_waitcnt vmcnt(4)
    s_barrier
    ds_read_b128 v[184:187], v4 offset:0
    ds_read_b128 v[188:191], v4 offset:2048
    ds_read_b128 v[128:131], v3 offset:0
    ds_read_b128 v[132:135], v3 offset:1024
    ds_read_b128 v[136:139], v3 offset:2048
    ds_read_b128 v[140:143], v3 offset:3072
    ds_read_b128 v[144:147], v3 offset:4096
    ds_read_b128 v[148:151], v3 offset:5120
    ds_read_b128 v[152:155], v3 offset:6144
    ds_read_b128 v[156:159], v3 offset:7168
    ds_read_b128 v[160:163], v3 offset:8192
    ds_read_b128 v[164:167], v3 offset:9216
    ds_read_b128 v[168:171], v3 offset:10240
    ds_read_b128 v[172:175], v3 offset:11264
    ds_read_b128 v[176:179], v3 offset:12288
    ds_read_b128 v[180:183], v3 offset:13312
    s_waitcnt lgkmcnt(13)
    v_mfma_f32_16x16x32_bf16 v[16:19], v[128:131], v[184:187], 0
    ds_read_b128 v[192:195], v4 offset:1024
    v_mfma_f32_16x16x32_bf16 v[72:75], v[128:131], v[188:191], 0
    ds_read_b128 v[196:199], v4 offset:3072
    s_waitcnt lgkmcnt(14)
    v_mfma_f32_16x16x32_bf16 v[20:23], v[132:135], v[184:187], 0
    ds_read_b128 v[128:131], v3 offset:14336
    v_mfma_f32_16x16x32_bf16 v[76:79], v[132:135], v[188:191], 0
    ds_read_b128 v[132:135], v3 offset:15360
    s_waitcnt lgkmcnt(15)
    v_mfma_f32_16x16x32_bf16 v[24:27], v[136:139], v[184:187], 0
    v_mfma_f32_16x16x32_bf16 v[80:83], v[136:139], v[188:191], 0
    ds_read_b128 v[136:139], v3 offset:16384
    s_waitcnt lgkmcnt(15)
    v_mfma_f32_16x16x32_bf16 v[28:31], v[140:143], v[184:187], 0
    v_mfma_f32_16x16x32_bf16 v[84:87], v[140:143], v[188:191], 0
    ds_read_b128 v[140:143], v3 offset:17408
    s_waitcnt lgkmcnt(15)
    v_mfma_f32_16x16x32_bf16 v[32:35], v[144:147], v[184:187], 0
    v_mfma_f32_16x16x32_bf16 v[88:91], v[144:147], v[188:191], 0
    ds_read_b128 v[144:147], v3 offset:18432
    s_waitcnt lgkmcnt(15)
    v_mfma_f32_16x16x32_bf16 v[36:39], v[148:151], v[184:187], 0
    v_mfma_f32_16x16x32_bf16 v[92:95], v[148:151], v[188:191], 0
    ds_read_b128 v[148:151], v3 offset:19456
    s_waitcnt lgkmcnt(15)
    v_mfma_f32_16x16x32_bf16 v[40:43], v[152:155], v[184:187], 0
    v_mfma_f32_16x16x32_bf16 v[96:99], v[152:155], v[188:191], 0
    ds_read_b128 v[152:155], v3 offset:20480
    s_waitcnt lgkmcnt(15)
    v_mfma_f32_16x16x32_bf16 v[44:47], v[156:159], v[184:187], 0
    v_mfma_f32_16x16x32_bf16 v[100:103], v[156:159], v[188:191], 0
    ds_read_b128 v[156:159], v3 offset:21504
    s_waitcnt lgkmcnt(15)
    v_mfma_f32_16x16x32_bf16 v[48:51], v[160:163], v[184:187], 0
    v_mfma_f32_16x16x32_bf16 v[104:107], v[160:163], v[188:191], 0
    ds_read_b128 v[160:163], v3 offset:22528
    s_waitcnt lgkmcnt(15)
    v_mfma_f32_16x16x32_bf16 v[52:55], v[164:167], v[184:187], 0
    v_mfma_f32_16x16x32_bf16 v[108:111], v[164:167], v[188:191], 0
    ds_read_b128 v[164:167], v3 offset:23552
    s_waitcnt lgkmcnt(15)
    v_mfma_f32_16x16x32_bf16 v[56:59], v[168:171], v[184:187], 0
    v_mfma_f32_16x16x32_bf16 v[112:115], v[168:171], v[188:191], 0
    ds_read_b128 v[168:171], v3 offset:24576
    s_waitcnt lgkmcnt(15)
    v_mfma_f32_16x16x32_bf16 v[60:63], v[172:175], v[184:187], 0
    v_mfma_f32_16x16x32_bf16 v[116:119], v[172:175], v[188:191], 0
    ds_read_b128 v[172:175], v3 offset:25600
    s_waitcnt lgkmcnt(15)
    v_mfma_f32_16x16x32_bf16 v[64:67], v[176:179], v[184:187], 0
    v_mfma_f32_16x16x32_bf16 v[120:123], v[176:179], v[188:191], 0
    ds_read_b128 v[176:179], v3 offset:26624
    s_waitcnt lgkmcnt(15)
    v_mfma_f32_16x16x32_bf16 v[68:71], v[180:183], v[184:187], 0
    v_mfma_f32_16x16x32_bf16 v[124:127], v[180:183], v[188:191], 0
    ds_read_b128 v[180:183], v3 offset:27648
    s_waitcnt lgkmcnt(13)
    v_mfma_f32_16x16x32_bf16 v[16:19], v[128:131], v[192:195], v[16:19]
    v_mfma_f32_16x16x32_bf16 v[72:75], v[128:131], v[196:199], v[72:75]
    s_waitcnt lgkmcnt(12)
    v_mfma_f32_16x16x32_bf16 v[20:23], v[132:135], v[192:195], v[20:23]
    v_mfma_f32_16x16x32_bf16 v[76:79], v[132:135], v[196:199], v[76:79]
    s_waitcnt lgkmcnt(11)
    v_mfma_f32_16x16x32_bf16 v[24:27], v[136:139], v[192:195], v[24:27]
    v_mfma_f32_16x16x32_bf16 v[80:83], v[136:139], v[196:199], v[80:83]
    s_waitcnt vmcnt(0)
    s_waitcnt lgkmcnt(0)
    s_barrier
    v_mfma_f32_16x16x32_bf16 v[28:31], v[140:143], v[192:195], v[28:31]
    ds_read_b128 v[184:187], v5 offset:0
    v_mfma_f32_16x16x32_bf16 v[84:87], v[140:143], v[196:199], v[84:87]
    ds_read_b128 v[188:191], v5 offset:2048
    v_mfma_f32_16x16x32_bf16 v[32:35], v[144:147], v[192:195], v[32:35]
    ds_read_b128 v[128:131], v2 offset:0
    v_mfma_f32_16x16x32_bf16 v[88:91], v[144:147], v[196:199], v[88:91]
    ds_read_b128 v[132:135], v2 offset:1024
    v_mfma_f32_16x16x32_bf16 v[36:39], v[148:151], v[192:195], v[36:39]
    ds_read_b128 v[136:139], v2 offset:2048
    v_mfma_f32_16x16x32_bf16 v[92:95], v[148:151], v[196:199], v[92:95]
    ds_read_b128 v[140:143], v2 offset:3072
    v_mfma_f32_16x16x32_bf16 v[40:43], v[152:155], v[192:195], v[40:43]
    ds_read_b128 v[144:147], v2 offset:4096
    v_mfma_f32_16x16x32_bf16 v[96:99], v[152:155], v[196:199], v[96:99]
    ds_read_b128 v[148:151], v2 offset:5120
    v_mfma_f32_16x16x32_bf16 v[44:47], v[156:159], v[192:195], v[44:47]
    ds_read_b128 v[152:155], v2 offset:6144
    v_mfma_f32_16x16x32_bf16 v[100:103], v[156:159], v[196:199], v[100:103]
    ds_read_b128 v[156:159], v2 offset:7168
    v_mfma_f32_16x16x32_bf16 v[48:51], v[160:163], v[192:195], v[48:51]
    v_mfma_f32_16x16x32_bf16 v[104:107], v[160:163], v[196:199], v[104:107]
    ds_read_b128 v[160:163], v2 offset:8192
    v_mfma_f32_16x16x32_bf16 v[52:55], v[164:167], v[192:195], v[52:55]
    v_mfma_f32_16x16x32_bf16 v[108:111], v[164:167], v[196:199], v[108:111]
    ds_read_b128 v[164:167], v2 offset:9216
    v_mfma_f32_16x16x32_bf16 v[56:59], v[168:171], v[192:195], v[56:59]
    v_mfma_f32_16x16x32_bf16 v[112:115], v[168:171], v[196:199], v[112:115]
    ds_read_b128 v[168:171], v2 offset:10240
    v_mfma_f32_16x16x32_bf16 v[60:63], v[172:175], v[192:195], v[60:63]
    v_mfma_f32_16x16x32_bf16 v[116:119], v[172:175], v[196:199], v[116:119]
    ds_read_b128 v[172:175], v2 offset:11264
    v_mfma_f32_16x16x32_bf16 v[64:67], v[176:179], v[192:195], v[64:67]
    v_mfma_f32_16x16x32_bf16 v[120:123], v[176:179], v[196:199], v[120:123]
    ds_read_b128 v[176:179], v2 offset:12288
    v_mfma_f32_16x16x32_bf16 v[68:71], v[180:183], v[192:195], v[68:71]
    v_mfma_f32_16x16x32_bf16 v[124:127], v[180:183], v[196:199], v[124:127]
    ds_read_b128 v[180:183], v2 offset:13312
    s_waitcnt lgkmcnt(13)
    v_mfma_f32_16x16x32_bf16 v[16:19], v[128:131], v[184:187], v[16:19]
    ds_read_b128 v[192:195], v5 offset:1024
    v_mfma_f32_16x16x32_bf16 v[72:75], v[128:131], v[188:191], v[72:75]
    ds_read_b128 v[196:199], v5 offset:3072
    s_waitcnt lgkmcnt(14)
    v_mfma_f32_16x16x32_bf16 v[20:23], v[132:135], v[184:187], v[20:23]
    ds_read_b128 v[128:131], v2 offset:14336
    v_mfma_f32_16x16x32_bf16 v[76:79], v[132:135], v[188:191], v[76:79]
    ds_read_b128 v[132:135], v2 offset:15360
    s_waitcnt lgkmcnt(15)
    v_mfma_f32_16x16x32_bf16 v[24:27], v[136:139], v[184:187], v[24:27]
    v_mfma_f32_16x16x32_bf16 v[80:83], v[136:139], v[188:191], v[80:83]
    ds_read_b128 v[136:139], v2 offset:16384
    s_waitcnt lgkmcnt(15)
    v_mfma_f32_16x16x32_bf16 v[28:31], v[140:143], v[184:187], v[28:31]
    v_mfma_f32_16x16x32_bf16 v[84:87], v[140:143], v[188:191], v[84:87]
    ds_read_b128 v[140:143], v2 offset:17408
    s_waitcnt lgkmcnt(15)
    v_mfma_f32_16x16x32_bf16 v[32:35], v[144:147], v[184:187], v[32:35]
    v_mfma_f32_16x16x32_bf16 v[88:91], v[144:147], v[188:191], v[88:91]
    ds_read_b128 v[144:147], v2 offset:18432
    s_waitcnt lgkmcnt(15)
    v_mfma_f32_16x16x32_bf16 v[36:39], v[148:151], v[184:187], v[36:39]
    v_mfma_f32_16x16x32_bf16 v[92:95], v[148:151], v[188:191], v[92:95]
    ds_read_b128 v[148:151], v2 offset:19456
    s_waitcnt lgkmcnt(15)
    v_mfma_f32_16x16x32_bf16 v[40:43], v[152:155], v[184:187], v[40:43]
    v_mfma_f32_16x16x32_bf16 v[96:99], v[152:155], v[188:191], v[96:99]
    ds_read_b128 v[152:155], v2 offset:20480
    s_waitcnt lgkmcnt(15)
    v_mfma_f32_16x16x32_bf16 v[44:47], v[156:159], v[184:187], v[44:47]
    v_mfma_f32_16x16x32_bf16 v[100:103], v[156:159], v[188:191], v[100:103]
    ds_read_b128 v[156:159], v2 offset:21504
    s_waitcnt lgkmcnt(15)
    v_mfma_f32_16x16x32_bf16 v[48:51], v[160:163], v[184:187], v[48:51]
    v_mfma_f32_16x16x32_bf16 v[104:107], v[160:163], v[188:191], v[104:107]
    ds_read_b128 v[160:163], v2 offset:22528
    s_waitcnt lgkmcnt(15)
    v_mfma_f32_16x16x32_bf16 v[52:55], v[164:167], v[184:187], v[52:55]
    v_mfma_f32_16x16x32_bf16 v[108:111], v[164:167], v[188:191], v[108:111]
    ds_read_b128 v[164:167], v2 offset:23552
    s_waitcnt lgkmcnt(15)
    v_mfma_f32_16x16x32_bf16 v[56:59], v[168:171], v[184:187], v[56:59]
    v_mfma_f32_16x16x32_bf16 v[112:115], v[168:171], v[188:191], v[112:115]
    ds_read_b128 v[168:171], v2 offset:24576
    s_waitcnt lgkmcnt(15)
    v_mfma_f32_16x16x32_bf16 v[60:63], v[172:175], v[184:187], v[60:63]
    v_mfma_f32_16x16x32_bf16 v[116:119], v[172:175], v[188:191], v[116:119]
    ds_read_b128 v[172:175], v2 offset:25600
    s_waitcnt lgkmcnt(15)
    v_mfma_f32_16x16x32_bf16 v[64:67], v[176:179], v[184:187], v[64:67]
    v_mfma_f32_16x16x32_bf16 v[120:123], v[176:179], v[188:191], v[120:123]
    ds_read_b128 v[176:179], v2 offset:26624
    s_waitcnt lgkmcnt(15)
    v_mfma_f32_16x16x32_bf16 v[68:71], v[180:183], v[184:187], v[68:71]
    v_mfma_f32_16x16x32_bf16 v[124:127], v[180:183], v[188:191], v[124:127]
    ds_read_b128 v[180:183], v2 offset:27648
    s_waitcnt lgkmcnt(13)
    v_mfma_f32_16x16x32_bf16 v[16:19], v[128:131], v[192:195], v[16:19]
    v_mfma_f32_16x16x32_bf16 v[72:75], v[128:131], v[196:199], v[72:75]
    s_waitcnt lgkmcnt(12)
    v_mfma_f32_16x16x32_bf16 v[20:23], v[132:135], v[192:195], v[20:23]
    v_mfma_f32_16x16x32_bf16 v[76:79], v[132:135], v[196:199], v[76:79]
    s_waitcnt lgkmcnt(11)
    v_mfma_f32_16x16x32_bf16 v[24:27], v[136:139], v[192:195], v[24:27]
    v_mfma_f32_16x16x32_bf16 v[80:83], v[136:139], v[196:199], v[80:83]
    s_waitcnt lgkmcnt(0)
    s_barrier
    v_mfma_f32_16x16x32_bf16 v[28:31], v[140:143], v[192:195], v[28:31]
    ds_read_b128 v[184:187], v5 offset:16384
    v_mfma_f32_16x16x32_bf16 v[84:87], v[140:143], v[196:199], v[84:87]
    ds_read_b128 v[188:191], v5 offset:18432
    v_mfma_f32_16x16x32_bf16 v[32:35], v[144:147], v[192:195], v[32:35]
    ds_read_b128 v[128:131], v2 offset:28672
    v_mfma_f32_16x16x32_bf16 v[88:91], v[144:147], v[196:199], v[88:91]
    ds_read_b128 v[132:135], v2 offset:29696
    v_mfma_f32_16x16x32_bf16 v[36:39], v[148:151], v[192:195], v[36:39]
    ds_read_b128 v[136:139], v2 offset:30720
    v_mfma_f32_16x16x32_bf16 v[92:95], v[148:151], v[196:199], v[92:95]
    ds_read_b128 v[140:143], v2 offset:31744
    v_mfma_f32_16x16x32_bf16 v[40:43], v[152:155], v[192:195], v[40:43]
    ds_read_b128 v[144:147], v2 offset:32768
    v_mfma_f32_16x16x32_bf16 v[96:99], v[152:155], v[196:199], v[96:99]
    ds_read_b128 v[148:151], v2 offset:33792
    v_mfma_f32_16x16x32_bf16 v[44:47], v[156:159], v[192:195], v[44:47]
    ds_read_b128 v[152:155], v2 offset:34816
    v_mfma_f32_16x16x32_bf16 v[100:103], v[156:159], v[196:199], v[100:103]
    ds_read_b128 v[156:159], v2 offset:35840
    v_mfma_f32_16x16x32_bf16 v[48:51], v[160:163], v[192:195], v[48:51]
    v_mfma_f32_16x16x32_bf16 v[104:107], v[160:163], v[196:199], v[104:107]
    ds_read_b128 v[160:163], v2 offset:36864
    v_mfma_f32_16x16x32_bf16 v[52:55], v[164:167], v[192:195], v[52:55]
    v_mfma_f32_16x16x32_bf16 v[108:111], v[164:167], v[196:199], v[108:111]
    ds_read_b128 v[164:167], v2 offset:37888
    v_mfma_f32_16x16x32_bf16 v[56:59], v[168:171], v[192:195], v[56:59]
    v_mfma_f32_16x16x32_bf16 v[112:115], v[168:171], v[196:199], v[112:115]
    ds_read_b128 v[168:171], v2 offset:38912
    v_mfma_f32_16x16x32_bf16 v[60:63], v[172:175], v[192:195], v[60:63]
    v_mfma_f32_16x16x32_bf16 v[116:119], v[172:175], v[196:199], v[116:119]
    ds_read_b128 v[172:175], v2 offset:39936
    v_mfma_f32_16x16x32_bf16 v[64:67], v[176:179], v[192:195], v[64:67]
    v_mfma_f32_16x16x32_bf16 v[120:123], v[176:179], v[196:199], v[120:123]
    ds_read_b128 v[176:179], v2 offset:40960
    v_mfma_f32_16x16x32_bf16 v[68:71], v[180:183], v[192:195], v[68:71]
    v_mfma_f32_16x16x32_bf16 v[124:127], v[180:183], v[196:199], v[124:127]
    ds_read_b128 v[180:183], v2 offset:41984
    s_waitcnt lgkmcnt(13)
    v_mfma_f32_16x16x32_bf16 v[16:19], v[128:131], v[184:187], v[16:19]
    ds_read_b128 v[192:195], v5 offset:17408
    v_mfma_f32_16x16x32_bf16 v[72:75], v[128:131], v[188:191], v[72:75]
    ds_read_b128 v[196:199], v5 offset:19456
    s_waitcnt lgkmcnt(14)
    v_mfma_f32_16x16x32_bf16 v[20:23], v[132:135], v[184:187], v[20:23]
    ds_read_b128 v[128:131], v2 offset:43008
    v_mfma_f32_16x16x32_bf16 v[76:79], v[132:135], v[188:191], v[76:79]
    ds_read_b128 v[132:135], v2 offset:44032
    s_waitcnt lgkmcnt(15)
    v_mfma_f32_16x16x32_bf16 v[24:27], v[136:139], v[184:187], v[24:27]
    v_mfma_f32_16x16x32_bf16 v[80:83], v[136:139], v[188:191], v[80:83]
    ds_read_b128 v[136:139], v2 offset:45056
    s_waitcnt lgkmcnt(15)
    v_mfma_f32_16x16x32_bf16 v[28:31], v[140:143], v[184:187], v[28:31]
    v_mfma_f32_16x16x32_bf16 v[84:87], v[140:143], v[188:191], v[84:87]
    ds_read_b128 v[140:143], v2 offset:46080
    s_waitcnt lgkmcnt(15)
    v_mfma_f32_16x16x32_bf16 v[32:35], v[144:147], v[184:187], v[32:35]
    v_mfma_f32_16x16x32_bf16 v[88:91], v[144:147], v[188:191], v[88:91]
    ds_read_b128 v[144:147], v2 offset:47104
    s_waitcnt lgkmcnt(15)
    v_mfma_f32_16x16x32_bf16 v[36:39], v[148:151], v[184:187], v[36:39]
    v_mfma_f32_16x16x32_bf16 v[92:95], v[148:151], v[188:191], v[92:95]
    ds_read_b128 v[148:151], v2 offset:48128
    s_waitcnt lgkmcnt(15)
    v_mfma_f32_16x16x32_bf16 v[40:43], v[152:155], v[184:187], v[40:43]
    v_mfma_f32_16x16x32_bf16 v[96:99], v[152:155], v[188:191], v[96:99]
    ds_read_b128 v[152:155], v2 offset:49152
    s_waitcnt lgkmcnt(15)
    v_mfma_f32_16x16x32_bf16 v[44:47], v[156:159], v[184:187], v[44:47]
    v_mfma_f32_16x16x32_bf16 v[100:103], v[156:159], v[188:191], v[100:103]
    ds_read_b128 v[156:159], v2 offset:50176
    s_waitcnt lgkmcnt(15)
    v_mfma_f32_16x16x32_bf16 v[48:51], v[160:163], v[184:187], v[48:51]
    v_mfma_f32_16x16x32_bf16 v[104:107], v[160:163], v[188:191], v[104:107]
    ds_read_b128 v[160:163], v2 offset:51200
    s_waitcnt lgkmcnt(15)
    v_mfma_f32_16x16x32_bf16 v[52:55], v[164:167], v[184:187], v[52:55]
    v_mfma_f32_16x16x32_bf16 v[108:111], v[164:167], v[188:191], v[108:111]
    ds_read_b128 v[164:167], v2 offset:52224
    s_waitcnt lgkmcnt(15)
    v_mfma_f32_16x16x32_bf16 v[56:59], v[168:171], v[184:187], v[56:59]
    v_mfma_f32_16x16x32_bf16 v[112:115], v[168:171], v[188:191], v[112:115]
    ds_read_b128 v[168:171], v2 offset:53248
    s_waitcnt lgkmcnt(15)
    v_mfma_f32_16x16x32_bf16 v[60:63], v[172:175], v[184:187], v[60:63]
    v_mfma_f32_16x16x32_bf16 v[116:119], v[172:175], v[188:191], v[116:119]
    ds_read_b128 v[172:175], v2 offset:54272
    s_waitcnt lgkmcnt(15)
    v_mfma_f32_16x16x32_bf16 v[64:67], v[176:179], v[184:187], v[64:67]
    v_mfma_f32_16x16x32_bf16 v[120:123], v[176:179], v[188:191], v[120:123]
    ds_read_b128 v[176:179], v2 offset:55296
    s_waitcnt lgkmcnt(15)
    v_mfma_f32_16x16x32_bf16 v[68:71], v[180:183], v[184:187], v[68:71]
    v_mfma_f32_16x16x32_bf16 v[124:127], v[180:183], v[188:191], v[124:127]
    ds_read_b128 v[180:183], v2 offset:56320
    s_waitcnt lgkmcnt(13)
    v_mfma_f32_16x16x32_bf16 v[16:19], v[128:131], v[192:195], v[16:19]
    v_mfma_f32_16x16x32_bf16 v[72:75], v[128:131], v[196:199], v[72:75]
    s_waitcnt lgkmcnt(12)
    v_mfma_f32_16x16x32_bf16 v[20:23], v[132:135], v[192:195], v[20:23]
    v_mfma_f32_16x16x32_bf16 v[76:79], v[132:135], v[196:199], v[76:79]
    s_waitcnt lgkmcnt(11)
    v_mfma_f32_16x16x32_bf16 v[24:27], v[136:139], v[192:195], v[24:27]
    v_mfma_f32_16x16x32_bf16 v[80:83], v[136:139], v[196:199], v[80:83]
    s_waitcnt lgkmcnt(0)
    s_barrier
    v_mfma_f32_16x16x32_bf16 v[28:31], v[140:143], v[192:195], v[28:31]
    ds_read_b128 v[184:187], v4 offset:0
    v_mfma_f32_16x16x32_bf16 v[84:87], v[140:143], v[196:199], v[84:87]
    ds_read_b128 v[188:191], v4 offset:2048
    v_mfma_f32_16x16x32_bf16 v[32:35], v[144:147], v[192:195], v[32:35]
    ds_read_b128 v[128:131], v3 offset:0
    v_mfma_f32_16x16x32_bf16 v[88:91], v[144:147], v[196:199], v[88:91]
    ds_read_b128 v[132:135], v3 offset:1024
    v_mfma_f32_16x16x32_bf16 v[36:39], v[148:151], v[192:195], v[36:39]
    ds_read_b128 v[136:139], v3 offset:2048
    v_mfma_f32_16x16x32_bf16 v[92:95], v[148:151], v[196:199], v[92:95]
    ds_read_b128 v[140:143], v3 offset:3072
    v_mfma_f32_16x16x32_bf16 v[40:43], v[152:155], v[192:195], v[40:43]
    ds_read_b128 v[144:147], v3 offset:4096
    v_mfma_f32_16x16x32_bf16 v[96:99], v[152:155], v[196:199], v[96:99]
    ds_read_b128 v[148:151], v3 offset:5120
    v_mfma_f32_16x16x32_bf16 v[44:47], v[156:159], v[192:195], v[44:47]
    ds_read_b128 v[152:155], v3 offset:6144
    v_mfma_f32_16x16x32_bf16 v[100:103], v[156:159], v[196:199], v[100:103]
    ds_read_b128 v[156:159], v3 offset:7168
    v_mfma_f32_16x16x32_bf16 v[48:51], v[160:163], v[192:195], v[48:51]
    v_mfma_f32_16x16x32_bf16 v[104:107], v[160:163], v[196:199], v[104:107]
    ds_read_b128 v[160:163], v3 offset:8192
    v_mfma_f32_16x16x32_bf16 v[52:55], v[164:167], v[192:195], v[52:55]
    v_mfma_f32_16x16x32_bf16 v[108:111], v[164:167], v[196:199], v[108:111]
    ds_read_b128 v[164:167], v3 offset:9216
    v_mfma_f32_16x16x32_bf16 v[56:59], v[168:171], v[192:195], v[56:59]
    v_mfma_f32_16x16x32_bf16 v[112:115], v[168:171], v[196:199], v[112:115]
    ds_read_b128 v[168:171], v3 offset:10240
    v_mfma_f32_16x16x32_bf16 v[60:63], v[172:175], v[192:195], v[60:63]
    v_mfma_f32_16x16x32_bf16 v[116:119], v[172:175], v[196:199], v[116:119]
    ds_read_b128 v[172:175], v3 offset:11264
    v_mfma_f32_16x16x32_bf16 v[64:67], v[176:179], v[192:195], v[64:67]
    v_mfma_f32_16x16x32_bf16 v[120:123], v[176:179], v[196:199], v[120:123]
    ds_read_b128 v[176:179], v3 offset:12288
    v_mfma_f32_16x16x32_bf16 v[68:71], v[180:183], v[192:195], v[68:71]
    v_mfma_f32_16x16x32_bf16 v[124:127], v[180:183], v[196:199], v[124:127]
    ds_read_b128 v[180:183], v3 offset:13312
    s_waitcnt lgkmcnt(13)
    v_mfma_f32_16x16x32_bf16 v[16:19], v[128:131], v[184:187], v[16:19]
    ds_read_b128 v[192:195], v4 offset:1024
    v_mfma_f32_16x16x32_bf16 v[72:75], v[128:131], v[188:191], v[72:75]
    ds_read_b128 v[196:199], v4 offset:3072
    s_waitcnt lgkmcnt(14)
    v_mfma_f32_16x16x32_bf16 v[20:23], v[132:135], v[184:187], v[20:23]
    ds_read_b128 v[128:131], v3 offset:14336
    v_mfma_f32_16x16x32_bf16 v[76:79], v[132:135], v[188:191], v[76:79]
    ds_read_b128 v[132:135], v3 offset:15360
    s_waitcnt lgkmcnt(15)
    v_mfma_f32_16x16x32_bf16 v[24:27], v[136:139], v[184:187], v[24:27]
    v_mfma_f32_16x16x32_bf16 v[80:83], v[136:139], v[188:191], v[80:83]
    ds_read_b128 v[136:139], v3 offset:16384
    s_waitcnt lgkmcnt(15)
    v_mfma_f32_16x16x32_bf16 v[28:31], v[140:143], v[184:187], v[28:31]
    v_mfma_f32_16x16x32_bf16 v[84:87], v[140:143], v[188:191], v[84:87]
    ds_read_b128 v[140:143], v3 offset:17408
    s_waitcnt lgkmcnt(15)
    v_mfma_f32_16x16x32_bf16 v[32:35], v[144:147], v[184:187], v[32:35]
    v_mfma_f32_16x16x32_bf16 v[88:91], v[144:147], v[188:191], v[88:91]
    ds_read_b128 v[144:147], v3 offset:18432
    s_waitcnt lgkmcnt(15)
    v_mfma_f32_16x16x32_bf16 v[36:39], v[148:151], v[184:187], v[36:39]
    v_mfma_f32_16x16x32_bf16 v[92:95], v[148:151], v[188:191], v[92:95]
    ds_read_b128 v[148:151], v3 offset:19456
    s_waitcnt lgkmcnt(15)
    v_mfma_f32_16x16x32_bf16 v[40:43], v[152:155], v[184:187], v[40:43]
    v_mfma_f32_16x16x32_bf16 v[96:99], v[152:155], v[188:191], v[96:99]
    ds_read_b128 v[152:155], v3 offset:20480
    s_waitcnt lgkmcnt(15)
    v_mfma_f32_16x16x32_bf16 v[44:47], v[156:159], v[184:187], v[44:47]
    v_mfma_f32_16x16x32_bf16 v[100:103], v[156:159], v[188:191], v[100:103]
    ds_read_b128 v[156:159], v3 offset:21504
    s_waitcnt lgkmcnt(15)
    v_mfma_f32_16x16x32_bf16 v[48:51], v[160:163], v[184:187], v[48:51]
    v_mfma_f32_16x16x32_bf16 v[104:107], v[160:163], v[188:191], v[104:107]
    ds_read_b128 v[160:163], v3 offset:22528
    s_waitcnt lgkmcnt(15)
    v_mfma_f32_16x16x32_bf16 v[52:55], v[164:167], v[184:187], v[52:55]
    v_mfma_f32_16x16x32_bf16 v[108:111], v[164:167], v[188:191], v[108:111]
    ds_read_b128 v[164:167], v3 offset:23552
    s_waitcnt lgkmcnt(15)
    v_mfma_f32_16x16x32_bf16 v[56:59], v[168:171], v[184:187], v[56:59]
    v_mfma_f32_16x16x32_bf16 v[112:115], v[168:171], v[188:191], v[112:115]
    ds_read_b128 v[168:171], v3 offset:24576
    s_waitcnt lgkmcnt(15)
    v_mfma_f32_16x16x32_bf16 v[60:63], v[172:175], v[184:187], v[60:63]
    v_mfma_f32_16x16x32_bf16 v[116:119], v[172:175], v[188:191], v[116:119]
    ds_read_b128 v[172:175], v3 offset:25600
    s_waitcnt lgkmcnt(15)
    v_mfma_f32_16x16x32_bf16 v[64:67], v[176:179], v[184:187], v[64:67]
    v_mfma_f32_16x16x32_bf16 v[120:123], v[176:179], v[188:191], v[120:123]
    ds_read_b128 v[176:179], v3 offset:26624
    s_waitcnt lgkmcnt(15)
    v_mfma_f32_16x16x32_bf16 v[68:71], v[180:183], v[184:187], v[68:71]
    v_mfma_f32_16x16x32_bf16 v[124:127], v[180:183], v[188:191], v[124:127]
    ds_read_b128 v[180:183], v3 offset:27648
    s_waitcnt lgkmcnt(13)
    v_mfma_f32_16x16x32_bf16 v[16:19], v[128:131], v[192:195], v[16:19]
    v_mfma_f32_16x16x32_bf16 v[72:75], v[128:131], v[196:199], v[72:75]
    s_waitcnt lgkmcnt(12)
    v_mfma_f32_16x16x32_bf16 v[20:23], v[132:135], v[192:195], v[20:23]
    v_mfma_f32_16x16x32_bf16 v[76:79], v[132:135], v[196:199], v[76:79]
    s_waitcnt lgkmcnt(11)
    v_mfma_f32_16x16x32_bf16 v[24:27], v[136:139], v[192:195], v[24:27]
    v_mfma_f32_16x16x32_bf16 v[80:83], v[136:139], v[196:199], v[80:83]
    s_waitcnt lgkmcnt(0)
    s_barrier
    v_mfma_f32_16x16x32_bf16 v[28:31], v[140:143], v[192:195], v[28:31]
    ds_read_b128 v[184:187], v5 offset:0
    v_mfma_f32_16x16x32_bf16 v[84:87], v[140:143], v[196:199], v[84:87]
    ds_read_b128 v[188:191], v5 offset:2048
    v_mfma_f32_16x16x32_bf16 v[32:35], v[144:147], v[192:195], v[32:35]
    ds_read_b128 v[128:131], v2 offset:0
    v_mfma_f32_16x16x32_bf16 v[88:91], v[144:147], v[196:199], v[88:91]
    ds_read_b128 v[132:135], v2 offset:1024
    v_mfma_f32_16x16x32_bf16 v[36:39], v[148:151], v[192:195], v[36:39]
    ds_read_b128 v[136:139], v2 offset:2048
    v_mfma_f32_16x16x32_bf16 v[92:95], v[148:151], v[196:199], v[92:95]
    ds_read_b128 v[140:143], v2 offset:3072
    v_mfma_f32_16x16x32_bf16 v[40:43], v[152:155], v[192:195], v[40:43]
    ds_read_b128 v[144:147], v2 offset:4096
    v_mfma_f32_16x16x32_bf16 v[96:99], v[152:155], v[196:199], v[96:99]
    ds_read_b128 v[148:151], v2 offset:5120
    v_mfma_f32_16x16x32_bf16 v[44:47], v[156:159], v[192:195], v[44:47]
    ds_read_b128 v[152:155], v2 offset:6144
    v_mfma_f32_16x16x32_bf16 v[100:103], v[156:159], v[196:199], v[100:103]
    ds_read_b128 v[156:159], v2 offset:7168
    v_mfma_f32_16x16x32_bf16 v[48:51], v[160:163], v[192:195], v[48:51]
    v_mfma_f32_16x16x32_bf16 v[104:107], v[160:163], v[196:199], v[104:107]
    ds_read_b128 v[160:163], v2 offset:8192
    v_mfma_f32_16x16x32_bf16 v[52:55], v[164:167], v[192:195], v[52:55]
    v_mfma_f32_16x16x32_bf16 v[108:111], v[164:167], v[196:199], v[108:111]
    ds_read_b128 v[164:167], v2 offset:9216
    v_mfma_f32_16x16x32_bf16 v[56:59], v[168:171], v[192:195], v[56:59]
    v_mfma_f32_16x16x32_bf16 v[112:115], v[168:171], v[196:199], v[112:115]
    ds_read_b128 v[168:171], v2 offset:10240
    v_mfma_f32_16x16x32_bf16 v[60:63], v[172:175], v[192:195], v[60:63]
    v_mfma_f32_16x16x32_bf16 v[116:119], v[172:175], v[196:199], v[116:119]
    ds_read_b128 v[172:175], v2 offset:11264
    v_mfma_f32_16x16x32_bf16 v[64:67], v[176:179], v[192:195], v[64:67]
    v_mfma_f32_16x16x32_bf16 v[120:123], v[176:179], v[196:199], v[120:123]
    ds_read_b128 v[176:179], v2 offset:12288
    v_mfma_f32_16x16x32_bf16 v[68:71], v[180:183], v[192:195], v[68:71]
    v_mfma_f32_16x16x32_bf16 v[124:127], v[180:183], v[196:199], v[124:127]
    ds_read_b128 v[180:183], v2 offset:13312
    s_waitcnt lgkmcnt(13)
    v_mfma_f32_16x16x32_bf16 v[16:19], v[128:131], v[184:187], v[16:19]
    ds_read_b128 v[192:195], v5 offset:1024
    v_mfma_f32_16x16x32_bf16 v[72:75], v[128:131], v[188:191], v[72:75]
    ds_read_b128 v[196:199], v5 offset:3072
    s_waitcnt lgkmcnt(14)
    v_mfma_f32_16x16x32_bf16 v[20:23], v[132:135], v[184:187], v[20:23]
    ds_read_b128 v[128:131], v2 offset:14336
    v_mfma_f32_16x16x32_bf16 v[76:79], v[132:135], v[188:191], v[76:79]
    ds_read_b128 v[132:135], v2 offset:15360
    s_waitcnt lgkmcnt(15)
    v_mfma_f32_16x16x32_bf16 v[24:27], v[136:139], v[184:187], v[24:27]
    v_mfma_f32_16x16x32_bf16 v[80:83], v[136:139], v[188:191], v[80:83]
    ds_read_b128 v[136:139], v2 offset:16384
    s_waitcnt lgkmcnt(15)
    v_mfma_f32_16x16x32_bf16 v[28:31], v[140:143], v[184:187], v[28:31]
    v_mfma_f32_16x16x32_bf16 v[84:87], v[140:143], v[188:191], v[84:87]
    ds_read_b128 v[140:143], v2 offset:17408
    s_waitcnt lgkmcnt(15)
    v_mfma_f32_16x16x32_bf16 v[32:35], v[144:147], v[184:187], v[32:35]
    v_mfma_f32_16x16x32_bf16 v[88:91], v[144:147], v[188:191], v[88:91]
    ds_read_b128 v[144:147], v2 offset:18432
    s_waitcnt lgkmcnt(15)
    v_mfma_f32_16x16x32_bf16 v[36:39], v[148:151], v[184:187], v[36:39]
    v_mfma_f32_16x16x32_bf16 v[92:95], v[148:151], v[188:191], v[92:95]
    ds_read_b128 v[148:151], v2 offset:19456
    s_waitcnt lgkmcnt(15)
    v_mfma_f32_16x16x32_bf16 v[40:43], v[152:155], v[184:187], v[40:43]
    v_mfma_f32_16x16x32_bf16 v[96:99], v[152:155], v[188:191], v[96:99]
    ds_read_b128 v[152:155], v2 offset:20480
    s_waitcnt lgkmcnt(15)
    v_mfma_f32_16x16x32_bf16 v[44:47], v[156:159], v[184:187], v[44:47]
    v_mfma_f32_16x16x32_bf16 v[100:103], v[156:159], v[188:191], v[100:103]
    ds_read_b128 v[156:159], v2 offset:21504
    s_waitcnt lgkmcnt(15)
    v_mfma_f32_16x16x32_bf16 v[48:51], v[160:163], v[184:187], v[48:51]
    v_mfma_f32_16x16x32_bf16 v[104:107], v[160:163], v[188:191], v[104:107]
    ds_read_b128 v[160:163], v2 offset:22528
    s_waitcnt lgkmcnt(15)
    v_mfma_f32_16x16x32_bf16 v[52:55], v[164:167], v[184:187], v[52:55]
    v_mfma_f32_16x16x32_bf16 v[108:111], v[164:167], v[188:191], v[108:111]
    ds_read_b128 v[164:167], v2 offset:23552
    s_waitcnt lgkmcnt(15)
    v_mfma_f32_16x16x32_bf16 v[56:59], v[168:171], v[184:187], v[56:59]
    v_mfma_f32_16x16x32_bf16 v[112:115], v[168:171], v[188:191], v[112:115]
    ds_read_b128 v[168:171], v2 offset:24576
    s_waitcnt lgkmcnt(15)
    v_mfma_f32_16x16x32_bf16 v[60:63], v[172:175], v[184:187], v[60:63]
    v_mfma_f32_16x16x32_bf16 v[116:119], v[172:175], v[188:191], v[116:119]
    ds_read_b128 v[172:175], v2 offset:25600
    s_waitcnt lgkmcnt(15)
    v_mfma_f32_16x16x32_bf16 v[64:67], v[176:179], v[184:187], v[64:67]
    v_mfma_f32_16x16x32_bf16 v[120:123], v[176:179], v[188:191], v[120:123]
    ds_read_b128 v[176:179], v2 offset:26624
    s_waitcnt lgkmcnt(15)
    v_mfma_f32_16x16x32_bf16 v[68:71], v[180:183], v[184:187], v[68:71]
    v_mfma_f32_16x16x32_bf16 v[124:127], v[180:183], v[188:191], v[124:127]
    ds_read_b128 v[180:183], v2 offset:27648
    s_waitcnt lgkmcnt(13)
    v_mfma_f32_16x16x32_bf16 v[16:19], v[128:131], v[192:195], v[16:19]
    v_mfma_f32_16x16x32_bf16 v[72:75], v[128:131], v[196:199], v[72:75]
    s_waitcnt lgkmcnt(12)
    v_mfma_f32_16x16x32_bf16 v[20:23], v[132:135], v[192:195], v[20:23]
    v_mfma_f32_16x16x32_bf16 v[76:79], v[132:135], v[196:199], v[76:79]
    s_waitcnt lgkmcnt(11)
    v_mfma_f32_16x16x32_bf16 v[24:27], v[136:139], v[192:195], v[24:27]
    v_mfma_f32_16x16x32_bf16 v[80:83], v[136:139], v[196:199], v[80:83]
    s_waitcnt lgkmcnt(0)
    s_barrier
    v_mfma_f32_16x16x32_bf16 v[28:31], v[140:143], v[192:195], v[28:31]
    ds_read_b128 v[184:187], v5 offset:16384
    v_mfma_f32_16x16x32_bf16 v[84:87], v[140:143], v[196:199], v[84:87]
    ds_read_b128 v[188:191], v5 offset:18432
    v_mfma_f32_16x16x32_bf16 v[32:35], v[144:147], v[192:195], v[32:35]
    ds_read_b128 v[128:131], v2 offset:28672
    v_mfma_f32_16x16x32_bf16 v[88:91], v[144:147], v[196:199], v[88:91]
    ds_read_b128 v[132:135], v2 offset:29696
    v_mfma_f32_16x16x32_bf16 v[36:39], v[148:151], v[192:195], v[36:39]
    ds_read_b128 v[136:139], v2 offset:30720
    v_mfma_f32_16x16x32_bf16 v[92:95], v[148:151], v[196:199], v[92:95]
    ds_read_b128 v[140:143], v2 offset:31744
    v_mfma_f32_16x16x32_bf16 v[40:43], v[152:155], v[192:195], v[40:43]
    ds_read_b128 v[144:147], v2 offset:32768
    v_mfma_f32_16x16x32_bf16 v[96:99], v[152:155], v[196:199], v[96:99]
    ds_read_b128 v[148:151], v2 offset:33792
    v_mfma_f32_16x16x32_bf16 v[44:47], v[156:159], v[192:195], v[44:47]
    ds_read_b128 v[152:155], v2 offset:34816
    v_mfma_f32_16x16x32_bf16 v[100:103], v[156:159], v[196:199], v[100:103]
    ds_read_b128 v[156:159], v2 offset:35840
    v_mfma_f32_16x16x32_bf16 v[48:51], v[160:163], v[192:195], v[48:51]
    v_mfma_f32_16x16x32_bf16 v[104:107], v[160:163], v[196:199], v[104:107]
    ds_read_b128 v[160:163], v2 offset:36864
    v_mfma_f32_16x16x32_bf16 v[52:55], v[164:167], v[192:195], v[52:55]
    v_mfma_f32_16x16x32_bf16 v[108:111], v[164:167], v[196:199], v[108:111]
    ds_read_b128 v[164:167], v2 offset:37888
    v_mfma_f32_16x16x32_bf16 v[56:59], v[168:171], v[192:195], v[56:59]
    v_mfma_f32_16x16x32_bf16 v[112:115], v[168:171], v[196:199], v[112:115]
    ds_read_b128 v[168:171], v2 offset:38912
    v_mfma_f32_16x16x32_bf16 v[60:63], v[172:175], v[192:195], v[60:63]
    v_mfma_f32_16x16x32_bf16 v[116:119], v[172:175], v[196:199], v[116:119]
    ds_read_b128 v[172:175], v2 offset:39936
    v_mfma_f32_16x16x32_bf16 v[64:67], v[176:179], v[192:195], v[64:67]
    v_mfma_f32_16x16x32_bf16 v[120:123], v[176:179], v[196:199], v[120:123]
    ds_read_b128 v[176:179], v2 offset:40960
    v_mfma_f32_16x16x32_bf16 v[68:71], v[180:183], v[192:195], v[68:71]
    v_mfma_f32_16x16x32_bf16 v[124:127], v[180:183], v[196:199], v[124:127]
    ds_read_b128 v[180:183], v2 offset:41984
    s_waitcnt lgkmcnt(13)
    v_mfma_f32_16x16x32_bf16 v[16:19], v[128:131], v[184:187], v[16:19]
    ds_read_b128 v[192:195], v5 offset:17408
    v_mfma_f32_16x16x32_bf16 v[72:75], v[128:131], v[188:191], v[72:75]
    ds_read_b128 v[196:199], v5 offset:19456
    s_waitcnt lgkmcnt(14)
    v_mfma_f32_16x16x32_bf16 v[20:23], v[132:135], v[184:187], v[20:23]
    ds_read_b128 v[128:131], v2 offset:43008
    v_mfma_f32_16x16x32_bf16 v[76:79], v[132:135], v[188:191], v[76:79]
    ds_read_b128 v[132:135], v2 offset:44032
    s_waitcnt lgkmcnt(15)
    v_mfma_f32_16x16x32_bf16 v[24:27], v[136:139], v[184:187], v[24:27]
    v_mfma_f32_16x16x32_bf16 v[80:83], v[136:139], v[188:191], v[80:83]
    ds_read_b128 v[136:139], v2 offset:45056
    s_waitcnt lgkmcnt(15)
    v_mfma_f32_16x16x32_bf16 v[28:31], v[140:143], v[184:187], v[28:31]
    v_mfma_f32_16x16x32_bf16 v[84:87], v[140:143], v[188:191], v[84:87]
    ds_read_b128 v[140:143], v2 offset:46080
    s_waitcnt lgkmcnt(15)
    v_mfma_f32_16x16x32_bf16 v[32:35], v[144:147], v[184:187], v[32:35]
    v_mfma_f32_16x16x32_bf16 v[88:91], v[144:147], v[188:191], v[88:91]
    ds_read_b128 v[144:147], v2 offset:47104
    s_waitcnt lgkmcnt(15)
    v_mfma_f32_16x16x32_bf16 v[36:39], v[148:151], v[184:187], v[36:39]
    v_mfma_f32_16x16x32_bf16 v[92:95], v[148:151], v[188:191], v[92:95]
    ds_read_b128 v[148:151], v2 offset:48128
    s_waitcnt lgkmcnt(15)
    v_mfma_f32_16x16x32_bf16 v[40:43], v[152:155], v[184:187], v[40:43]
    v_mfma_f32_16x16x32_bf16 v[96:99], v[152:155], v[188:191], v[96:99]
    ds_read_b128 v[152:155], v2 offset:49152
    s_waitcnt lgkmcnt(15)
    v_mfma_f32_16x16x32_bf16 v[44:47], v[156:159], v[184:187], v[44:47]
    v_mfma_f32_16x16x32_bf16 v[100:103], v[156:159], v[188:191], v[100:103]
    ds_read_b128 v[156:159], v2 offset:50176
    s_waitcnt lgkmcnt(15)
    v_mfma_f32_16x16x32_bf16 v[48:51], v[160:163], v[184:187], v[48:51]
    v_mfma_f32_16x16x32_bf16 v[104:107], v[160:163], v[188:191], v[104:107]
    ds_read_b128 v[160:163], v2 offset:51200
    s_waitcnt lgkmcnt(15)
    v_mfma_f32_16x16x32_bf16 v[52:55], v[164:167], v[184:187], v[52:55]
    v_mfma_f32_16x16x32_bf16 v[108:111], v[164:167], v[188:191], v[108:111]
    ds_read_b128 v[164:167], v2 offset:52224
    s_waitcnt lgkmcnt(15)
    v_mfma_f32_16x16x32_bf16 v[56:59], v[168:171], v[184:187], v[56:59]
    v_mfma_f32_16x16x32_bf16 v[112:115], v[168:171], v[188:191], v[112:115]
    ds_read_b128 v[168:171], v2 offset:53248
    s_waitcnt lgkmcnt(15)
    v_mfma_f32_16x16x32_bf16 v[60:63], v[172:175], v[184:187], v[60:63]
    v_mfma_f32_16x16x32_bf16 v[116:119], v[172:175], v[188:191], v[116:119]
    ds_read_b128 v[172:175], v2 offset:54272
    s_waitcnt lgkmcnt(15)
    v_mfma_f32_16x16x32_bf16 v[64:67], v[176:179], v[184:187], v[64:67]
    v_mfma_f32_16x16x32_bf16 v[120:123], v[176:179], v[188:191], v[120:123]
    ds_read_b128 v[176:179], v2 offset:55296
    s_waitcnt lgkmcnt(15)
    v_mfma_f32_16x16x32_bf16 v[68:71], v[180:183], v[184:187], v[68:71]
    v_mfma_f32_16x16x32_bf16 v[124:127], v[180:183], v[188:191], v[124:127]
    ds_read_b128 v[180:183], v2 offset:56320
    s_waitcnt lgkmcnt(13)
    v_mfma_f32_16x16x32_bf16 v[16:19], v[128:131], v[192:195], v[16:19]
    v_mfma_f32_16x16x32_bf16 v[72:75], v[128:131], v[196:199], v[72:75]
    s_waitcnt lgkmcnt(12)
    v_mfma_f32_16x16x32_bf16 v[20:23], v[132:135], v[192:195], v[20:23]
    v_mfma_f32_16x16x32_bf16 v[76:79], v[132:135], v[196:199], v[76:79]
    s_waitcnt lgkmcnt(11)
    v_mfma_f32_16x16x32_bf16 v[24:27], v[136:139], v[192:195], v[24:27]
    v_mfma_f32_16x16x32_bf16 v[80:83], v[136:139], v[196:199], v[80:83]
    s_waitcnt lgkmcnt(0)
    s_barrier
    v_mfma_f32_16x16x32_bf16 v[28:31], v[140:143], v[192:195], v[28:31]
    ds_read_b128 v[184:187], v4 offset:0
    v_mfma_f32_16x16x32_bf16 v[84:87], v[140:143], v[196:199], v[84:87]
    ds_read_b128 v[188:191], v4 offset:2048
    v_mfma_f32_16x16x32_bf16 v[32:35], v[144:147], v[192:195], v[32:35]
    ds_read_b128 v[128:131], v3 offset:0
    v_mfma_f32_16x16x32_bf16 v[88:91], v[144:147], v[196:199], v[88:91]
    ds_read_b128 v[132:135], v3 offset:1024
    v_mfma_f32_16x16x32_bf16 v[36:39], v[148:151], v[192:195], v[36:39]
    ds_read_b128 v[136:139], v3 offset:2048
    v_mfma_f32_16x16x32_bf16 v[92:95], v[148:151], v[196:199], v[92:95]
    ds_read_b128 v[140:143], v3 offset:3072
    v_mfma_f32_16x16x32_bf16 v[40:43], v[152:155], v[192:195], v[40:43]
    ds_read_b128 v[144:147], v3 offset:4096
    v_mfma_f32_16x16x32_bf16 v[96:99], v[152:155], v[196:199], v[96:99]
    ds_read_b128 v[148:151], v3 offset:5120
    v_mfma_f32_16x16x32_bf16 v[44:47], v[156:159], v[192:195], v[44:47]
    ds_read_b128 v[152:155], v3 offset:6144
    v_mfma_f32_16x16x32_bf16 v[100:103], v[156:159], v[196:199], v[100:103]
    ds_read_b128 v[156:159], v3 offset:7168
    v_mfma_f32_16x16x32_bf16 v[48:51], v[160:163], v[192:195], v[48:51]
    v_mfma_f32_16x16x32_bf16 v[104:107], v[160:163], v[196:199], v[104:107]
    ds_read_b128 v[160:163], v3 offset:8192
    v_mfma_f32_16x16x32_bf16 v[52:55], v[164:167], v[192:195], v[52:55]
    v_mfma_f32_16x16x32_bf16 v[108:111], v[164:167], v[196:199], v[108:111]
    ds_read_b128 v[164:167], v3 offset:9216
    v_mfma_f32_16x16x32_bf16 v[56:59], v[168:171], v[192:195], v[56:59]
    v_mfma_f32_16x16x32_bf16 v[112:115], v[168:171], v[196:199], v[112:115]
    ds_read_b128 v[168:171], v3 offset:10240
    v_mfma_f32_16x16x32_bf16 v[60:63], v[172:175], v[192:195], v[60:63]
    v_mfma_f32_16x16x32_bf16 v[116:119], v[172:175], v[196:199], v[116:119]
    ds_read_b128 v[172:175], v3 offset:11264
    v_mfma_f32_16x16x32_bf16 v[64:67], v[176:179], v[192:195], v[64:67]
    v_mfma_f32_16x16x32_bf16 v[120:123], v[176:179], v[196:199], v[120:123]
    ds_read_b128 v[176:179], v3 offset:12288
    v_mfma_f32_16x16x32_bf16 v[68:71], v[180:183], v[192:195], v[68:71]
    v_mfma_f32_16x16x32_bf16 v[124:127], v[180:183], v[196:199], v[124:127]
    ds_read_b128 v[180:183], v3 offset:13312
    s_waitcnt lgkmcnt(13)
    v_mfma_f32_16x16x32_bf16 v[16:19], v[128:131], v[184:187], v[16:19]
    ds_read_b128 v[192:195], v4 offset:1024
    v_mfma_f32_16x16x32_bf16 v[72:75], v[128:131], v[188:191], v[72:75]
    ds_read_b128 v[196:199], v4 offset:3072
    s_waitcnt lgkmcnt(14)
    v_mfma_f32_16x16x32_bf16 v[20:23], v[132:135], v[184:187], v[20:23]
    ds_read_b128 v[128:131], v3 offset:14336
    v_mfma_f32_16x16x32_bf16 v[76:79], v[132:135], v[188:191], v[76:79]
    ds_read_b128 v[132:135], v3 offset:15360
    s_waitcnt lgkmcnt(15)
    v_mfma_f32_16x16x32_bf16 v[24:27], v[136:139], v[184:187], v[24:27]
    v_mfma_f32_16x16x32_bf16 v[80:83], v[136:139], v[188:191], v[80:83]
    ds_read_b128 v[136:139], v3 offset:16384
    s_waitcnt lgkmcnt(15)
    v_mfma_f32_16x16x32_bf16 v[28:31], v[140:143], v[184:187], v[28:31]
    v_mfma_f32_16x16x32_bf16 v[84:87], v[140:143], v[188:191], v[84:87]
    ds_read_b128 v[140:143], v3 offset:17408
    s_waitcnt lgkmcnt(15)
    v_mfma_f32_16x16x32_bf16 v[32:35], v[144:147], v[184:187], v[32:35]
    v_mfma_f32_16x16x32_bf16 v[88:91], v[144:147], v[188:191], v[88:91]
    ds_read_b128 v[144:147], v3 offset:18432
    s_waitcnt lgkmcnt(15)
    v_mfma_f32_16x16x32_bf16 v[36:39], v[148:151], v[184:187], v[36:39]
    v_mfma_f32_16x16x32_bf16 v[92:95], v[148:151], v[188:191], v[92:95]
    ds_read_b128 v[148:151], v3 offset:19456
    s_waitcnt lgkmcnt(15)
    v_mfma_f32_16x16x32_bf16 v[40:43], v[152:155], v[184:187], v[40:43]
    v_mfma_f32_16x16x32_bf16 v[96:99], v[152:155], v[188:191], v[96:99]
    ds_read_b128 v[152:155], v3 offset:20480
    s_waitcnt lgkmcnt(15)
    v_mfma_f32_16x16x32_bf16 v[44:47], v[156:159], v[184:187], v[44:47]
    v_mfma_f32_16x16x32_bf16 v[100:103], v[156:159], v[188:191], v[100:103]
    ds_read_b128 v[156:159], v3 offset:21504
    s_waitcnt lgkmcnt(15)
    v_mfma_f32_16x16x32_bf16 v[48:51], v[160:163], v[184:187], v[48:51]
    v_mfma_f32_16x16x32_bf16 v[104:107], v[160:163], v[188:191], v[104:107]
    ds_read_b128 v[160:163], v3 offset:22528
    s_waitcnt lgkmcnt(15)
    v_mfma_f32_16x16x32_bf16 v[52:55], v[164:167], v[184:187], v[52:55]
    v_mfma_f32_16x16x32_bf16 v[108:111], v[164:167], v[188:191], v[108:111]
    ds_read_b128 v[164:167], v3 offset:23552
    s_waitcnt lgkmcnt(15)
    v_mfma_f32_16x16x32_bf16 v[56:59], v[168:171], v[184:187], v[56:59]
    v_mfma_f32_16x16x32_bf16 v[112:115], v[168:171], v[188:191], v[112:115]
    ds_read_b128 v[168:171], v3 offset:24576
    s_waitcnt lgkmcnt(15)
    v_mfma_f32_16x16x32_bf16 v[60:63], v[172:175], v[184:187], v[60:63]
    v_mfma_f32_16x16x32_bf16 v[116:119], v[172:175], v[188:191], v[116:119]
    ds_read_b128 v[172:175], v3 offset:25600
    s_waitcnt lgkmcnt(15)
    v_mfma_f32_16x16x32_bf16 v[64:67], v[176:179], v[184:187], v[64:67]
    v_mfma_f32_16x16x32_bf16 v[120:123], v[176:179], v[188:191], v[120:123]
    ds_read_b128 v[176:179], v3 offset:26624
    s_waitcnt lgkmcnt(15)
    v_mfma_f32_16x16x32_bf16 v[68:71], v[180:183], v[184:187], v[68:71]
    v_mfma_f32_16x16x32_bf16 v[124:127], v[180:183], v[188:191], v[124:127]
    ds_read_b128 v[180:183], v3 offset:27648
    s_waitcnt lgkmcnt(13)
    v_mfma_f32_16x16x32_bf16 v[16:19], v[128:131], v[192:195], v[16:19]
    v_mfma_f32_16x16x32_bf16 v[72:75], v[128:131], v[196:199], v[72:75]
    s_waitcnt lgkmcnt(12)
    v_mfma_f32_16x16x32_bf16 v[20:23], v[132:135], v[192:195], v[20:23]
    v_mfma_f32_16x16x32_bf16 v[76:79], v[132:135], v[196:199], v[76:79]
    s_waitcnt lgkmcnt(11)
    v_mfma_f32_16x16x32_bf16 v[24:27], v[136:139], v[192:195], v[24:27]
    v_mfma_f32_16x16x32_bf16 v[80:83], v[136:139], v[196:199], v[80:83]
    s_waitcnt lgkmcnt(0)
    s_barrier
    v_mfma_f32_16x16x32_bf16 v[28:31], v[140:143], v[192:195], v[28:31]
    ds_read_b128 v[184:187], v5 offset:0
    v_mfma_f32_16x16x32_bf16 v[84:87], v[140:143], v[196:199], v[84:87]
    ds_read_b128 v[188:191], v5 offset:2048
    v_mfma_f32_16x16x32_bf16 v[32:35], v[144:147], v[192:195], v[32:35]
    ds_read_b128 v[128:131], v2 offset:0
    v_mfma_f32_16x16x32_bf16 v[88:91], v[144:147], v[196:199], v[88:91]
    ds_read_b128 v[132:135], v2 offset:1024
    v_mfma_f32_16x16x32_bf16 v[36:39], v[148:151], v[192:195], v[36:39]
    ds_read_b128 v[136:139], v2 offset:2048
    v_mfma_f32_16x16x32_bf16 v[92:95], v[148:151], v[196:199], v[92:95]
    ds_read_b128 v[140:143], v2 offset:3072
    v_mfma_f32_16x16x32_bf16 v[40:43], v[152:155], v[192:195], v[40:43]
    ds_read_b128 v[144:147], v2 offset:4096
    v_mfma_f32_16x16x32_bf16 v[96:99], v[152:155], v[196:199], v[96:99]
    ds_read_b128 v[148:151], v2 offset:5120
    v_mfma_f32_16x16x32_bf16 v[44:47], v[156:159], v[192:195], v[44:47]
    ds_read_b128 v[152:155], v2 offset:6144
    v_mfma_f32_16x16x32_bf16 v[100:103], v[156:159], v[196:199], v[100:103]
    ds_read_b128 v[156:159], v2 offset:7168
    v_mfma_f32_16x16x32_bf16 v[48:51], v[160:163], v[192:195], v[48:51]
    v_mfma_f32_16x16x32_bf16 v[104:107], v[160:163], v[196:199], v[104:107]
    ds_read_b128 v[160:163], v2 offset:8192
    v_mfma_f32_16x16x32_bf16 v[52:55], v[164:167], v[192:195], v[52:55]
    v_mfma_f32_16x16x32_bf16 v[108:111], v[164:167], v[196:199], v[108:111]
    ds_read_b128 v[164:167], v2 offset:9216
    v_mfma_f32_16x16x32_bf16 v[56:59], v[168:171], v[192:195], v[56:59]
    v_mfma_f32_16x16x32_bf16 v[112:115], v[168:171], v[196:199], v[112:115]
    ds_read_b128 v[168:171], v2 offset:10240
    v_mfma_f32_16x16x32_bf16 v[60:63], v[172:175], v[192:195], v[60:63]
    v_mfma_f32_16x16x32_bf16 v[116:119], v[172:175], v[196:199], v[116:119]
    ds_read_b128 v[172:175], v2 offset:11264
    v_mfma_f32_16x16x32_bf16 v[64:67], v[176:179], v[192:195], v[64:67]
    v_mfma_f32_16x16x32_bf16 v[120:123], v[176:179], v[196:199], v[120:123]
    ds_read_b128 v[176:179], v2 offset:12288
    v_mfma_f32_16x16x32_bf16 v[68:71], v[180:183], v[192:195], v[68:71]
    v_mfma_f32_16x16x32_bf16 v[124:127], v[180:183], v[196:199], v[124:127]
    ds_read_b128 v[180:183], v2 offset:13312
    s_waitcnt lgkmcnt(13)
    v_mfma_f32_16x16x32_bf16 v[16:19], v[128:131], v[184:187], v[16:19]
    ds_read_b128 v[192:195], v5 offset:1024
    v_mfma_f32_16x16x32_bf16 v[72:75], v[128:131], v[188:191], v[72:75]
    ds_read_b128 v[196:199], v5 offset:3072
    s_waitcnt lgkmcnt(14)
    v_mfma_f32_16x16x32_bf16 v[20:23], v[132:135], v[184:187], v[20:23]
    ds_read_b128 v[128:131], v2 offset:14336
    v_mfma_f32_16x16x32_bf16 v[76:79], v[132:135], v[188:191], v[76:79]
    ds_read_b128 v[132:135], v2 offset:15360
    s_waitcnt lgkmcnt(15)
    v_mfma_f32_16x16x32_bf16 v[24:27], v[136:139], v[184:187], v[24:27]
    v_mfma_f32_16x16x32_bf16 v[80:83], v[136:139], v[188:191], v[80:83]
    ds_read_b128 v[136:139], v2 offset:16384
    s_waitcnt lgkmcnt(15)
    v_mfma_f32_16x16x32_bf16 v[28:31], v[140:143], v[184:187], v[28:31]
    v_mfma_f32_16x16x32_bf16 v[84:87], v[140:143], v[188:191], v[84:87]
    ds_read_b128 v[140:143], v2 offset:17408
    s_waitcnt lgkmcnt(15)
    v_mfma_f32_16x16x32_bf16 v[32:35], v[144:147], v[184:187], v[32:35]
    v_mfma_f32_16x16x32_bf16 v[88:91], v[144:147], v[188:191], v[88:91]
    ds_read_b128 v[144:147], v2 offset:18432
    s_waitcnt lgkmcnt(15)
    v_mfma_f32_16x16x32_bf16 v[36:39], v[148:151], v[184:187], v[36:39]
    v_mfma_f32_16x16x32_bf16 v[92:95], v[148:151], v[188:191], v[92:95]
    ds_read_b128 v[148:151], v2 offset:19456
    s_waitcnt lgkmcnt(15)
    v_mfma_f32_16x16x32_bf16 v[40:43], v[152:155], v[184:187], v[40:43]
    v_mfma_f32_16x16x32_bf16 v[96:99], v[152:155], v[188:191], v[96:99]
    ds_read_b128 v[152:155], v2 offset:20480
    s_waitcnt lgkmcnt(15)
    v_mfma_f32_16x16x32_bf16 v[44:47], v[156:159], v[184:187], v[44:47]
    v_mfma_f32_16x16x32_bf16 v[100:103], v[156:159], v[188:191], v[100:103]
    ds_read_b128 v[156:159], v2 offset:21504
    s_waitcnt lgkmcnt(15)
    v_mfma_f32_16x16x32_bf16 v[48:51], v[160:163], v[184:187], v[48:51]
    v_mfma_f32_16x16x32_bf16 v[104:107], v[160:163], v[188:191], v[104:107]
    ds_read_b128 v[160:163], v2 offset:22528
    s_waitcnt lgkmcnt(15)
    v_mfma_f32_16x16x32_bf16 v[52:55], v[164:167], v[184:187], v[52:55]
    v_mfma_f32_16x16x32_bf16 v[108:111], v[164:167], v[188:191], v[108:111]
    ds_read_b128 v[164:167], v2 offset:23552
    s_waitcnt lgkmcnt(15)
    v_mfma_f32_16x16x32_bf16 v[56:59], v[168:171], v[184:187], v[56:59]
    v_mfma_f32_16x16x32_bf16 v[112:115], v[168:171], v[188:191], v[112:115]
    ds_read_b128 v[168:171], v2 offset:24576
    s_waitcnt lgkmcnt(15)
    v_mfma_f32_16x16x32_bf16 v[60:63], v[172:175], v[184:187], v[60:63]
    v_mfma_f32_16x16x32_bf16 v[116:119], v[172:175], v[188:191], v[116:119]
    ds_read_b128 v[172:175], v2 offset:25600
    s_waitcnt lgkmcnt(15)
    v_mfma_f32_16x16x32_bf16 v[64:67], v[176:179], v[184:187], v[64:67]
    v_mfma_f32_16x16x32_bf16 v[120:123], v[176:179], v[188:191], v[120:123]
    ds_read_b128 v[176:179], v2 offset:26624
    s_waitcnt lgkmcnt(15)
    v_mfma_f32_16x16x32_bf16 v[68:71], v[180:183], v[184:187], v[68:71]
    v_mfma_f32_16x16x32_bf16 v[124:127], v[180:183], v[188:191], v[124:127]
    ds_read_b128 v[180:183], v2 offset:27648
    s_waitcnt lgkmcnt(13)
    v_mfma_f32_16x16x32_bf16 v[16:19], v[128:131], v[192:195], v[16:19]
    v_mfma_f32_16x16x32_bf16 v[72:75], v[128:131], v[196:199], v[72:75]
    s_waitcnt lgkmcnt(12)
    v_mfma_f32_16x16x32_bf16 v[20:23], v[132:135], v[192:195], v[20:23]
    v_mfma_f32_16x16x32_bf16 v[76:79], v[132:135], v[196:199], v[76:79]
    s_waitcnt lgkmcnt(11)
    v_mfma_f32_16x16x32_bf16 v[24:27], v[136:139], v[192:195], v[24:27]
    v_mfma_f32_16x16x32_bf16 v[80:83], v[136:139], v[196:199], v[80:83]
    s_waitcnt lgkmcnt(0)
    s_barrier
    v_mfma_f32_16x16x32_bf16 v[28:31], v[140:143], v[192:195], v[28:31]
    ds_read_b128 v[184:187], v5 offset:16384
    v_mfma_f32_16x16x32_bf16 v[84:87], v[140:143], v[196:199], v[84:87]
    ds_read_b128 v[188:191], v5 offset:18432
    v_mfma_f32_16x16x32_bf16 v[32:35], v[144:147], v[192:195], v[32:35]
    ds_read_b128 v[128:131], v2 offset:28672
    v_mfma_f32_16x16x32_bf16 v[88:91], v[144:147], v[196:199], v[88:91]
    ds_read_b128 v[132:135], v2 offset:29696
    v_mfma_f32_16x16x32_bf16 v[36:39], v[148:151], v[192:195], v[36:39]
    ds_read_b128 v[136:139], v2 offset:30720
    v_mfma_f32_16x16x32_bf16 v[92:95], v[148:151], v[196:199], v[92:95]
    ds_read_b128 v[140:143], v2 offset:31744
    v_mfma_f32_16x16x32_bf16 v[40:43], v[152:155], v[192:195], v[40:43]
    ds_read_b128 v[144:147], v2 offset:32768
    v_mfma_f32_16x16x32_bf16 v[96:99], v[152:155], v[196:199], v[96:99]
    ds_read_b128 v[148:151], v2 offset:33792
    v_mfma_f32_16x16x32_bf16 v[44:47], v[156:159], v[192:195], v[44:47]
    ds_read_b128 v[152:155], v2 offset:34816
    v_mfma_f32_16x16x32_bf16 v[100:103], v[156:159], v[196:199], v[100:103]
    ds_read_b128 v[156:159], v2 offset:35840
    v_mfma_f32_16x16x32_bf16 v[48:51], v[160:163], v[192:195], v[48:51]
    v_mfma_f32_16x16x32_bf16 v[104:107], v[160:163], v[196:199], v[104:107]
    ds_read_b128 v[160:163], v2 offset:36864
    v_mfma_f32_16x16x32_bf16 v[52:55], v[164:167], v[192:195], v[52:55]
    v_mfma_f32_16x16x32_bf16 v[108:111], v[164:167], v[196:199], v[108:111]
    ds_read_b128 v[164:167], v2 offset:37888
    v_mfma_f32_16x16x32_bf16 v[56:59], v[168:171], v[192:195], v[56:59]
    v_mfma_f32_16x16x32_bf16 v[112:115], v[168:171], v[196:199], v[112:115]
    ds_read_b128 v[168:171], v2 offset:38912
    v_mfma_f32_16x16x32_bf16 v[60:63], v[172:175], v[192:195], v[60:63]
    v_mfma_f32_16x16x32_bf16 v[116:119], v[172:175], v[196:199], v[116:119]
    ds_read_b128 v[172:175], v2 offset:39936
    v_mfma_f32_16x16x32_bf16 v[64:67], v[176:179], v[192:195], v[64:67]
    v_mfma_f32_16x16x32_bf16 v[120:123], v[176:179], v[196:199], v[120:123]
    ds_read_b128 v[176:179], v2 offset:40960
    v_mfma_f32_16x16x32_bf16 v[68:71], v[180:183], v[192:195], v[68:71]
    v_mfma_f32_16x16x32_bf16 v[124:127], v[180:183], v[196:199], v[124:127]
    ds_read_b128 v[180:183], v2 offset:41984
    s_waitcnt lgkmcnt(13)
    v_mfma_f32_16x16x32_bf16 v[16:19], v[128:131], v[184:187], v[16:19]
    ds_read_b128 v[192:195], v5 offset:17408
    v_mfma_f32_16x16x32_bf16 v[72:75], v[128:131], v[188:191], v[72:75]
    ds_read_b128 v[196:199], v5 offset:19456
    s_waitcnt lgkmcnt(14)
    v_mfma_f32_16x16x32_bf16 v[20:23], v[132:135], v[184:187], v[20:23]
    ds_read_b128 v[128:131], v2 offset:43008
    v_mfma_f32_16x16x32_bf16 v[76:79], v[132:135], v[188:191], v[76:79]
    ds_read_b128 v[132:135], v2 offset:44032
    s_waitcnt lgkmcnt(15)
    v_mfma_f32_16x16x32_bf16 v[24:27], v[136:139], v[184:187], v[24:27]
    v_mfma_f32_16x16x32_bf16 v[80:83], v[136:139], v[188:191], v[80:83]
    ds_read_b128 v[136:139], v2 offset:45056
    s_waitcnt lgkmcnt(15)
    v_mfma_f32_16x16x32_bf16 v[28:31], v[140:143], v[184:187], v[28:31]
    v_mfma_f32_16x16x32_bf16 v[84:87], v[140:143], v[188:191], v[84:87]
    ds_read_b128 v[140:143], v2 offset:46080
    s_waitcnt lgkmcnt(15)
    v_mfma_f32_16x16x32_bf16 v[32:35], v[144:147], v[184:187], v[32:35]
    v_mfma_f32_16x16x32_bf16 v[88:91], v[144:147], v[188:191], v[88:91]
    ds_read_b128 v[144:147], v2 offset:47104
    s_waitcnt lgkmcnt(15)
    v_mfma_f32_16x16x32_bf16 v[36:39], v[148:151], v[184:187], v[36:39]
    v_mfma_f32_16x16x32_bf16 v[92:95], v[148:151], v[188:191], v[92:95]
    ds_read_b128 v[148:151], v2 offset:48128
    s_waitcnt lgkmcnt(15)
    v_mfma_f32_16x16x32_bf16 v[40:43], v[152:155], v[184:187], v[40:43]
    v_mfma_f32_16x16x32_bf16 v[96:99], v[152:155], v[188:191], v[96:99]
    ds_read_b128 v[152:155], v2 offset:49152
    s_waitcnt lgkmcnt(15)
    v_mfma_f32_16x16x32_bf16 v[44:47], v[156:159], v[184:187], v[44:47]
    v_mfma_f32_16x16x32_bf16 v[100:103], v[156:159], v[188:191], v[100:103]
    ds_read_b128 v[156:159], v2 offset:50176
    s_waitcnt lgkmcnt(15)
    v_mfma_f32_16x16x32_bf16 v[48:51], v[160:163], v[184:187], v[48:51]
    v_mfma_f32_16x16x32_bf16 v[104:107], v[160:163], v[188:191], v[104:107]
    ds_read_b128 v[160:163], v2 offset:51200
    s_waitcnt lgkmcnt(15)
    v_mfma_f32_16x16x32_bf16 v[52:55], v[164:167], v[184:187], v[52:55]
    v_mfma_f32_16x16x32_bf16 v[108:111], v[164:167], v[188:191], v[108:111]
    ds_read_b128 v[164:167], v2 offset:52224
    s_waitcnt lgkmcnt(15)
    v_mfma_f32_16x16x32_bf16 v[56:59], v[168:171], v[184:187], v[56:59]
    v_mfma_f32_16x16x32_bf16 v[112:115], v[168:171], v[188:191], v[112:115]
    ds_read_b128 v[168:171], v2 offset:53248
    s_waitcnt lgkmcnt(15)
    v_mfma_f32_16x16x32_bf16 v[60:63], v[172:175], v[184:187], v[60:63]
    v_mfma_f32_16x16x32_bf16 v[116:119], v[172:175], v[188:191], v[116:119]
    ds_read_b128 v[172:175], v2 offset:54272
    s_waitcnt lgkmcnt(15)
    v_mfma_f32_16x16x32_bf16 v[64:67], v[176:179], v[184:187], v[64:67]
    v_mfma_f32_16x16x32_bf16 v[120:123], v[176:179], v[188:191], v[120:123]
    ds_read_b128 v[176:179], v2 offset:55296
    s_waitcnt lgkmcnt(15)
    v_mfma_f32_16x16x32_bf16 v[68:71], v[180:183], v[184:187], v[68:71]
    v_mfma_f32_16x16x32_bf16 v[124:127], v[180:183], v[188:191], v[124:127]
    ds_read_b128 v[180:183], v2 offset:56320
    s_waitcnt lgkmcnt(13)
    v_mfma_f32_16x16x32_bf16 v[16:19], v[128:131], v[192:195], v[16:19]
    v_mfma_f32_16x16x32_bf16 v[72:75], v[128:131], v[196:199], v[72:75]
    s_waitcnt lgkmcnt(12)
    v_mfma_f32_16x16x32_bf16 v[20:23], v[132:135], v[192:195], v[20:23]
    v_mfma_f32_16x16x32_bf16 v[76:79], v[132:135], v[196:199], v[76:79]
    s_waitcnt lgkmcnt(11)
    v_mfma_f32_16x16x32_bf16 v[24:27], v[136:139], v[192:195], v[24:27]
    v_mfma_f32_16x16x32_bf16 v[80:83], v[136:139], v[196:199], v[80:83]
    s_waitcnt lgkmcnt(0)
    s_barrier
    v_mfma_f32_16x16x32_bf16 v[28:31], v[140:143], v[192:195], v[28:31]
    ds_read_b128 v[184:187], v4 offset:0
    v_mfma_f32_16x16x32_bf16 v[84:87], v[140:143], v[196:199], v[84:87]
    ds_read_b128 v[188:191], v4 offset:2048
    v_mfma_f32_16x16x32_bf16 v[32:35], v[144:147], v[192:195], v[32:35]
    ds_read_b128 v[128:131], v3 offset:0
    v_mfma_f32_16x16x32_bf16 v[88:91], v[144:147], v[196:199], v[88:91]
    ds_read_b128 v[132:135], v3 offset:1024
    v_mfma_f32_16x16x32_bf16 v[36:39], v[148:151], v[192:195], v[36:39]
    ds_read_b128 v[136:139], v3 offset:2048
    v_mfma_f32_16x16x32_bf16 v[92:95], v[148:151], v[196:199], v[92:95]
    ds_read_b128 v[140:143], v3 offset:3072
    v_mfma_f32_16x16x32_bf16 v[40:43], v[152:155], v[192:195], v[40:43]
    ds_read_b128 v[144:147], v3 offset:4096
    v_mfma_f32_16x16x32_bf16 v[96:99], v[152:155], v[196:199], v[96:99]
    ds_read_b128 v[148:151], v3 offset:5120
    v_mfma_f32_16x16x32_bf16 v[44:47], v[156:159], v[192:195], v[44:47]
    ds_read_b128 v[152:155], v3 offset:6144
    v_mfma_f32_16x16x32_bf16 v[100:103], v[156:159], v[196:199], v[100:103]
    ds_read_b128 v[156:159], v3 offset:7168
    v_mfma_f32_16x16x32_bf16 v[48:51], v[160:163], v[192:195], v[48:51]
    v_mfma_f32_16x16x32_bf16 v[104:107], v[160:163], v[196:199], v[104:107]
    ds_read_b128 v[160:163], v3 offset:8192
    v_mfma_f32_16x16x32_bf16 v[52:55], v[164:167], v[192:195], v[52:55]
    v_mfma_f32_16x16x32_bf16 v[108:111], v[164:167], v[196:199], v[108:111]
    ds_read_b128 v[164:167], v3 offset:9216
    v_mfma_f32_16x16x32_bf16 v[56:59], v[168:171], v[192:195], v[56:59]
    v_mfma_f32_16x16x32_bf16 v[112:115], v[168:171], v[196:199], v[112:115]
    ds_read_b128 v[168:171], v3 offset:10240
    v_mfma_f32_16x16x32_bf16 v[60:63], v[172:175], v[192:195], v[60:63]
    v_mfma_f32_16x16x32_bf16 v[116:119], v[172:175], v[196:199], v[116:119]
    ds_read_b128 v[172:175], v3 offset:11264
    v_mfma_f32_16x16x32_bf16 v[64:67], v[176:179], v[192:195], v[64:67]
    v_mfma_f32_16x16x32_bf16 v[120:123], v[176:179], v[196:199], v[120:123]
    ds_read_b128 v[176:179], v3 offset:12288
    v_mfma_f32_16x16x32_bf16 v[68:71], v[180:183], v[192:195], v[68:71]
    v_mfma_f32_16x16x32_bf16 v[124:127], v[180:183], v[196:199], v[124:127]
    ds_read_b128 v[180:183], v3 offset:13312
    s_waitcnt lgkmcnt(13)
    v_mfma_f32_16x16x32_bf16 v[16:19], v[128:131], v[184:187], v[16:19]
    ds_read_b128 v[192:195], v4 offset:1024
    v_mfma_f32_16x16x32_bf16 v[72:75], v[128:131], v[188:191], v[72:75]
    ds_read_b128 v[196:199], v4 offset:3072
    s_waitcnt lgkmcnt(14)
    v_mfma_f32_16x16x32_bf16 v[20:23], v[132:135], v[184:187], v[20:23]
    ds_read_b128 v[128:131], v3 offset:14336
    v_mfma_f32_16x16x32_bf16 v[76:79], v[132:135], v[188:191], v[76:79]
    ds_read_b128 v[132:135], v3 offset:15360
    s_waitcnt lgkmcnt(15)
    v_mfma_f32_16x16x32_bf16 v[24:27], v[136:139], v[184:187], v[24:27]
    v_mfma_f32_16x16x32_bf16 v[80:83], v[136:139], v[188:191], v[80:83]
    ds_read_b128 v[136:139], v3 offset:16384
    s_waitcnt lgkmcnt(15)
    v_mfma_f32_16x16x32_bf16 v[28:31], v[140:143], v[184:187], v[28:31]
    v_mfma_f32_16x16x32_bf16 v[84:87], v[140:143], v[188:191], v[84:87]
    ds_read_b128 v[140:143], v3 offset:17408
    s_waitcnt lgkmcnt(15)
    v_mfma_f32_16x16x32_bf16 v[32:35], v[144:147], v[184:187], v[32:35]
    v_mfma_f32_16x16x32_bf16 v[88:91], v[144:147], v[188:191], v[88:91]
    ds_read_b128 v[144:147], v3 offset:18432
    s_waitcnt lgkmcnt(15)
    v_mfma_f32_16x16x32_bf16 v[36:39], v[148:151], v[184:187], v[36:39]
    v_mfma_f32_16x16x32_bf16 v[92:95], v[148:151], v[188:191], v[92:95]
    ds_read_b128 v[148:151], v3 offset:19456
    s_waitcnt lgkmcnt(15)
    v_mfma_f32_16x16x32_bf16 v[40:43], v[152:155], v[184:187], v[40:43]
    v_mfma_f32_16x16x32_bf16 v[96:99], v[152:155], v[188:191], v[96:99]
    ds_read_b128 v[152:155], v3 offset:20480
    s_waitcnt lgkmcnt(15)
    v_mfma_f32_16x16x32_bf16 v[44:47], v[156:159], v[184:187], v[44:47]
    v_mfma_f32_16x16x32_bf16 v[100:103], v[156:159], v[188:191], v[100:103]
    ds_read_b128 v[156:159], v3 offset:21504
    s_waitcnt lgkmcnt(15)
    v_mfma_f32_16x16x32_bf16 v[48:51], v[160:163], v[184:187], v[48:51]
    v_mfma_f32_16x16x32_bf16 v[104:107], v[160:163], v[188:191], v[104:107]
    ds_read_b128 v[160:163], v3 offset:22528
    s_waitcnt lgkmcnt(15)
    v_mfma_f32_16x16x32_bf16 v[52:55], v[164:167], v[184:187], v[52:55]
    v_mfma_f32_16x16x32_bf16 v[108:111], v[164:167], v[188:191], v[108:111]
    ds_read_b128 v[164:167], v3 offset:23552
    s_waitcnt lgkmcnt(15)
    v_mfma_f32_16x16x32_bf16 v[56:59], v[168:171], v[184:187], v[56:59]
    v_mfma_f32_16x16x32_bf16 v[112:115], v[168:171], v[188:191], v[112:115]
    ds_read_b128 v[168:171], v3 offset:24576
    s_waitcnt lgkmcnt(15)
    v_mfma_f32_16x16x32_bf16 v[60:63], v[172:175], v[184:187], v[60:63]
    v_mfma_f32_16x16x32_bf16 v[116:119], v[172:175], v[188:191], v[116:119]
    ds_read_b128 v[172:175], v3 offset:25600
    s_waitcnt lgkmcnt(15)
    v_mfma_f32_16x16x32_bf16 v[64:67], v[176:179], v[184:187], v[64:67]
    v_mfma_f32_16x16x32_bf16 v[120:123], v[176:179], v[188:191], v[120:123]
    ds_read_b128 v[176:179], v3 offset:26624
    s_waitcnt lgkmcnt(15)
    v_mfma_f32_16x16x32_bf16 v[68:71], v[180:183], v[184:187], v[68:71]
    v_mfma_f32_16x16x32_bf16 v[124:127], v[180:183], v[188:191], v[124:127]
    ds_read_b128 v[180:183], v3 offset:27648
    s_waitcnt lgkmcnt(13)
    v_mfma_f32_16x16x32_bf16 v[16:19], v[128:131], v[192:195], v[16:19]
    ds_read_b128 v[200:203], v8 offset:0
    v_mfma_f32_16x16x32_bf16 v[72:75], v[128:131], v[196:199], v[72:75]
    s_waitcnt lgkmcnt(13)
    v_mfma_f32_16x16x32_bf16 v[20:23], v[132:135], v[192:195], v[20:23]
    ds_read_b128 v[204:207], v8 offset:64
    v_mfma_f32_16x16x32_bf16 v[76:79], v[132:135], v[196:199], v[76:79]
    s_waitcnt lgkmcnt(13)
    v_mfma_f32_16x16x32_bf16 v[24:27], v[136:139], v[192:195], v[24:27]
    ds_read_b128 v[208:211], v8 offset:128
    v_mfma_f32_16x16x32_bf16 v[80:83], v[136:139], v[196:199], v[80:83]
    s_waitcnt lgkmcnt(13)
    v_mfma_f32_16x16x32_bf16 v[28:31], v[140:143], v[192:195], v[28:31]
    ds_read_b128 v[212:215], v8 offset:192
    v_mfma_f32_16x16x32_bf16 v[84:87], v[140:143], v[196:199], v[84:87]
    s_waitcnt lgkmcnt(13)
    v_mfma_f32_16x16x32_bf16 v[32:35], v[144:147], v[192:195], v[32:35]
    ds_read_b128 v[216:219], v8 offset:256
    v_mfma_f32_16x16x32_bf16 v[88:91], v[144:147], v[196:199], v[88:91]
    s_waitcnt lgkmcnt(13)
    v_mfma_f32_16x16x32_bf16 v[36:39], v[148:151], v[192:195], v[36:39]
    ds_read_b128 v[220:223], v8 offset:320
    v_mfma_f32_16x16x32_bf16 v[92:95], v[148:151], v[196:199], v[92:95]
    s_waitcnt lgkmcnt(13)
    v_mfma_f32_16x16x32_bf16 v[40:43], v[152:155], v[192:195], v[40:43]
    ds_read_b128 v[224:227], v8 offset:384
    v_mfma_f32_16x16x32_bf16 v[96:99], v[152:155], v[196:199], v[96:99]
    s_waitcnt lgkmcnt(13)
    v_mfma_f32_16x16x32_bf16 v[44:47], v[156:159], v[192:195], v[44:47]
    ds_read_b128 v[228:231], v8 offset:448
    v_mfma_f32_16x16x32_bf16 v[100:103], v[156:159], v[196:199], v[100:103]
    s_waitcnt lgkmcnt(13)
    v_mfma_f32_16x16x32_bf16 v[48:51], v[160:163], v[192:195], v[48:51]
    ds_read_b128 v[232:235], v8 offset:512
    v_mfma_f32_16x16x32_bf16 v[104:107], v[160:163], v[196:199], v[104:107]
    s_waitcnt lgkmcnt(13)
    v_mfma_f32_16x16x32_bf16 v[52:55], v[164:167], v[192:195], v[52:55]
    ds_read_b128 v[236:239], v8 offset:576
    v_mfma_f32_16x16x32_bf16 v[108:111], v[164:167], v[196:199], v[108:111]
    s_waitcnt lgkmcnt(13)
    v_mfma_f32_16x16x32_bf16 v[56:59], v[168:171], v[192:195], v[56:59]
    ds_read_b128 v[240:243], v8 offset:640
    v_mfma_f32_16x16x32_bf16 v[112:115], v[168:171], v[196:199], v[112:115]
    s_waitcnt lgkmcnt(13)
    v_mfma_f32_16x16x32_bf16 v[60:63], v[172:175], v[192:195], v[60:63]
    ds_read_b128 v[244:247], v8 offset:704
    v_mfma_f32_16x16x32_bf16 v[116:119], v[172:175], v[196:199], v[116:119]
    s_waitcnt lgkmcnt(13)
    v_mfma_f32_16x16x32_bf16 v[64:67], v[176:179], v[192:195], v[64:67]
    ds_read_b128 v[248:251], v8 offset:768
    v_mfma_f32_16x16x32_bf16 v[120:123], v[176:179], v[196:199], v[120:123]
    s_waitcnt lgkmcnt(13)
    v_mfma_f32_16x16x32_bf16 v[68:71], v[180:183], v[192:195], v[68:71]
    ds_read_b128 v[252:255], v8 offset:832
    v_mfma_f32_16x16x32_bf16 v[124:127], v[180:183], v[196:199], v[124:127]
    ds_read_b128 v[10:13], v9 offset:2048
    ds_read_b128 v[4:7], v9 offset:3072
    s_waitcnt lgkmcnt(0)
    s_barrier
    v_add_f32 v10, v10, v12
    v_add_f32 v11, v11, v13
    v_mov_b32 v12, v10
    v_mov_b32 v13, v11
    s_nop 0
    v_permlane32_swap_b32 v10, v12
    v_permlane32_swap_b32 v11, v13
    v_add_f32 v10, v10, v12
    v_add_f32 v11, v11, v13
    v_mov_b32 v12, v10
    v_mov_b32 v13, v11
    s_nop 0
    v_permlane16_swap_b32 v10, v12
    v_permlane16_swap_b32 v11, v13
    v_add_f32 v10, v10, v12
    v_add_f32 v11, v11, v13
    v_mul_f32 v128, s76, v10
    v_mul_f32 v130, s76, v11
    v_fma_f32 v130, -v128, v128, v130
    v_max_f32 v130, 0, v130
    v_add_f32 v130, s77, v130
    v_rsq_f32 v132, v130
    v_sub_f32 v128, 0, v128
    v_mul_f32 v132, s49, v132
    v_add_f32 v4, v4, v6
    v_add_f32 v5, v5, v7
    v_mov_b32 v6, v4
    v_mov_b32 v7, v5
    s_nop 0
    v_permlane32_swap_b32 v4, v6
    v_permlane32_swap_b32 v5, v7
    v_add_f32 v4, v4, v6
    v_add_f32 v5, v5, v7
    v_mov_b32 v6, v4
    v_mov_b32 v7, v5
    s_nop 0
    v_permlane16_swap_b32 v4, v6
    v_permlane16_swap_b32 v5, v7
    v_add_f32 v4, v4, v6
    v_add_f32 v5, v5, v7
    v_mul_f32 v134, s76, v4
    v_mul_f32 v136, s76, v5
    v_fma_f32 v136, -v134, v134, v136
    v_max_f32 v136, 0, v136
    v_add_f32 v136, s77, v136
    v_rsq_f32 v138, v136
    v_sub_f32 v134, 0, v134
    v_mul_f32 v138, s49, v138
    v_pk_fma_f32 v[16:17], v[200:201], v[128:129], v[16:17] op_sel_hi:[1,0,1]
    v_pk_fma_f32 v[18:19], v[202:203], v[128:129], v[18:19] op_sel_hi:[1,0,1]
    v_pk_mul_f32 v[172:173], v[16:17], v[132:133] op_sel_hi:[1,0]
    v_pk_mul_f32 v[174:175], v[18:19], v[132:133] op_sel_hi:[1,0]
    v_exp_f32 v172, v172
    v_exp_f32 v173, v173
    v_exp_f32 v174, v174
    v_exp_f32 v175, v175
    v_pk_fma_f32 v[44:45], v[228:229], v[128:129], v[44:45] op_sel_hi:[1,0,1]
    v_pk_fma_f32 v[46:47], v[230:231], v[128:129], v[46:47] op_sel_hi:[1,0,1]
    v_pk_fma_f32 v[172:173], v[172:173], v[130:131], v[130:131] op_sel_hi:[1,0,0]
    v_pk_fma_f32 v[174:175], v[174:175], v[130:131], v[130:131] op_sel_hi:[1,0,0]
    v_rcp_f32 v172, v172
    v_rcp_f32 v173, v173
    v_rcp_f32 v174, v174
    v_rcp_f32 v175, v175
    v_pk_mul_f32 v[44:45], v[16:17], v[44:45]
    v_pk_mul_f32 v[46:47], v[18:19], v[46:47]
    v_pk_mul_f32 v[44:45], v[44:45], v[172:173]
    v_pk_mul_f32 v[46:47], v[46:47], v[174:175]
    v_cvt_pk_bf16_f32 v140, v44, v45
    v_cvt_pk_bf16_f32 v141, v46, v47
    v_pk_fma_f32 v[20:21], v[204:205], v[128:129], v[20:21] op_sel_hi:[1,0,1]
    v_pk_fma_f32 v[22:23], v[206:207], v[128:129], v[22:23] op_sel_hi:[1,0,1]
    v_pk_mul_f32 v[176:177], v[20:21], v[132:133] op_sel_hi:[1,0]
    v_pk_mul_f32 v[178:179], v[22:23], v[132:133] op_sel_hi:[1,0]
    v_exp_f32 v176, v176
    v_exp_f32 v177, v177
    v_exp_f32 v178, v178
    v_exp_f32 v179, v179
    v_pk_fma_f32 v[48:49], v[232:233], v[128:129], v[48:49] op_sel_hi:[1,0,1]
    v_pk_fma_f32 v[50:51], v[234:235], v[128:129], v[50:51] op_sel_hi:[1,0,1]
    v_pk_fma_f32 v[176:177], v[176:177], v[130:131], v[130:131] op_sel_hi:[1,0,0]
    v_pk_fma_f32 v[178:179], v[178:179], v[130:131], v[130:131] op_sel_hi:[1,0,0]
    v_rcp_f32 v176, v176
    v_rcp_f32 v177, v177
    v_rcp_f32 v178, v178
    v_rcp_f32 v179, v179
    v_pk_mul_f32 v[48:49], v[20:21], v[48:49]
    v_pk_mul_f32 v[50:51], v[22:23], v[50:51]
    v_pk_mul_f32 v[48:49], v[48:49], v[176:177]
    v_pk_mul_f32 v[50:51], v[50:51], v[178:179]
    v_cvt_pk_bf16_f32 v142, v48, v49
    v_cvt_pk_bf16_f32 v143, v50, v51
    buffer_store_dwordx4 v[140:143], v2, s[8:11], s66 offen
    v_pk_fma_f32 v[24:25], v[208:209], v[128:129], v[24:25] op_sel_hi:[1,0,1]
    v_pk_fma_f32 v[26:27], v[210:211], v[128:129], v[26:27] op_sel_hi:[1,0,1]
    v_pk_mul_f32 v[172:173], v[24:25], v[132:133] op_sel_hi:[1,0]
    v_pk_mul_f32 v[174:175], v[26:27], v[132:133] op_sel_hi:[1,0]
    v_exp_f32 v172, v172
    v_exp_f32 v173, v173
    v_exp_f32 v174, v174
    v_exp_f32 v175, v175
    v_pk_fma_f32 v[52:53], v[236:237], v[128:129], v[52:53] op_sel_hi:[1,0,1]
    v_pk_fma_f32 v[54:55], v[238:239], v[128:129], v[54:55] op_sel_hi:[1,0,1]
    v_pk_fma_f32 v[172:173], v[172:173], v[130:131], v[130:131] op_sel_hi:[1,0,0]
    v_pk_fma_f32 v[174:175], v[174:175], v[130:131], v[130:131] op_sel_hi:[1,0,0]
    v_rcp_f32 v172, v172
    v_rcp_f32 v173, v173
    v_rcp_f32 v174, v174
    v_rcp_f32 v175, v175
    v_pk_mul_f32 v[52:53], v[24:25], v[52:53]
    v_pk_mul_f32 v[54:55], v[26:27], v[54:55]
    v_pk_mul_f32 v[52:53], v[52:53], v[172:173]
    v_pk_mul_f32 v[54:55], v[54:55], v[174:175]
    v_cvt_pk_bf16_f32 v144, v52, v53
    v_cvt_pk_bf16_f32 v145, v54, v55
    v_pk_fma_f32 v[28:29], v[212:213], v[128:129], v[28:29] op_sel_hi:[1,0,1]
    v_pk_fma_f32 v[30:31], v[214:215], v[128:129], v[30:31] op_sel_hi:[1,0,1]
    v_pk_mul_f32 v[176:177], v[28:29], v[132:133] op_sel_hi:[1,0]
    v_pk_mul_f32 v[178:179], v[30:31], v[132:133] op_sel_hi:[1,0]
    v_exp_f32 v176, v176
    v_exp_f32 v177, v177
    v_exp_f32 v178, v178
    v_exp_f32 v179, v179
    v_pk_fma_f32 v[56:57], v[240:241], v[128:129], v[56:57] op_sel_hi:[1,0,1]
    v_pk_fma_f32 v[58:59], v[242:243], v[128:129], v[58:59] op_sel_hi:[1,0,1]
    v_pk_fma_f32 v[176:177], v[176:177], v[130:131], v[130:131] op_sel_hi:[1,0,0]
    v_pk_fma_f32 v[178:179], v[178:179], v[130:131], v[130:131] op_sel_hi:[1,0,0]
    v_rcp_f32 v176, v176
    v_rcp_f32 v177, v177
    v_rcp_f32 v178, v178
    v_rcp_f32 v179, v179
    v_pk_mul_f32 v[56:57], v[28:29], v[56:57]
    v_pk_mul_f32 v[58:59], v[30:31], v[58:59]
    v_pk_mul_f32 v[56:57], v[56:57], v[176:177]
    v_pk_mul_f32 v[58:59], v[58:59], v[178:179]
    v_cvt_pk_bf16_f32 v146, v56, v57
    v_cvt_pk_bf16_f32 v147, v58, v59
    buffer_store_dwordx4 v[144:147], v2, s[8:11], s67 offen
    v_pk_fma_f32 v[32:33], v[216:217], v[128:129], v[32:33] op_sel_hi:[1,0,1]
    v_pk_fma_f32 v[34:35], v[218:219], v[128:129], v[34:35] op_sel_hi:[1,0,1]
    v_pk_mul_f32 v[172:173], v[32:33], v[132:133] op_sel_hi:[1,0]
    v_pk_mul_f32 v[174:175], v[34:35], v[132:133] op_sel_hi:[1,0]
    v_exp_f32 v172, v172
    v_exp_f32 v173, v173
    v_exp_f32 v174, v174
    v_exp_f32 v175, v175
    v_pk_fma_f32 v[60:61], v[244:245], v[128:129], v[60:61] op_sel_hi:[1,0,1]
    v_pk_fma_f32 v[62:63], v[246:247], v[128:129], v[62:63] op_sel_hi:[1,0,1]
    v_pk_fma_f32 v[172:173], v[172:173], v[130:131], v[130:131] op_sel_hi:[1,0,0]
    v_pk_fma_f32 v[174:175], v[174:175], v[130:131], v[130:131] op_sel_hi:[1,0,0]
    v_rcp_f32 v172, v172
    v_rcp_f32 v173, v173
    v_rcp_f32 v174, v174
    v_rcp_f32 v175, v175
    v_pk_mul_f32 v[60:61], v[32:33], v[60:61]
    v_pk_mul_f32 v[62:63], v[34:35], v[62:63]
    v_pk_mul_f32 v[60:61], v[60:61], v[172:173]
    v_pk_mul_f32 v[62:63], v[62:63], v[174:175]
    v_cvt_pk_bf16_f32 v148, v60, v61
    v_cvt_pk_bf16_f32 v149, v62, v63
    v_pk_fma_f32 v[36:37], v[220:221], v[128:129], v[36:37] op_sel_hi:[1,0,1]
    v_pk_fma_f32 v[38:39], v[222:223], v[128:129], v[38:39] op_sel_hi:[1,0,1]
    v_pk_mul_f32 v[176:177], v[36:37], v[132:133] op_sel_hi:[1,0]
    v_pk_mul_f32 v[178:179], v[38:39], v[132:133] op_sel_hi:[1,0]
    v_exp_f32 v176, v176
    v_exp_f32 v177, v177
    v_exp_f32 v178, v178
    v_exp_f32 v179, v179
    v_pk_fma_f32 v[64:65], v[248:249], v[128:129], v[64:65] op_sel_hi:[1,0,1]
    v_pk_fma_f32 v[66:67], v[250:251], v[128:129], v[66:67] op_sel_hi:[1,0,1]
    v_pk_fma_f32 v[176:177], v[176:177], v[130:131], v[130:131] op_sel_hi:[1,0,0]
    v_pk_fma_f32 v[178:179], v[178:179], v[130:131], v[130:131] op_sel_hi:[1,0,0]
    v_rcp_f32 v176, v176
    v_rcp_f32 v177, v177
    v_rcp_f32 v178, v178
    v_rcp_f32 v179, v179
    v_pk_mul_f32 v[64:65], v[36:37], v[64:65]
    v_pk_mul_f32 v[66:67], v[38:39], v[66:67]
    v_pk_mul_f32 v[64:65], v[64:65], v[176:177]
    v_pk_mul_f32 v[66:67], v[66:67], v[178:179]
    v_cvt_pk_bf16_f32 v150, v64, v65
    v_cvt_pk_bf16_f32 v151, v66, v67
    buffer_store_dwordx4 v[148:151], v2, s[8:11], s68 offen
    v_pk_fma_f32 v[40:41], v[224:225], v[128:129], v[40:41] op_sel_hi:[1,0,1]
    v_pk_fma_f32 v[42:43], v[226:227], v[128:129], v[42:43] op_sel_hi:[1,0,1]
    v_pk_mul_f32 v[172:173], v[40:41], v[132:133] op_sel_hi:[1,0]
    v_pk_mul_f32 v[174:175], v[42:43], v[132:133] op_sel_hi:[1,0]
    v_exp_f32 v172, v172
    v_exp_f32 v173, v173
    v_exp_f32 v174, v174
    v_exp_f32 v175, v175
    v_pk_fma_f32 v[68:69], v[252:253], v[128:129], v[68:69] op_sel_hi:[1,0,1]
    v_pk_fma_f32 v[70:71], v[254:255], v[128:129], v[70:71] op_sel_hi:[1,0,1]
    v_pk_fma_f32 v[172:173], v[172:173], v[130:131], v[130:131] op_sel_hi:[1,0,0]
    v_pk_fma_f32 v[174:175], v[174:175], v[130:131], v[130:131] op_sel_hi:[1,0,0]
    v_rcp_f32 v172, v172
    v_rcp_f32 v173, v173
    v_rcp_f32 v174, v174
    v_rcp_f32 v175, v175
    v_pk_mul_f32 v[68:69], v[40:41], v[68:69]
    v_pk_mul_f32 v[70:71], v[42:43], v[70:71]
    v_pk_mul_f32 v[68:69], v[68:69], v[172:173]
    v_pk_mul_f32 v[70:71], v[70:71], v[174:175]
    v_cvt_pk_bf16_f32 v152, v68, v69
    v_cvt_pk_bf16_f32 v153, v70, v71
    buffer_store_dwordx2 v[152:153], v2, s[8:11], s69 offen
    v_pk_fma_f32 v[72:73], v[200:201], v[134:135], v[72:73] op_sel_hi:[1,0,1]
    v_pk_fma_f32 v[74:75], v[202:203], v[134:135], v[74:75] op_sel_hi:[1,0,1]
    v_pk_mul_f32 v[172:173], v[72:73], v[138:139] op_sel_hi:[1,0]
    v_pk_mul_f32 v[174:175], v[74:75], v[138:139] op_sel_hi:[1,0]
    v_exp_f32 v172, v172
    v_exp_f32 v173, v173
    v_exp_f32 v174, v174
    v_exp_f32 v175, v175
    v_pk_fma_f32 v[100:101], v[228:229], v[134:135], v[100:101] op_sel_hi:[1,0,1]
    v_pk_fma_f32 v[102:103], v[230:231], v[134:135], v[102:103] op_sel_hi:[1,0,1]
    v_pk_fma_f32 v[172:173], v[172:173], v[136:137], v[136:137] op_sel_hi:[1,0,0]
    v_pk_fma_f32 v[174:175], v[174:175], v[136:137], v[136:137] op_sel_hi:[1,0,0]
    v_rcp_f32 v172, v172
    v_rcp_f32 v173, v173
    v_rcp_f32 v174, v174
    v_rcp_f32 v175, v175
    v_pk_mul_f32 v[100:101], v[72:73], v[100:101]
    v_pk_mul_f32 v[102:103], v[74:75], v[102:103]
    v_pk_mul_f32 v[100:101], v[100:101], v[172:173]
    v_pk_mul_f32 v[102:103], v[102:103], v[174:175]
    v_cvt_pk_bf16_f32 v156, v100, v101
    v_cvt_pk_bf16_f32 v157, v102, v103
    v_pk_fma_f32 v[76:77], v[204:205], v[134:135], v[76:77] op_sel_hi:[1,0,1]
    v_pk_fma_f32 v[78:79], v[206:207], v[134:135], v[78:79] op_sel_hi:[1,0,1]
    v_pk_mul_f32 v[176:177], v[76:77], v[138:139] op_sel_hi:[1,0]
    v_pk_mul_f32 v[178:179], v[78:79], v[138:139] op_sel_hi:[1,0]
    v_exp_f32 v176, v176
    v_exp_f32 v177, v177
    v_exp_f32 v178, v178
    v_exp_f32 v179, v179
    v_pk_fma_f32 v[104:105], v[232:233], v[134:135], v[104:105] op_sel_hi:[1,0,1]
    v_pk_fma_f32 v[106:107], v[234:235], v[134:135], v[106:107] op_sel_hi:[1,0,1]
    v_pk_fma_f32 v[176:177], v[176:177], v[136:137], v[136:137] op_sel_hi:[1,0,0]
    v_pk_fma_f32 v[178:179], v[178:179], v[136:137], v[136:137] op_sel_hi:[1,0,0]
    v_rcp_f32 v176, v176
    v_rcp_f32 v177, v177
    v_rcp_f32 v178, v178
    v_rcp_f32 v179, v179
    v_pk_mul_f32 v[104:105], v[76:77], v[104:105]
    v_pk_mul_f32 v[106:107], v[78:79], v[106:107]
    v_pk_mul_f32 v[104:105], v[104:105], v[176:177]
    v_pk_mul_f32 v[106:107], v[106:107], v[178:179]
    v_cvt_pk_bf16_f32 v158, v104, v105
    v_cvt_pk_bf16_f32 v159, v106, v107
    buffer_store_dwordx4 v[156:159], v2, s[8:11], s70 offen
    v_pk_fma_f32 v[80:81], v[208:209], v[134:135], v[80:81] op_sel_hi:[1,0,1]
    v_pk_fma_f32 v[82:83], v[210:211], v[134:135], v[82:83] op_sel_hi:[1,0,1]
    v_pk_mul_f32 v[172:173], v[80:81], v[138:139] op_sel_hi:[1,0]
    v_pk_mul_f32 v[174:175], v[82:83], v[138:139] op_sel_hi:[1,0]
    v_exp_f32 v172, v172
    v_exp_f32 v173, v173
    v_exp_f32 v174, v174
    v_exp_f32 v175, v175
    v_pk_fma_f32 v[108:109], v[236:237], v[134:135], v[108:109] op_sel_hi:[1,0,1]
    v_pk_fma_f32 v[110:111], v[238:239], v[134:135], v[110:111] op_sel_hi:[1,0,1]
    v_pk_fma_f32 v[172:173], v[172:173], v[136:137], v[136:137] op_sel_hi:[1,0,0]
    v_pk_fma_f32 v[174:175], v[174:175], v[136:137], v[136:137] op_sel_hi:[1,0,0]
    v_rcp_f32 v172, v172
    v_rcp_f32 v173, v173
    v_rcp_f32 v174, v174
    v_rcp_f32 v175, v175
    v_pk_mul_f32 v[108:109], v[80:81], v[108:109]
    v_pk_mul_f32 v[110:111], v[82:83], v[110:111]
    v_pk_mul_f32 v[108:109], v[108:109], v[172:173]
    v_pk_mul_f32 v[110:111], v[110:111], v[174:175]
    v_cvt_pk_bf16_f32 v160, v108, v109
    v_cvt_pk_bf16_f32 v161, v110, v111
    v_pk_fma_f32 v[84:85], v[212:213], v[134:135], v[84:85] op_sel_hi:[1,0,1]
    v_pk_fma_f32 v[86:87], v[214:215], v[134:135], v[86:87] op_sel_hi:[1,0,1]
    v_pk_mul_f32 v[176:177], v[84:85], v[138:139] op_sel_hi:[1,0]
    v_pk_mul_f32 v[178:179], v[86:87], v[138:139] op_sel_hi:[1,0]
    v_exp_f32 v176, v176
    v_exp_f32 v177, v177
    v_exp_f32 v178, v178
    v_exp_f32 v179, v179
    v_pk_fma_f32 v[112:113], v[240:241], v[134:135], v[112:113] op_sel_hi:[1,0,1]
    v_pk_fma_f32 v[114:115], v[242:243], v[134:135], v[114:115] op_sel_hi:[1,0,1]
    v_pk_fma_f32 v[176:177], v[176:177], v[136:137], v[136:137] op_sel_hi:[1,0,0]
    v_pk_fma_f32 v[178:179], v[178:179], v[136:137], v[136:137] op_sel_hi:[1,0,0]
    v_rcp_f32 v176, v176
    v_rcp_f32 v177, v177
    v_rcp_f32 v178, v178
    v_rcp_f32 v179, v179
    v_pk_mul_f32 v[112:113], v[84:85], v[112:113]
    v_pk_mul_f32 v[114:115], v[86:87], v[114:115]
    v_pk_mul_f32 v[112:113], v[112:113], v[176:177]
    v_pk_mul_f32 v[114:115], v[114:115], v[178:179]
    v_cvt_pk_bf16_f32 v162, v112, v113
    v_cvt_pk_bf16_f32 v163, v114, v115
    buffer_store_dwordx4 v[160:163], v2, s[8:11], s71 offen
    v_pk_fma_f32 v[88:89], v[216:217], v[134:135], v[88:89] op_sel_hi:[1,0,1]
    v_pk_fma_f32 v[90:91], v[218:219], v[134:135], v[90:91] op_sel_hi:[1,0,1]
    v_pk_mul_f32 v[172:173], v[88:89], v[138:139] op_sel_hi:[1,0]
    v_pk_mul_f32 v[174:175], v[90:91], v[138:139] op_sel_hi:[1,0]
    v_exp_f32 v172, v172
    v_exp_f32 v173, v173
    v_exp_f32 v174, v174
    v_exp_f32 v175, v175
    v_pk_fma_f32 v[116:117], v[244:245], v[134:135], v[116:117] op_sel_hi:[1,0,1]
    v_pk_fma_f32 v[118:119], v[246:247], v[134:135], v[118:119] op_sel_hi:[1,0,1]
    v_pk_fma_f32 v[172:173], v[172:173], v[136:137], v[136:137] op_sel_hi:[1,0,0]
    v_pk_fma_f32 v[174:175], v[174:175], v[136:137], v[136:137] op_sel_hi:[1,0,0]
    v_rcp_f32 v172, v172
    v_rcp_f32 v173, v173
    v_rcp_f32 v174, v174
    v_rcp_f32 v175, v175
    v_pk_mul_f32 v[116:117], v[88:89], v[116:117]
    v_pk_mul_f32 v[118:119], v[90:91], v[118:119]
    v_pk_mul_f32 v[116:117], v[116:117], v[172:173]
    v_pk_mul_f32 v[118:119], v[118:119], v[174:175]
    v_cvt_pk_bf16_f32 v164, v116, v117
    v_cvt_pk_bf16_f32 v165, v118, v119
    v_pk_fma_f32 v[92:93], v[220:221], v[134:135], v[92:93] op_sel_hi:[1,0,1]
    v_pk_fma_f32 v[94:95], v[222:223], v[134:135], v[94:95] op_sel_hi:[1,0,1]
    v_pk_mul_f32 v[176:177], v[92:93], v[138:139] op_sel_hi:[1,0]
    v_pk_mul_f32 v[178:179], v[94:95], v[138:139] op_sel_hi:[1,0]
    v_exp_f32 v176, v176
    v_exp_f32 v177, v177
    v_exp_f32 v178, v178
    v_exp_f32 v179, v179
    v_pk_fma_f32 v[120:121], v[248:249], v[134:135], v[120:121] op_sel_hi:[1,0,1]
    v_pk_fma_f32 v[122:123], v[250:251], v[134:135], v[122:123] op_sel_hi:[1,0,1]
    v_pk_fma_f32 v[176:177], v[176:177], v[136:137], v[136:137] op_sel_hi:[1,0,0]
    v_pk_fma_f32 v[178:179], v[178:179], v[136:137], v[136:137] op_sel_hi:[1,0,0]
    v_rcp_f32 v176, v176
    v_rcp_f32 v177, v177
    v_rcp_f32 v178, v178
    v_rcp_f32 v179, v179
    v_pk_mul_f32 v[120:121], v[92:93], v[120:121]
    v_pk_mul_f32 v[122:123], v[94:95], v[122:123]
    v_pk_mul_f32 v[120:121], v[120:121], v[176:177]
    v_pk_mul_f32 v[122:123], v[122:123], v[178:179]
    v_cvt_pk_bf16_f32 v166, v120, v121
    v_cvt_pk_bf16_f32 v167, v122, v123
    buffer_store_dwordx4 v[164:167], v2, s[8:11], s72 offen
    v_pk_fma_f32 v[96:97], v[224:225], v[134:135], v[96:97] op_sel_hi:[1,0,1]
    v_pk_fma_f32 v[98:99], v[226:227], v[134:135], v[98:99] op_sel_hi:[1,0,1]
    v_pk_mul_f32 v[172:173], v[96:97], v[138:139] op_sel_hi:[1,0]
    v_pk_mul_f32 v[174:175], v[98:99], v[138:139] op_sel_hi:[1,0]
    v_exp_f32 v172, v172
    v_exp_f32 v173, v173
    v_exp_f32 v174, v174
    v_exp_f32 v175, v175
    v_pk_fma_f32 v[124:125], v[252:253], v[134:135], v[124:125] op_sel_hi:[1,0,1]
    v_pk_fma_f32 v[126:127], v[254:255], v[134:135], v[126:127] op_sel_hi:[1,0,1]
    v_pk_fma_f32 v[172:173], v[172:173], v[136:137], v[136:137] op_sel_hi:[1,0,0]
    v_pk_fma_f32 v[174:175], v[174:175], v[136:137], v[136:137] op_sel_hi:[1,0,0]
    v_rcp_f32 v172, v172
    v_rcp_f32 v173, v173
    v_rcp_f32 v174, v174
    v_rcp_f32 v175, v175
    v_pk_mul_f32 v[124:125], v[96:97], v[124:125]
    v_pk_mul_f32 v[126:127], v[98:99], v[126:127]
    v_pk_mul_f32 v[124:125], v[124:125], v[172:173]
    v_pk_mul_f32 v[126:127], v[126:127], v[174:175]
    v_cvt_pk_bf16_f32 v168, v124, v125
    v_cvt_pk_bf16_f32 v169, v126, v127
    buffer_store_dwordx2 v[168:169], v2, s[8:11], s73 offen
    v_add_u32 v3, 61440, v2
    v_add_u32 v4, 110592, v2
    v_add_u32 v5, s34, v2
    v_add_u32 v6, 131072, v5
    v_add_u32 v5, 81920, v5
    v_and_b32 v7, 15, v0
    v_lshrrev_b32 v8, 4, v0
    v_mul_u32_u24 v7, 1280, v7
    v_lshl_add_u32 v7, v8, 4, v7
    s_add_u32 s12, s88, s37
    s_addc_u32 s13, s89, 0
    s_mov_b32 s14, 20480
    s_mov_b32 s15, 0x20000
    v_mov_b32 v14, s93
    s_waitcnt vmcnt(0)
    s_mov_b64 exec, 1
    s_cmp_eq_u32 s92, 1
    s_cbranch_scc1 L_pubf_86
    buffer_wbl2 sc1
    s_waitcnt vmcnt(0)
    buffer_store_dword v14, v15, s[24:27], s86 offen sc1
    s_branch L_pubd_86
L_pubf_86:
    buffer_store_dword v14, v15, s[24:27], s86 offen
L_pubd_86:
    s_mov_b64 exec, -1
    s_lshr_b32 s48, s31, 1
    s_lshl_b32 s48, s48, 6
    s_add_u32 s48, s48, 8192
    v_lshlrev_b32 v10, 2, v0
    s_mul_i32 s50, s31, 57344
    s_add_u32 s50, s50, 13041664
    s_add_u32 s52, s37, 7667712
    s_mov_b32 s53, s50
    s_cmp_eq_u32 s92, 1
    s_cselect_b32 s52, s52, s53
    s_and_b32 s50, s29, 3
    s_mul_i32 s50, s50, 3
    s_add_u32 s50, s50, s30
    s_sub_u32 s51, s50, 13
    s_cmp_ge_u32 s50, 13
    s_cselect_b32 s50, s51, s50
    s_lshl_b32 s50, s50, 12
    s_mov_b32 s51, s50
    s_add_u32 s51, s51, 4096
    s_sub_u32 s97, s51, 53248
    s_cmp_ge_u32 s51, 53248
    s_cselect_b32 s51, s97, s51
    s_cmp_lt_u32 s50, 20480
    s_cselect_b32 s54, s52, s53
    s_add_u32 s50, s50, s54
    s_cmp_lt_u32 s51, 20480
    s_cselect_b32 s54, s52, s53
    s_add_u32 s51, s51, s54
    s_mov_b64 exec, 0xffff
    s_mov_b32 s96, 0
L_poll_act:
    s_cmp_eq_u32 s92, 1
    s_cbranch_scc1 L_pl_act
    buffer_load_dword v11, v10, s[24:27], s48 offen sc1
    s_branch L_pw_act
L_pl_act:
    buffer_load_dword v11, v10, s[24:27], s48 offen sc1
L_pw_act:
    s_waitcnt vmcnt(0)
    v_cmp_ne_u32 vcc, s93, v11
    s_add_u32 s96, s96, 1
    s_cmp_eq_u64 vcc, 0
    s_cbranch_scc1 L_pdone_act
    s_cmp_lt_u32 s96, 200000
    s_sleep 1
    s_cbranch_scc1 L_poll_act
    s_endpgm
L_pdone_act:
    s_mov_b64 exec, -1
    s_cmp_eq_u32 s92, 1
    s_cbranch_scc1 L_pfast_act
    buffer_inv sc1
    s_waitcnt vmcnt(0)
L_pfast_act:
    s_add_u32 m0, s34, 81920
    s_nop 0
    buffer_load_dwordx4 v2, s[8:11], s50 offen offset:0 sc1 lds
    buffer_load_dwordx4 v2, s[8:11], s50 offen offset:1024 sc1 lds
    buffer_load_dwordx4 v2, s[8:11], s50 offen offset:2048 sc1 lds
    buffer_load_dwordx4 v2, s[8:11], s50 offen offset:3072 sc1 lds
    s_add_u32 m0, s34, 131072
    s_nop 0
    buffer_load_dwordx4 v2, s[8:11], s51 offen offset:0 sc1 lds
    buffer_load_dwordx4 v2, s[8:11], s51 offen offset:1024 sc1 lds
    buffer_load_dwordx4 v2, s[8:11], s51 offen offset:2048 sc1 lds
    buffer_load_dwordx4 v2, s[8:11], s51 offen offset:3072 sc1 lds
    buffer_load_dwordx4 v[196:199], v2, s[16:19], s40 offen sc1
    buffer_load_dwordx4 v[200:203], v2, s[16:19], s40 offen offset:1024 sc1
    buffer_load_dwordx2 v[204:205], v2, s[16:19], s42 offen sc1
    s_waitcnt vmcnt(7)
    s_barrier
    ds_read_b128 v[116:119], v5 offset:0
    ds_read_b128 v[36:39], v2 offset:0
    ds_read_b128 v[40:43], v2 offset:1024
    ds_read_b128 v[44:47], v2 offset:2048
    ds_read_b128 v[48:51], v2 offset:3072
    ds_read_b128 v[52:55], v2 offset:4096
    ds_read_b128 v[120:123], v5 offset:1024
    ds_read_b128 v[56:59], v2 offset:5120
    ds_read_b128 v[60:63], v2 offset:6144
    ds_read_b128 v[64:67], v2 offset:7168
    ds_read_b128 v[68:71], v2 offset:8192
    ds_read_b128 v[72:75], v2 offset:9216
    s_waitcnt lgkmcnt(6)
    v_mfma_f32_16x16x32_bf16 v[16:19], v[36:39], v[116:119], 0
    ds_read_b128 v[124:127], v5 offset:2048
    ds_read_b128 v[76:79], v2 offset:10240
    v_mfma_f32_16x16x32_bf16 v[20:23], v[40:43], v[116:119], 0
    ds_read_b128 v[80:83], v2 offset:11264
    v_mfma_f32_16x16x32_bf16 v[24:27], v[44:47], v[116:119], 0
    ds_read_b128 v[84:87], v2 offset:12288
    v_mfma_f32_16x16x32_bf16 v[28:31], v[48:51], v[116:119], 0
    ds_read_b128 v[88:91], v2 offset:13312
    v_mfma_f32_16x16x32_bf16 v[32:35], v[52:55], v[116:119], 0
    ds_read_b128 v[92:95], v2 offset:14336
    s_waitcnt lgkmcnt(6)
    v_mfma_f32_16x16x32_bf16 v[16:19], v[56:59], v[120:123], v[16:19]
    ds_read_b128 v[128:131], v5 offset:3072
    ds_read_b128 v[96:99], v2 offset:15360
    v_mfma_f32_16x16x32_bf16 v[20:23], v[60:63], v[120:123], v[20:23]
    ds_read_b128 v[100:103], v2 offset:16384
    v_mfma_f32_16x16x32_bf16 v[24:27], v[64:67], v[120:123], v[24:27]
    ds_read_b128 v[104:107], v2 offset:17408
    v_mfma_f32_16x16x32_bf16 v[28:31], v[68:71], v[120:123], v[28:31]
    ds_read_b128 v[108:111], v2 offset:18432
    v_mfma_f32_16x16x32_bf16 v[32:35], v[72:75], v[120:123], v[32:35]
    ds_read_b128 v[112:115], v2 offset:19456
    s_waitcnt vmcnt(3)
    s_waitcnt lgkmcnt(0)
    s_barrier
    v_mfma_f32_16x16x32_bf16 v[16:19], v[76:79], v[124:127], v[16:19]
    ds_read_b128 v[116:119], v6 offset:0
    ds_read_b128 v[36:39], v2 offset:20480
    v_mfma_f32_16x16x32_bf16 v[20:23], v[80:83], v[124:127], v[20:23]
    ds_read_b128 v[40:43], v2 offset:21504
    v_mfma_f32_16x16x32_bf16 v[24:27], v[84:87], v[124:127], v[24:27]
    ds_read_b128 v[44:47], v2 offset:22528
    v_mfma_f32_16x16x32_bf16 v[28:31], v[88:91], v[124:127], v[28:31]
    ds_read_b128 v[48:51], v2 offset:23552
    v_mfma_f32_16x16x32_bf16 v[32:35], v[92:95], v[124:127], v[32:35]
    ds_read_b128 v[52:55], v2 offset:24576
    v_mfma_f32_16x16x32_bf16 v[16:19], v[96:99], v[128:131], v[16:19]
    ds_read_b128 v[120:123], v6 offset:1024
    ds_read_b128 v[56:59], v2 offset:25600
    v_mfma_f32_16x16x32_bf16 v[20:23], v[100:103], v[128:131], v[20:23]
    ds_read_b128 v[60:63], v2 offset:26624
    v_mfma_f32_16x16x32_bf16 v[24:27], v[104:107], v[128:131], v[24:27]
    ds_read_b128 v[64:67], v2 offset:27648
    v_mfma_f32_16x16x32_bf16 v[28:31], v[108:111], v[128:131], v[28:31]
    ds_read_b128 v[68:71], v2 offset:28672
    v_mfma_f32_16x16x32_bf16 v[32:35], v[112:115], v[128:131], v[32:35]
    ds_read_b128 v[72:75], v2 offset:29696
    s_waitcnt lgkmcnt(6)
    v_mfma_f32_16x16x32_bf16 v[16:19], v[36:39], v[116:119], v[16:19]
    ds_read_b128 v[124:127], v6 offset:2048
    ds_read_b128 v[76:79], v2 offset:30720
    v_mfma_f32_16x16x32_bf16 v[20:23], v[40:43], v[116:119], v[20:23]
    ds_read_b128 v[80:83], v2 offset:31744
    v_mfma_f32_16x16x32_bf16 v[24:27], v[44:47], v[116:119], v[24:27]
    ds_read_b128 v[84:87], v2 offset:32768
    v_mfma_f32_16x16x32_bf16 v[28:31], v[48:51], v[116:119], v[28:31]
    ds_read_b128 v[88:91], v2 offset:33792
    v_mfma_f32_16x16x32_bf16 v[32:35], v[52:55], v[116:119], v[32:35]
    ds_read_b128 v[92:95], v2 offset:34816
    s_waitcnt lgkmcnt(6)
    v_mfma_f32_16x16x32_bf16 v[16:19], v[56:59], v[120:123], v[16:19]
    ds_read_b128 v[128:131], v6 offset:3072
    ds_read_b128 v[96:99], v2 offset:35840
    v_mfma_f32_16x16x32_bf16 v[20:23], v[60:63], v[120:123], v[20:23]
    ds_read_b128 v[100:103], v2 offset:36864
    v_mfma_f32_16x16x32_bf16 v[24:27], v[64:67], v[120:123], v[24:27]
    ds_read_b128 v[104:107], v2 offset:37888
    v_mfma_f32_16x16x32_bf16 v[28:31], v[68:71], v[120:123], v[28:31]
    ds_read_b128 v[108:111], v2 offset:38912
    v_mfma_f32_16x16x32_bf16 v[32:35], v[72:75], v[120:123], v[32:35]
    ds_read_b128 v[112:115], v2 offset:39936
    s_waitcnt lgkmcnt(0)
    s_barrier
    v_mfma_f32_16x16x32_bf16 v[16:19], v[76:79], v[124:127], v[16:19]
    ds_read_b128 v[116:119], v6 offset:16384
    ds_read_b128 v[36:39], v4 offset:0
    v_mfma_f32_16x16x32_bf16 v[20:23], v[80:83], v[124:127], v[20:23]
    ds_read_b128 v[40:43], v4 offset:1024
    v_mfma_f32_16x16x32_bf16 v[24:27], v[84:87], v[124:127], v[24:27]
    ds_read_b128 v[44:47], v4 offset:2048
    v_mfma_f32_16x16x32_bf16 v[28:31], v[88:91], v[124:127], v[28:31]
    ds_read_b128 v[48:51], v4 offset:3072
    v_mfma_f32_16x16x32_bf16 v[32:35], v[92:95], v[124:127], v[32:35]
    ds_read_b128 v[52:55], v4 offset:4096
    v_mfma_f32_16x16x32_bf16 v[16:19], v[96:99], v[128:131], v[16:19]
    ds_read_b128 v[120:123], v6 offset:17408
    ds_read_b128 v[56:59], v4 offset:5120
    v_mfma_f32_16x16x32_bf16 v[20:23], v[100:103], v[128:131], v[20:23]
    ds_read_b128 v[60:63], v4 offset:6144
    v_mfma_f32_16x16x32_bf16 v[24:27], v[104:107], v[128:131], v[24:27]
    ds_read_b128 v[64:67], v4 offset:7168
    v_mfma_f32_16x16x32_bf16 v[28:31], v[108:111], v[128:131], v[28:31]
    ds_read_b128 v[68:71], v4 offset:8192
    v_mfma_f32_16x16x32_bf16 v[32:35], v[112:115], v[128:131], v[32:35]
    ds_read_b128 v[72:75], v4 offset:9216
    s_waitcnt lgkmcnt(6)
    v_mfma_f32_16x16x32_bf16 v[16:19], v[36:39], v[116:119], v[16:19]
    ds_read_b128 v[124:127], v6 offset:18432
    ds_read_b128 v[76:79], v4 offset:10240
    v_mfma_f32_16x16x32_bf16 v[20:23], v[40:43], v[116:119], v[20:23]
    ds_read_b128 v[80:83], v4 offset:11264
    v_mfma_f32_16x16x32_bf16 v[24:27], v[44:47], v[116:119], v[24:27]
    ds_read_b128 v[84:87], v4 offset:12288
    v_mfma_f32_16x16x32_bf16 v[28:31], v[48:51], v[116:119], v[28:31]
    ds_read_b128 v[88:91], v4 offset:13312
    v_mfma_f32_16x16x32_bf16 v[32:35], v[52:55], v[116:119], v[32:35]
    ds_read_b128 v[92:95], v4 offset:14336
    s_waitcnt lgkmcnt(6)
    v_mfma_f32_16x16x32_bf16 v[16:19], v[56:59], v[120:123], v[16:19]
    ds_read_b128 v[128:131], v6 offset:19456
    ds_read_b128 v[96:99], v4 offset:15360
    v_mfma_f32_16x16x32_bf16 v[20:23], v[60:63], v[120:123], v[20:23]
    ds_read_b128 v[100:103], v4 offset:16384
    v_mfma_f32_16x16x32_bf16 v[24:27], v[64:67], v[120:123], v[24:27]
    ds_read_b128 v[104:107], v4 offset:17408
    v_mfma_f32_16x16x32_bf16 v[28:31], v[68:71], v[120:123], v[28:31]
    ds_read_b128 v[108:111], v4 offset:18432
    v_mfma_f32_16x16x32_bf16 v[32:35], v[72:75], v[120:123], v[32:35]
    ds_read_b128 v[112:115], v4 offset:19456
    s_waitcnt lgkmcnt(0)
    s_barrier
    v_mfma_f32_16x16x32_bf16 v[16:19], v[76:79], v[124:127], v[16:19]
    ds_read_b128 v[116:119], v5 offset:0
    ds_read_b128 v[36:39], v2 offset:40960
    v_mfma_f32_16x16x32_bf16 v[20:23], v[80:83], v[124:127], v[20:23]
    ds_read_b128 v[40:43], v2 offset:41984
    v_mfma_f32_16x16x32_bf16 v[24:27], v[84:87], v[124:127], v[24:27]
    ds_read_b128 v[44:47], v2 offset:43008
    v_mfma_f32_16x16x32_bf16 v[28:31], v[88:91], v[124:127], v[28:31]
    ds_read_b128 v[48:51], v2 offset:44032
    v_mfma_f32_16x16x32_bf16 v[32:35], v[92:95], v[124:127], v[32:35]
    ds_read_b128 v[52:55], v2 offset:45056
    v_mfma_f32_16x16x32_bf16 v[16:19], v[96:99], v[128:131], v[16:19]
    ds_read_b128 v[120:123], v5 offset:1024
    ds_read_b128 v[56:59], v2 offset:46080
    v_mfma_f32_16x16x32_bf16 v[20:23], v[100:103], v[128:131], v[20:23]
    ds_read_b128 v[60:63], v2 offset:47104
    v_mfma_f32_16x16x32_bf16 v[24:27], v[104:107], v[128:131], v[24:27]
    ds_read_b128 v[64:67], v2 offset:48128
    v_mfma_f32_16x16x32_bf16 v[28:31], v[108:111], v[128:131], v[28:31]
    ds_read_b128 v[68:71], v2 offset:49152
    v_mfma_f32_16x16x32_bf16 v[32:35], v[112:115], v[128:131], v[32:35]
    ds_read_b128 v[72:75], v2 offset:50176
    s_waitcnt lgkmcnt(6)
    v_mfma_f32_16x16x32_bf16 v[16:19], v[36:39], v[116:119], v[16:19]
    ds_read_b128 v[124:127], v5 offset:2048
    ds_read_b128 v[76:79], v2 offset:51200
    v_mfma_f32_16x16x32_bf16 v[20:23], v[40:43], v[116:119], v[20:23]
    ds_read_b128 v[80:83], v2 offset:52224
    v_mfma_f32_16x16x32_bf16 v[24:27], v[44:47], v[116:119], v[24:27]
    ds_read_b128 v[84:87], v2 offset:53248
    v_mfma_f32_16x16x32_bf16 v[28:31], v[48:51], v[116:119], v[28:31]
    ds_read_b128 v[88:91], v2 offset:54272
    v_mfma_f32_16x16x32_bf16 v[32:35], v[52:55], v[116:119], v[32:35]
    ds_read_b128 v[92:95], v2 offset:55296
    s_waitcnt lgkmcnt(6)
    v_mfma_f32_16x16x32_bf16 v[16:19], v[56:59], v[120:123], v[16:19]
    ds_read_b128 v[128:131], v5 offset:3072
    ds_read_b128 v[96:99], v2 offset:56320
    v_mfma_f32_16x16x32_bf16 v[20:23], v[60:63], v[120:123], v[20:23]
    ds_read_b128 v[100:103], v2 offset:57344
    v_mfma_f32_16x16x32_bf16 v[24:27], v[64:67], v[120:123], v[24:27]
    ds_read_b128 v[104:107], v2 offset:58368
    v_mfma_f32_16x16x32_bf16 v[28:31], v[68:71], v[120:123], v[28:31]
    ds_read_b128 v[108:111], v2 offset:59392
    v_mfma_f32_16x16x32_bf16 v[32:35], v[72:75], v[120:123], v[32:35]
    ds_read_b128 v[112:115], v2 offset:60416
    s_waitcnt lgkmcnt(0)
    s_barrier
    v_mfma_f32_16x16x32_bf16 v[16:19], v[76:79], v[124:127], v[16:19]
    ds_read_b128 v[116:119], v6 offset:0
    ds_read_b128 v[36:39], v3 offset:0
    v_mfma_f32_16x16x32_bf16 v[20:23], v[80:83], v[124:127], v[20:23]
    ds_read_b128 v[40:43], v3 offset:1024
    v_mfma_f32_16x16x32_bf16 v[24:27], v[84:87], v[124:127], v[24:27]
    ds_read_b128 v[44:47], v3 offset:2048
    v_mfma_f32_16x16x32_bf16 v[28:31], v[88:91], v[124:127], v[28:31]
    ds_read_b128 v[48:51], v3 offset:3072
    v_mfma_f32_16x16x32_bf16 v[32:35], v[92:95], v[124:127], v[32:35]
    ds_read_b128 v[52:55], v3 offset:4096
    v_mfma_f32_16x16x32_bf16 v[16:19], v[96:99], v[128:131], v[16:19]
    ds_read_b128 v[120:123], v6 offset:1024
    ds_read_b128 v[56:59], v3 offset:5120
    v_mfma_f32_16x16x32_bf16 v[20:23], v[100:103], v[128:131], v[20:23]
    ds_read_b128 v[60:63], v3 offset:6144
    v_mfma_f32_16x16x32_bf16 v[24:27], v[104:107], v[128:131], v[24:27]
    ds_read_b128 v[64:67], v3 offset:7168
    v_mfma_f32_16x16x32_bf16 v[28:31], v[108:111], v[128:131], v[28:31]
    ds_read_b128 v[68:71], v3 offset:8192
    v_mfma_f32_16x16x32_bf16 v[32:35], v[112:115], v[128:131], v[32:35]
    ds_read_b128 v[72:75], v3 offset:9216
    s_waitcnt lgkmcnt(6)
    v_mfma_f32_16x16x32_bf16 v[16:19], v[36:39], v[116:119], v[16:19]
    ds_read_b128 v[124:127], v6 offset:2048
    ds_read_b128 v[76:79], v3 offset:10240
    v_mfma_f32_16x16x32_bf16 v[20:23], v[40:43], v[116:119], v[20:23]
    ds_read_b128 v[80:83], v3 offset:11264
    v_mfma_f32_16x16x32_bf16 v[24:27], v[44:47], v[116:119], v[24:27]
    ds_read_b128 v[84:87], v3 offset:12288
    v_mfma_f32_16x16x32_bf16 v[28:31], v[48:51], v[116:119], v[28:31]
    ds_read_b128 v[88:91], v3 offset:13312
    v_mfma_f32_16x16x32_bf16 v[32:35], v[52:55], v[116:119], v[32:35]
    ds_read_b128 v[92:95], v3 offset:14336
    s_waitcnt lgkmcnt(6)
    v_mfma_f32_16x16x32_bf16 v[16:19], v[56:59], v[120:123], v[16:19]
    ds_read_b128 v[128:131], v6 offset:3072
    ds_read_b128 v[96:99], v3 offset:15360
    v_mfma_f32_16x16x32_bf16 v[20:23], v[60:63], v[120:123], v[20:23]
    ds_read_b128 v[100:103], v3 offset:16384
    v_mfma_f32_16x16x32_bf16 v[24:27], v[64:67], v[120:123], v[24:27]
    ds_read_b128 v[104:107], v3 offset:17408
    v_mfma_f32_16x16x32_bf16 v[28:31], v[68:71], v[120:123], v[28:31]
    ds_read_b128 v[108:111], v3 offset:18432
    v_mfma_f32_16x16x32_bf16 v[32:35], v[72:75], v[120:123], v[32:35]
    ds_read_b128 v[112:115], v3 offset:19456
    s_waitcnt lgkmcnt(0)
    s_barrier
    v_mfma_f32_16x16x32_bf16 v[16:19], v[76:79], v[124:127], v[16:19]
    ds_read_b128 v[116:119], v6 offset:16384
    ds_read_b128 v[36:39], v2 offset:0
    v_mfma_f32_16x16x32_bf16 v[20:23], v[80:83], v[124:127], v[20:23]
    ds_read_b128 v[40:43], v2 offset:1024
    v_mfma_f32_16x16x32_bf16 v[24:27], v[84:87], v[124:127], v[24:27]
    ds_read_b128 v[44:47], v2 offset:2048
    v_mfma_f32_16x16x32_bf16 v[28:31], v[88:91], v[124:127], v[28:31]
    ds_read_b128 v[48:51], v2 offset:3072
    v_mfma_f32_16x16x32_bf16 v[32:35], v[92:95], v[124:127], v[32:35]
    ds_read_b128 v[52:55], v2 offset:4096
    v_mfma_f32_16x16x32_bf16 v[16:19], v[96:99], v[128:131], v[16:19]
    ds_read_b128 v[120:123], v6 offset:17408
    ds_read_b128 v[56:59], v2 offset:5120
    v_mfma_f32_16x16x32_bf16 v[20:23], v[100:103], v[128:131], v[20:23]
    ds_read_b128 v[60:63], v2 offset:6144
    v_mfma_f32_16x16x32_bf16 v[24:27], v[104:107], v[128:131], v[24:27]
    ds_read_b128 v[64:67], v2 offset:7168
    v_mfma_f32_16x16x32_bf16 v[28:31], v[108:111], v[128:131], v[28:31]
    ds_read_b128 v[68:71], v2 offset:8192
    v_mfma_f32_16x16x32_bf16 v[32:35], v[112:115], v[128:131], v[32:35]
    ds_read_b128 v[72:75], v2 offset:9216
    s_waitcnt lgkmcnt(6)
    v_mfma_f32_16x16x32_bf16 v[16:19], v[36:39], v[116:119], v[16:19]
    ds_read_b128 v[124:127], v6 offset:18432
    ds_read_b128 v[76:79], v2 offset:10240
    v_mfma_f32_16x16x32_bf16 v[20:23], v[40:43], v[116:119], v[20:23]
    ds_read_b128 v[80:83], v2 offset:11264
    v_mfma_f32_16x16x32_bf16 v[24:27], v[44:47], v[116:119], v[24:27]
    ds_read_b128 v[84:87], v2 offset:12288
    v_mfma_f32_16x16x32_bf16 v[28:31], v[48:51], v[116:119], v[28:31]
    ds_read_b128 v[88:91], v2 offset:13312
    v_mfma_f32_16x16x32_bf16 v[32:35], v[52:55], v[116:119], v[32:35]
    ds_read_b128 v[92:95], v2 offset:14336
    s_waitcnt lgkmcnt(6)
    v_mfma_f32_16x16x32_bf16 v[16:19], v[56:59], v[120:123], v[16:19]
    ds_read_b128 v[128:131], v6 offset:19456
    ds_read_b128 v[96:99], v2 offset:15360
    v_mfma_f32_16x16x32_bf16 v[20:23], v[60:63], v[120:123], v[20:23]
    ds_read_b128 v[100:103], v2 offset:16384
    v_mfma_f32_16x16x32_bf16 v[24:27], v[64:67], v[120:123], v[24:27]
    ds_read_b128 v[104:107], v2 offset:17408
    v_mfma_f32_16x16x32_bf16 v[28:31], v[68:71], v[120:123], v[28:31]
    ds_read_b128 v[108:111], v2 offset:18432
    v_mfma_f32_16x16x32_bf16 v[32:35], v[72:75], v[120:123], v[32:35]
    ds_read_b128 v[112:115], v2 offset:19456
    s_waitcnt lgkmcnt(0)
    s_barrier
    v_mfma_f32_16x16x32_bf16 v[16:19], v[76:79], v[124:127], v[16:19]
    ds_read_b128 v[116:119], v5 offset:0
    ds_read_b128 v[36:39], v2 offset:20480
    v_mfma_f32_16x16x32_bf16 v[20:23], v[80:83], v[124:127], v[20:23]
    ds_read_b128 v[40:43], v2 offset:21504
    v_mfma_f32_16x16x32_bf16 v[24:27], v[84:87], v[124:127], v[24:27]
    ds_read_b128 v[44:47], v2 offset:22528
    v_mfma_f32_16x16x32_bf16 v[28:31], v[88:91], v[124:127], v[28:31]
    ds_read_b128 v[48:51], v2 offset:23552
    v_mfma_f32_16x16x32_bf16 v[32:35], v[92:95], v[124:127], v[32:35]
    ds_read_b128 v[52:55], v2 offset:24576
    v_mfma_f32_16x16x32_bf16 v[16:19], v[96:99], v[128:131], v[16:19]
    ds_read_b128 v[120:123], v5 offset:1024
    ds_read_b128 v[56:59], v2 offset:25600
    v_mfma_f32_16x16x32_bf16 v[20:23], v[100:103], v[128:131], v[20:23]
    ds_read_b128 v[60:63], v2 offset:26624
    v_mfma_f32_16x16x32_bf16 v[24:27], v[104:107], v[128:131], v[24:27]
    ds_read_b128 v[64:67], v2 offset:27648
    v_mfma_f32_16x16x32_bf16 v[28:31], v[108:111], v[128:131], v[28:31]
    ds_read_b128 v[68:71], v2 offset:28672
    v_mfma_f32_16x16x32_bf16 v[32:35], v[112:115], v[128:131], v[32:35]
    ds_read_b128 v[72:75], v2 offset:29696
    s_waitcnt lgkmcnt(6)
    v_mfma_f32_16x16x32_bf16 v[16:19], v[36:39], v[116:119], v[16:19]
    ds_read_b128 v[124:127], v5 offset:2048
    ds_read_b128 v[76:79], v2 offset:30720
    v_mfma_f32_16x16x32_bf16 v[20:23], v[40:43], v[116:119], v[20:23]
    ds_read_b128 v[80:83], v2 offset:31744
    v_mfma_f32_16x16x32_bf16 v[24:27], v[44:47], v[116:119], v[24:27]
    ds_read_b128 v[84:87], v2 offset:32768
    v_mfma_f32_16x16x32_bf16 v[28:31], v[48:51], v[116:119], v[28:31]
    ds_read_b128 v[88:91], v2 offset:33792
    v_mfma_f32_16x16x32_bf16 v[32:35], v[52:55], v[116:119], v[32:35]
    ds_read_b128 v[92:95], v2 offset:34816
    s_waitcnt lgkmcnt(6)
    v_mfma_f32_16x16x32_bf16 v[16:19], v[56:59], v[120:123], v[16:19]
    ds_read_b128 v[128:131], v5 offset:3072
    ds_read_b128 v[96:99], v2 offset:35840
    v_mfma_f32_16x16x32_bf16 v[20:23], v[60:63], v[120:123], v[20:23]
    ds_read_b128 v[100:103], v2 offset:36864
    v_mfma_f32_16x16x32_bf16 v[24:27], v[64:67], v[120:123], v[24:27]
    ds_read_b128 v[104:107], v2 offset:37888
    v_mfma_f32_16x16x32_bf16 v[28:31], v[68:71], v[120:123], v[28:31]
    ds_read_b128 v[108:111], v2 offset:38912
    v_mfma_f32_16x16x32_bf16 v[32:35], v[72:75], v[120:123], v[32:35]
    ds_read_b128 v[112:115], v2 offset:39936
    s_waitcnt lgkmcnt(0)
    s_barrier
    v_mfma_f32_16x16x32_bf16 v[16:19], v[76:79], v[124:127], v[16:19]
    ds_read_b128 v[116:119], v6 offset:0
    ds_read_b128 v[36:39], v4 offset:0
    v_mfma_f32_16x16x32_bf16 v[20:23], v[80:83], v[124:127], v[20:23]
    ds_read_b128 v[40:43], v4 offset:1024
    v_mfma_f32_16x16x32_bf16 v[24:27], v[84:87], v[124:127], v[24:27]
    ds_read_b128 v[44:47], v4 offset:2048
    v_mfma_f32_16x16x32_bf16 v[28:31], v[88:91], v[124:127], v[28:31]
    ds_read_b128 v[48:51], v4 offset:3072
    v_mfma_f32_16x16x32_bf16 v[32:35], v[92:95], v[124:127], v[32:35]
    ds_read_b128 v[52:55], v4 offset:4096
    v_mfma_f32_16x16x32_bf16 v[16:19], v[96:99], v[128:131], v[16:19]
    ds_read_b128 v[120:123], v6 offset:1024
    ds_read_b128 v[56:59], v4 offset:5120
    v_mfma_f32_16x16x32_bf16 v[20:23], v[100:103], v[128:131], v[20:23]
    ds_read_b128 v[60:63], v4 offset:6144
    v_mfma_f32_16x16x32_bf16 v[24:27], v[104:107], v[128:131], v[24:27]
    ds_read_b128 v[64:67], v4 offset:7168
    v_mfma_f32_16x16x32_bf16 v[28:31], v[108:111], v[128:131], v[28:31]
    ds_read_b128 v[68:71], v4 offset:8192
    v_mfma_f32_16x16x32_bf16 v[32:35], v[112:115], v[128:131], v[32:35]
    ds_read_b128 v[72:75], v4 offset:9216
    s_waitcnt lgkmcnt(6)
    v_mfma_f32_16x16x32_bf16 v[16:19], v[36:39], v[116:119], v[16:19]
    ds_read_b128 v[124:127], v6 offset:2048
    ds_read_b128 v[76:79], v4 offset:10240
    v_mfma_f32_16x16x32_bf16 v[20:23], v[40:43], v[116:119], v[20:23]
    ds_read_b128 v[80:83], v4 offset:11264
    v_mfma_f32_16x16x32_bf16 v[24:27], v[44:47], v[116:119], v[24:27]
    ds_read_b128 v[84:87], v4 offset:12288
    v_mfma_f32_16x16x32_bf16 v[28:31], v[48:51], v[116:119], v[28:31]
    ds_read_b128 v[88:91], v4 offset:13312
    v_mfma_f32_16x16x32_bf16 v[32:35], v[52:55], v[116:119], v[32:35]
    ds_read_b128 v[92:95], v4 offset:14336
    s_waitcnt lgkmcnt(6)
    v_mfma_f32_16x16x32_bf16 v[16:19], v[56:59], v[120:123], v[16:19]
    ds_read_b128 v[128:131], v6 offset:3072
    ds_read_b128 v[96:99], v4 offset:15360
    v_mfma_f32_16x16x32_bf16 v[20:23], v[60:63], v[120:123], v[20:23]
    ds_read_b128 v[100:103], v4 offset:16384
    v_mfma_f32_16x16x32_bf16 v[24:27], v[64:67], v[120:123], v[24:27]
    ds_read_b128 v[104:107], v4 offset:17408
    v_mfma_f32_16x16x32_bf16 v[28:31], v[68:71], v[120:123], v[28:31]
    ds_read_b128 v[108:111], v4 offset:18432
    v_mfma_f32_16x16x32_bf16 v[32:35], v[72:75], v[120:123], v[32:35]
    ds_read_b128 v[112:115], v4 offset:19456
    s_waitcnt lgkmcnt(0)
    s_barrier
    v_mfma_f32_16x16x32_bf16 v[16:19], v[76:79], v[124:127], v[16:19]
    ds_read_b128 v[116:119], v6 offset:16384
    ds_read_b128 v[36:39], v2 offset:40960
    v_mfma_f32_16x16x32_bf16 v[20:23], v[80:83], v[124:127], v[20:23]
    ds_read_b128 v[40:43], v2 offset:41984
    v_mfma_f32_16x16x32_bf16 v[24:27], v[84:87], v[124:127], v[24:27]
    ds_read_b128 v[44:47], v2 offset:43008
    v_mfma_f32_16x16x32_bf16 v[28:31], v[88:91], v[124:127], v[28:31]
    ds_read_b128 v[48:51], v2 offset:44032
    v_mfma_f32_16x16x32_bf16 v[32:35], v[92:95], v[124:127], v[32:35]
    ds_read_b128 v[52:55], v2 offset:45056
    v_mfma_f32_16x16x32_bf16 v[16:19], v[96:99], v[128:131], v[16:19]
    ds_read_b128 v[120:123], v6 offset:17408
    ds_read_b128 v[56:59], v2 offset:46080
    v_mfma_f32_16x16x32_bf16 v[20:23], v[100:103], v[128:131], v[20:23]
    ds_read_b128 v[60:63], v2 offset:47104
    v_mfma_f32_16x16x32_bf16 v[24:27], v[104:107], v[128:131], v[24:27]
    ds_read_b128 v[64:67], v2 offset:48128
    v_mfma_f32_16x16x32_bf16 v[28:31], v[108:111], v[128:131], v[28:31]
    ds_read_b128 v[68:71], v2 offset:49152
    v_mfma_f32_16x16x32_bf16 v[32:35], v[112:115], v[128:131], v[32:35]
    ds_read_b128 v[72:75], v2 offset:50176
    s_waitcnt lgkmcnt(6)
    v_mfma_f32_16x16x32_bf16 v[16:19], v[36:39], v[116:119], v[16:19]
    ds_read_b128 v[124:127], v6 offset:18432
    ds_read_b128 v[76:79], v2 offset:51200
    v_mfma_f32_16x16x32_bf16 v[20:23], v[40:43], v[116:119], v[20:23]
    ds_read_b128 v[80:83], v2 offset:52224
    v_mfma_f32_16x16x32_bf16 v[24:27], v[44:47], v[116:119], v[24:27]
    ds_read_b128 v[84:87], v2 offset:53248
    v_mfma_f32_16x16x32_bf16 v[28:31], v[48:51], v[116:119], v[28:31]
    ds_read_b128 v[88:91], v2 offset:54272
    v_mfma_f32_16x16x32_bf16 v[32:35], v[52:55], v[116:119], v[32:35]
    ds_read_b128 v[92:95], v2 offset:55296
    s_waitcnt lgkmcnt(6)
    v_mfma_f32_16x16x32_bf16 v[16:19], v[56:59], v[120:123], v[16:19]
    ds_read_b128 v[128:131], v6 offset:19456
    ds_read_b128 v[96:99], v2 offset:56320
    v_mfma_f32_16x16x32_bf16 v[20:23], v[60:63], v[120:123], v[20:23]
    ds_read_b128 v[100:103], v2 offset:57344
    v_mfma_f32_16x16x32_bf16 v[24:27], v[64:67], v[120:123], v[24:27]
    ds_read_b128 v[104:107], v2 offset:58368
    v_mfma_f32_16x16x32_bf16 v[28:31], v[68:71], v[120:123], v[28:31]
    ds_read_b128 v[108:111], v2 offset:59392
    v_mfma_f32_16x16x32_bf16 v[32:35], v[72:75], v[120:123], v[32:35]
    ds_read_b128 v[112:115], v2 offset:60416
    s_waitcnt lgkmcnt(0)
    s_barrier
    v_mfma_f32_16x16x32_bf16 v[16:19], v[76:79], v[124:127], v[16:19]
    ds_read_b128 v[116:119], v5 offset:0
    ds_read_b128 v[36:39], v3 offset:0
    v_mfma_f32_16x16x32_bf16 v[20:23], v[80:83], v[124:127], v[20:23]
    ds_read_b128 v[40:43], v3 offset:1024
    v_mfma_f32_16x16x32_bf16 v[24:27], v[84:87], v[124:127], v[24:27]
    ds_read_b128 v[44:47], v3 offset:2048
    v_mfma_f32_16x16x32_bf16 v[28:31], v[88:91], v[124:127], v[28:31]
    ds_read_b128 v[48:51], v3 offset:3072
    v_mfma_f32_16x16x32_bf16 v[32:35], v[92:95], v[124:127], v[32:35]
    ds_read_b128 v[52:55], v3 offset:4096
    v_mfma_f32_16x16x32_bf16 v[16:19], v[96:99], v[128:131], v[16:19]
    ds_read_b128 v[120:123], v5 offset:1024
    ds_read_b128 v[56:59], v3 offset:5120
    v_mfma_f32_16x16x32_bf16 v[20:23], v[100:103], v[128:131], v[20:23]
    ds_read_b128 v[60:63], v3 offset:6144
    v_mfma_f32_16x16x32_bf16 v[24:27], v[104:107], v[128:131], v[24:27]
    ds_read_b128 v[64:67], v3 offset:7168
    v_mfma_f32_16x16x32_bf16 v[28:31], v[108:111], v[128:131], v[28:31]
    ds_read_b128 v[68:71], v3 offset:8192
    v_mfma_f32_16x16x32_bf16 v[32:35], v[112:115], v[128:131], v[32:35]
    ds_read_b128 v[72:75], v3 offset:9216
    s_waitcnt lgkmcnt(6)
    v_mfma_f32_16x16x32_bf16 v[16:19], v[36:39], v[116:119], v[16:19]
    ds_read_b128 v[124:127], v5 offset:2048
    ds_read_b128 v[76:79], v3 offset:10240
    v_mfma_f32_16x16x32_bf16 v[20:23], v[40:43], v[116:119], v[20:23]
    ds_read_b128 v[80:83], v3 offset:11264
    v_mfma_f32_16x16x32_bf16 v[24:27], v[44:47], v[116:119], v[24:27]
    ds_read_b128 v[84:87], v3 offset:12288
    v_mfma_f32_16x16x32_bf16 v[28:31], v[48:51], v[116:119], v[28:31]
    ds_read_b128 v[88:91], v3 offset:13312
    v_mfma_f32_16x16x32_bf16 v[32:35], v[52:55], v[116:119], v[32:35]
    ds_read_b128 v[92:95], v3 offset:14336
    s_waitcnt lgkmcnt(6)
    v_mfma_f32_16x16x32_bf16 v[16:19], v[56:59], v[120:123], v[16:19]
    ds_read_b128 v[128:131], v5 offset:3072
    ds_read_b128 v[96:99], v3 offset:15360
    v_mfma_f32_16x16x32_bf16 v[20:23], v[60:63], v[120:123], v[20:23]
    ds_read_b128 v[100:103], v3 offset:16384
    v_mfma_f32_16x16x32_bf16 v[24:27], v[64:67], v[120:123], v[24:27]
    ds_read_b128 v[104:107], v3 offset:17408
    v_mfma_f32_16x16x32_bf16 v[28:31], v[68:71], v[120:123], v[28:31]
    ds_read_b128 v[108:111], v3 offset:18432
    v_mfma_f32_16x16x32_bf16 v[32:35], v[72:75], v[120:123], v[32:35]
    ds_read_b128 v[112:115], v3 offset:19456
    s_waitcnt lgkmcnt(0)
    s_barrier
    v_mfma_f32_16x16x32_bf16 v[16:19], v[76:79], v[124:127], v[16:19]
    ds_read_b128 v[116:119], v6 offset:0
    ds_read_b128 v[36:39], v2 offset:0
    v_mfma_f32_16x16x32_bf16 v[20:23], v[80:83], v[124:127], v[20:23]
    ds_read_b128 v[40:43], v2 offset:1024
    v_mfma_f32_16x16x32_bf16 v[24:27], v[84:87], v[124:127], v[24:27]
    ds_read_b128 v[44:47], v2 offset:2048
    v_mfma_f32_16x16x32_bf16 v[28:31], v[88:91], v[124:127], v[28:31]
    ds_read_b128 v[48:51], v2 offset:3072
    v_mfma_f32_16x16x32_bf16 v[32:35], v[92:95], v[124:127], v[32:35]
    ds_read_b128 v[52:55], v2 offset:4096
    v_mfma_f32_16x16x32_bf16 v[16:19], v[96:99], v[128:131], v[16:19]
    ds_read_b128 v[120:123], v6 offset:1024
    ds_read_b128 v[56:59], v2 offset:5120
    v_mfma_f32_16x16x32_bf16 v[20:23], v[100:103], v[128:131], v[20:23]
    ds_read_b128 v[60:63], v2 offset:6144
    v_mfma_f32_16x16x32_bf16 v[24:27], v[104:107], v[128:131], v[24:27]
    ds_read_b128 v[64:67], v2 offset:7168
    v_mfma_f32_16x16x32_bf16 v[28:31], v[108:111], v[128:131], v[28:31]
    ds_read_b128 v[68:71], v2 offset:8192
    v_mfma_f32_16x16x32_bf16 v[32:35], v[112:115], v[128:131], v[32:35]
    ds_read_b128 v[72:75], v2 offset:9216
    s_waitcnt lgkmcnt(6)
    v_mfma_f32_16x16x32_bf16 v[16:19], v[36:39], v[116:119], v[16:19]
    ds_read_b128 v[124:127], v6 offset:2048
    ds_read_b128 v[76:79], v2 offset:10240
    v_mfma_f32_16x16x32_bf16 v[20:23], v[40:43], v[116:119], v[20:23]
    ds_read_b128 v[80:83], v2 offset:11264
    v_mfma_f32_16x16x32_bf16 v[24:27], v[44:47], v[116:119], v[24:27]
    ds_read_b128 v[84:87], v2 offset:12288
    v_mfma_f32_16x16x32_bf16 v[28:31], v[48:51], v[116:119], v[28:31]
    ds_read_b128 v[88:91], v2 offset:13312
    v_mfma_f32_16x16x32_bf16 v[32:35], v[52:55], v[116:119], v[32:35]
    ds_read_b128 v[92:95], v2 offset:14336
    s_waitcnt lgkmcnt(6)
    v_mfma_f32_16x16x32_bf16 v[16:19], v[56:59], v[120:123], v[16:19]
    ds_read_b128 v[128:131], v6 offset:3072
    ds_read_b128 v[96:99], v2 offset:15360
    v_mfma_f32_16x16x32_bf16 v[20:23], v[60:63], v[120:123], v[20:23]
    ds_read_b128 v[100:103], v2 offset:16384
    v_mfma_f32_16x16x32_bf16 v[24:27], v[64:67], v[120:123], v[24:27]
    ds_read_b128 v[104:107], v2 offset:17408
    v_mfma_f32_16x16x32_bf16 v[28:31], v[68:71], v[120:123], v[28:31]
    ds_read_b128 v[108:111], v2 offset:18432
    v_mfma_f32_16x16x32_bf16 v[32:35], v[72:75], v[120:123], v[32:35]
    ds_read_b128 v[112:115], v2 offset:19456
    s_waitcnt lgkmcnt(0)
    s_barrier
    v_mfma_f32_16x16x32_bf16 v[16:19], v[76:79], v[124:127], v[16:19]
    ds_read_b128 v[116:119], v6 offset:16384
    ds_read_b128 v[36:39], v2 offset:20480
    v_mfma_f32_16x16x32_bf16 v[20:23], v[80:83], v[124:127], v[20:23]
    ds_read_b128 v[40:43], v2 offset:21504
    v_mfma_f32_16x16x32_bf16 v[24:27], v[84:87], v[124:127], v[24:27]
    ds_read_b128 v[44:47], v2 offset:22528
    v_mfma_f32_16x16x32_bf16 v[28:31], v[88:91], v[124:127], v[28:31]
    ds_read_b128 v[48:51], v2 offset:23552
    v_mfma_f32_16x16x32_bf16 v[32:35], v[92:95], v[124:127], v[32:35]
    ds_read_b128 v[52:55], v2 offset:24576
    v_mfma_f32_16x16x32_bf16 v[16:19], v[96:99], v[128:131], v[16:19]
    ds_read_b128 v[120:123], v6 offset:17408
    ds_read_b128 v[56:59], v2 offset:25600
    v_mfma_f32_16x16x32_bf16 v[20:23], v[100:103], v[128:131], v[20:23]
    ds_read_b128 v[60:63], v2 offset:26624
    v_mfma_f32_16x16x32_bf16 v[24:27], v[104:107], v[128:131], v[24:27]
    ds_read_b128 v[64:67], v2 offset:27648
    v_mfma_f32_16x16x32_bf16 v[28:31], v[108:111], v[128:131], v[28:31]
    ds_read_b128 v[68:71], v2 offset:28672
    v_mfma_f32_16x16x32_bf16 v[32:35], v[112:115], v[128:131], v[32:35]
    ds_read_b128 v[72:75], v2 offset:29696
    s_waitcnt lgkmcnt(6)
    v_mfma_f32_16x16x32_bf16 v[16:19], v[36:39], v[116:119], v[16:19]
    ds_read_b128 v[124:127], v6 offset:18432
    ds_read_b128 v[76:79], v2 offset:30720
    v_mfma_f32_16x16x32_bf16 v[20:23], v[40:43], v[116:119], v[20:23]
    ds_read_b128 v[80:83], v2 offset:31744
    v_mfma_f32_16x16x32_bf16 v[24:27], v[44:47], v[116:119], v[24:27]
    ds_read_b128 v[84:87], v2 offset:32768
    v_mfma_f32_16x16x32_bf16 v[28:31], v[48:51], v[116:119], v[28:31]
    ds_read_b128 v[88:91], v2 offset:33792
    v_mfma_f32_16x16x32_bf16 v[32:35], v[52:55], v[116:119], v[32:35]
    ds_read_b128 v[92:95], v2 offset:34816
    s_waitcnt lgkmcnt(6)
    v_mfma_f32_16x16x32_bf16 v[16:19], v[56:59], v[120:123], v[16:19]
    ds_read_b128 v[128:131], v6 offset:19456
    ds_read_b128 v[96:99], v2 offset:35840
    v_mfma_f32_16x16x32_bf16 v[20:23], v[60:63], v[120:123], v[20:23]
    ds_read_b128 v[100:103], v2 offset:36864
    v_mfma_f32_16x16x32_bf16 v[24:27], v[64:67], v[120:123], v[24:27]
    ds_read_b128 v[104:107], v2 offset:37888
    v_mfma_f32_16x16x32_bf16 v[28:31], v[68:71], v[120:123], v[28:31]
    ds_read_b128 v[108:111], v2 offset:38912
    v_mfma_f32_16x16x32_bf16 v[32:35], v[72:75], v[120:123], v[32:35]
    ds_read_b128 v[112:115], v2 offset:39936
    s_waitcnt lgkmcnt(0)
    s_barrier
    v_mfma_f32_16x16x32_bf16 v[16:19], v[76:79], v[124:127], v[16:19]
    ds_read_b128 v[116:119], v5 offset:0
    ds_read_b128 v[36:39], v4 offset:0
    v_mfma_f32_16x16x32_bf16 v[20:23], v[80:83], v[124:127], v[20:23]
    ds_read_b128 v[40:43], v4 offset:1024
    v_mfma_f32_16x16x32_bf16 v[24:27], v[84:87], v[124:127], v[24:27]
    ds_read_b128 v[44:47], v4 offset:2048
    v_mfma_f32_16x16x32_bf16 v[28:31], v[88:91], v[124:127], v[28:31]
    ds_read_b128 v[48:51], v4 offset:3072
    v_mfma_f32_16x16x32_bf16 v[32:35], v[92:95], v[124:127], v[32:35]
    ds_read_b128 v[52:55], v4 offset:4096
    v_mfma_f32_16x16x32_bf16 v[16:19], v[96:99], v[128:131], v[16:19]
    ds_read_b128 v[120:123], v5 offset:1024
    ds_read_b128 v[56:59], v4 offset:5120
    v_mfma_f32_16x16x32_bf16 v[20:23], v[100:103], v[128:131], v[20:23]
    ds_read_b128 v[60:63], v4 offset:6144
    v_mfma_f32_16x16x32_bf16 v[24:27], v[104:107], v[128:131], v[24:27]
    ds_read_b128 v[64:67], v4 offset:7168
    v_mfma_f32_16x16x32_bf16 v[28:31], v[108:111], v[128:131], v[28:31]
    ds_read_b128 v[68:71], v4 offset:8192
    v_mfma_f32_16x16x32_bf16 v[32:35], v[112:115], v[128:131], v[32:35]
    ds_read_b128 v[72:75], v4 offset:9216
    s_waitcnt lgkmcnt(6)
    v_mfma_f32_16x16x32_bf16 v[16:19], v[36:39], v[116:119], v[16:19]
    ds_read_b128 v[124:127], v5 offset:2048
    ds_read_b128 v[76:79], v4 offset:10240
    v_mfma_f32_16x16x32_bf16 v[20:23], v[40:43], v[116:119], v[20:23]
    ds_read_b128 v[80:83], v4 offset:11264
    v_mfma_f32_16x16x32_bf16 v[24:27], v[44:47], v[116:119], v[24:27]
    ds_read_b128 v[84:87], v4 offset:12288
    v_mfma_f32_16x16x32_bf16 v[28:31], v[48:51], v[116:119], v[28:31]
    ds_read_b128 v[88:91], v4 offset:13312
    v_mfma_f32_16x16x32_bf16 v[32:35], v[52:55], v[116:119], v[32:35]
    ds_read_b128 v[92:95], v4 offset:14336
    s_waitcnt lgkmcnt(6)
    v_mfma_f32_16x16x32_bf16 v[16:19], v[56:59], v[120:123], v[16:19]
    ds_read_b128 v[128:131], v5 offset:3072
    ds_read_b128 v[96:99], v4 offset:15360
    v_mfma_f32_16x16x32_bf16 v[20:23], v[60:63], v[120:123], v[20:23]
    ds_read_b128 v[100:103], v4 offset:16384
    v_mfma_f32_16x16x32_bf16 v[24:27], v[64:67], v[120:123], v[24:27]
    ds_read_b128 v[104:107], v4 offset:17408
    v_mfma_f32_16x16x32_bf16 v[28:31], v[68:71], v[120:123], v[28:31]
    ds_read_b128 v[108:111], v4 offset:18432
    v_mfma_f32_16x16x32_bf16 v[32:35], v[72:75], v[120:123], v[32:35]
    ds_read_b128 v[112:115], v4 offset:19456
    s_waitcnt lgkmcnt(0)
    s_barrier
    v_mfma_f32_16x16x32_bf16 v[16:19], v[76:79], v[124:127], v[16:19]
    ds_read_b128 v[116:119], v6 offset:0
    ds_read_b128 v[36:39], v2 offset:40960
    v_mfma_f32_16x16x32_bf16 v[20:23], v[80:83], v[124:127], v[20:23]
    ds_read_b128 v[40:43], v2 offset:41984
    v_mfma_f32_16x16x32_bf16 v[24:27], v[84:87], v[124:127], v[24:27]
    ds_read_b128 v[44:47], v2 offset:43008
    v_mfma_f32_16x16x32_bf16 v[28:31], v[88:91], v[124:127], v[28:31]
    ds_read_b128 v[48:51], v2 offset:44032
    v_mfma_f32_16x16x32_bf16 v[32:35], v[92:95], v[124:127], v[32:35]
    ds_read_b128 v[52:55], v2 offset:45056
    v_mfma_f32_16x16x32_bf16 v[16:19], v[96:99], v[128:131], v[16:19]
    ds_read_b128 v[120:123], v6 offset:1024
    ds_read_b128 v[56:59], v2 offset:46080
    v_mfma_f32_16x16x32_bf16 v[20:23], v[100:103], v[128:131], v[20:23]
    ds_read_b128 v[60:63], v2 offset:47104
    v_mfma_f32_16x16x32_bf16 v[24:27], v[104:107], v[128:131], v[24:27]
    ds_read_b128 v[64:67], v2 offset:48128
    v_mfma_f32_16x16x32_bf16 v[28:31], v[108:111], v[128:131], v[28:31]
    ds_read_b128 v[68:71], v2 offset:49152
    v_mfma_f32_16x16x32_bf16 v[32:35], v[112:115], v[128:131], v[32:35]
    ds_read_b128 v[72:75], v2 offset:50176
    s_waitcnt lgkmcnt(6)
    v_mfma_f32_16x16x32_bf16 v[16:19], v[36:39], v[116:119], v[16:19]
    v_mfma_f32_16x16x32_bf16 v[20:23], v[40:43], v[116:119], v[20:23]
    v_mfma_f32_16x16x32_bf16 v[24:27], v[44:47], v[116:119], v[24:27]
    v_mfma_f32_16x16x32_bf16 v[28:31], v[48:51], v[116:119], v[28:31]
    v_mfma_f32_16x16x32_bf16 v[32:35], v[52:55], v[116:119], v[32:35]
    s_waitcnt lgkmcnt(0)
    v_mfma_f32_16x16x32_bf16 v[16:19], v[56:59], v[120:123], v[16:19]
    v_mfma_f32_16x16x32_bf16 v[20:23], v[60:63], v[120:123], v[20:23]
    v_mfma_f32_16x16x32_bf16 v[24:27], v[64:67], v[120:123], v[24:27]
    v_mfma_f32_16x16x32_bf16 v[28:31], v[68:71], v[120:123], v[28:31]
    v_mfma_f32_16x16x32_bf16 v[32:35], v[72:75], v[120:123], v[32:35]
    s_waitcnt vmcnt(2)
    v_lshlrev_b32 v218, 16, v196
    v_and_b32 v219, 0xffff0000, v196
    v_lshlrev_b32 v220, 16, v197
    v_and_b32 v221, 0xffff0000, v197
    v_pk_add_f32 v[218:219], v[218:219], v[16:17]
    v_pk_add_f32 v[220:221], v[220:221], v[18:19]
    v_cvt_pk_bf16_f32 v208, v218, v219
    v_cvt_pk_bf16_f32 v209, v220, v221
    v_lshlrev_b32 v218, 16, v198
    v_and_b32 v219, 0xffff0000, v198
    v_lshlrev_b32 v220, 16, v199
    v_and_b32 v221, 0xffff0000, v199
    v_pk_add_f32 v[218:219], v[218:219], v[20:21]
    v_pk_add_f32 v[220:221], v[220:221], v[22:23]
    v_cvt_pk_bf16_f32 v210, v218, v219
    v_cvt_pk_bf16_f32 v211, v220, v221
    buffer_store_dwordx4 v[208:211], v7, s[12:15], s41 offen offset:0 nt
    s_waitcnt vmcnt(2)
    v_lshlrev_b32 v218, 16, v200
    v_and_b32 v219, 0xffff0000, v200
    v_lshlrev_b32 v220, 16, v201
    v_and_b32 v221, 0xffff0000, v201
    v_pk_add_f32 v[218:219], v[218:219], v[24:25]
    v_pk_add_f32 v[220:221], v[220:221], v[26:27]
    v_cvt_pk_bf16_f32 v212, v218, v219
    v_cvt_pk_bf16_f32 v213, v220, v221
    v_lshlrev_b32 v218, 16, v202
    v_and_b32 v219, 0xffff0000, v202
    v_lshlrev_b32 v220, 16, v203
    v_and_b32 v221, 0xffff0000, v203
    v_pk_add_f32 v[218:219], v[218:219], v[28:29]
    v_pk_add_f32 v[220:221], v[220:221], v[30:31]
    v_cvt_pk_bf16_f32 v214, v218, v219
    v_cvt_pk_bf16_f32 v215, v220, v221
    buffer_store_dwordx4 v[212:215], v7, s[12:15], s41 offen offset:64 nt
    s_waitcnt vmcnt(2)
    v_lshlrev_b32 v218, 16, v204
    v_and_b32 v219, 0xffff0000, v204
    v_lshlrev_b32 v220, 16, v205
    v_and_b32 v221, 0xffff0000, v205
    v_pk_add_f32 v[218:219], v[218:219], v[32:33]
    v_pk_add_f32 v[220:221], v[220:221], v[34:35]
    v_cvt_pk_bf16_f32 v216, v218, v219
    v_cvt_pk_bf16_f32 v217, v220, v221
    buffer_store_dwordx2 v[216:217], v7, s[12:15], s43 offen nt
    s_endpgm
L_end:
    s_endpgm
.section .rodata,"a"
.p2align 6
.amdhsa_kernel sequential_preLN__sliding_local_dilated__swiglu_ffn__prompt_kernel
  .amdhsa_next_free_vgpr 256
  .amdhsa_next_free_sgpr 102
  .amdhsa_accum_offset 256
  .amdhsa_group_segment_fixed_size 0
  .amdhsa_kernarg_size 80
  .amdhsa_user_sgpr_count 2
  .amdhsa_user_sgpr_kernarg_segment_ptr 1
  .amdhsa_system_sgpr_workgroup_id_x 1
.end_amdhsa_kernel
```
